```python
import torch

def _softmax(x, axis=-1):
    return torch.softmax(x, dim=axis)
def _gelu(x):
    return torch.nn.functional.gelu(x, approximate="tanh")
def _silu(x):
    return torch.nn.functional.silu(x)
def _sigmoid(x):
    return torch.sigmoid(x)
def _layernorm(x, axis=-1, eps=1e-5):
    m = x.mean(dim=axis, keepdim=True)
    v = x.var(dim=axis, keepdim=True, unbiased=False)
    return (x - m) / torch.sqrt(v + eps)
def _scatter_add(tgt, idx, src, axis=0):
    return tgt.clone().index_add_(axis, idx, src)
def _segment_sum(src, seg, n):
    out = torch.zeros((n,) + src.shape[1:], dtype=src.dtype)
    return out.index_add_(0, seg, src)
def _pad(x, pw):
    flat = tuple(v for pair in reversed(pw) for v in pair)
    return torch.nn.functional.pad(x, flat)

kernel_name = 'recurrent_scan__linear_kernel_hedgehog__dense_activation_silu__prompt'

def setup_inputs():

    _w = (lambda a: (lambda t: t.to(torch.bfloat16) if t.is_floating_point() else t)(torch.as_tensor(a)))
    def _A_setup():
        B, S, D, H = 1, 2048, 640, 32
        Dh = D // H
        return {
            "x": _w((lambda *s: torch.randn(*s, dtype=torch.bfloat16) * 0.05)(B, S, D)),
            "wqkv": _w((lambda *s: torch.randn(*s, dtype=torch.bfloat16) * 0.4)(D, 3 * D)),
            "w_phi": _w((lambda *s: torch.randn(*s, dtype=torch.bfloat16) * 0.4)(H, Dh, Dh) * (Dh ** -0.5)),
            "wo": _w((lambda *s: torch.randn(*s, dtype=torch.bfloat16) * 0.2)(D, D)),
        }
    _A_in = _A_setup()

    def _B_setup():
        B, S, D, F = 1, 2048, 640, 1728
        return {
            "x": _w((lambda *s: torch.randn(*s, dtype=torch.bfloat16) * 0.05)(B, S, D)),
            "w1": _w((lambda *s: torch.randn(*s, dtype=torch.bfloat16) * 0.4)(D, F) * (D ** -0.5)),
            "w2": _w((lambda *s: torch.randn(*s, dtype=torch.bfloat16) * 0.1)(F, D) * (F ** -0.5)),
        }
    _B_in = _B_setup()

    return {
        "A_x": _A_in["x"],
        "A_wqkv": _A_in["wqkv"],
        "A_w_phi": _A_in["w_phi"],
        "A_wo": _A_in["wo"],
        "B_x": _B_in["x"],
        "B_w1": _B_in["w1"],
        "B_w2": _B_in["w2"],
    }

def reference(A_x, A_wqkv, A_w_phi, A_wo, B_x, B_w1, B_w2):
    def _A_ref(x, wqkv, w_phi, wo):
        B, S, D = x.shape
        H = 32; Dh = D // H
        qkv = (lambda x, *d: x.permute(*d))((x @ wqkv).reshape(B, S, 3, H, Dh), 2, 0, 3, 1, 4)
        q, k, v = qkv[0], qkv[1], qkv[2]
        pq = torch.einsum("bhsd,hdf->bhsf", q, w_phi)
        pk = torch.einsum("bhsd,hdf->bhsf", k, w_phi)
        phi_q = torch.concatenate([_softmax(pq, axis=-1), _softmax(-pq, axis=-1)], axis=-1)
        phi_k = torch.concatenate([_softmax(pk, axis=-1), _softmax(-pk, axis=-1)], axis=-1)
        kv = torch.einsum("bhsf,bhsd->bhfd", phi_k, v)
        z  = torch.einsum("bhsf->bhf", phi_k)
        num = torch.einsum("bhqf,bhfd->bhqd", phi_q, kv)
        den = torch.einsum("bhqf,bhf->bhq", phi_q, z)[..., None] + 1e-6
        o = num / den
        return (lambda x, *d: x.permute(*d))(o, 0, 2, 1, 3).reshape(B, S, D) @ wo

    def _B_ref(x, w1, w2):
        h = torch.einsum("bsd,df->bsf", x, w1)
        h = _silu(h)
        out = torch.einsum("bsf,fd->bsd", h, w2)
        return out

    x = A_x
    xn = _layernorm(x, axis=-1)
    s = _A_ref(xn, A_wqkv, A_w_phi, A_wo)
    g = _silu(_B_ref(xn, B_w1, B_w2))
    return x + s * g
```

```asm
; @launch grid=(256,1,1) block=(256,1,1) lds=163840
.amdgcn_target "amdgcn-amd-amdhsa--gfx950"
.text
.globl recurrent_scan__linear_kernel_hedgehog__dense_activation_silu__prompt_kernel
.p2align 8
.type recurrent_scan__linear_kernel_hedgehog__dense_activation_silu__prompt_kernel,@function
recurrent_scan__linear_kernel_hedgehog__dense_activation_silu__prompt_kernel:
s_cmp_ge_u32 s2, 256
s_cbranch_scc1 L1_end
s_load_dwordx4 s[4:7], s[0:1], 0
s_load_dwordx4 s[8:11], s[0:1], 16
s_load_dwordx4 s[12:15], s[0:1], 40
s_load_dwordx4 s[16:19], s[0:1], 56
s_load_dwordx2 s[20:21], s[0:1], 72
s_getpc_b64 s[22:23]
L1_pc:
v_and_b32 v1, 63, v0
v_lshrrev_b32 v2, 6, v0
s_and_b32 s60, s2, 7
v_readfirstlane_b32 s56, v2
s_lshr_b32 s61, s2, 3
s_lshr_b32 s62, s60, 2
s_lshl_b32 s57, s62, 3
s_lshr_b32 s62, s61, 2
s_add_u32 s57, s57, s62
s_and_b32 s62, s60, 3
s_lshl_b32 s58, s62, 1
s_and_b32 s62, s61, 1
s_add_u32 s58, s58, s62
s_bfe_u32 s62, s61, 0x10001
s_lshl_b32 s62, s62, 3
s_add_u32 s59, s58, s62
s_and_b32 s62, s61, 3
s_mul_i32 s63, s62, 5
s_lshr_b32 s63, s63, 1
s_lshr_b32 s62, s61, 2
s_add_u32 s85, s62, s63
s_sub_u32 s62, s85, 10
s_cmp_ge_u32 s85, 10
s_cselect_b32 s85, s62, s85
s_mov_b32 s52, s22
s_and_b32 s53, s23, 0xffff
s_mov_b32 s54, L_code_end-L1_pc
s_mov_b32 s55, 0x20000
v_lshlrev_b32 v2, 4, v0
s_lshl_b32 s63, s61, 12
buffer_load_dwordx4 a[252:255], v2, s[52:55], s63 offen
s_mov_b32 s64, 0xffff0000
s_mov_b32 s65, 0x3f803f80
s_mov_b32 s84, 0
s_mov_b32 s66, 0x3fb8aa3b
s_mov_b32 s67, 0x3fb8aa3b
s_mov_b32 s68, 0xbfb8aa3b
s_mov_b32 s69, 0xbfb8aa3b
s_mov_b32 s80, 1.0
s_mov_b32 s81, 1.0
s_mul_i32 s74, s56, 5120
s_mul_i32 s75, s56, 3072
s_lshl_b32 s60, s57, 2
s_add_u32 s60, s60, s56
s_mul_i32 s70, s60, 40960
s_add_u32 s71, s70, 10240
s_add_u32 s72, s70, 20480
s_add_u32 s73, s70, 30720
s_lshr_b32 s60, s56, 1
s_lshl_b32 s61, s57, 1
s_add_u32 s60, s60, s61
s_mul_i32 s78, s60, 303104
s_add_u32 s78, s78, 2359296
s_lshl_b32 s79, s2, 2
s_add_u32 s79, s79, s56
s_and_b32 s60, s2, 7
s_lshr_b32 s61, s2, 3
s_lshr_b32 s62, s61, 2
s_and_b32 s63, s60, 1
s_lshr_b32 s60, s60, 1
s_lshl_b32 s60, s60, 3
s_add_u32 s60, s60, s62
s_and_b32 s61, s61, 3
s_lshl_b32 s63, s63, 2
s_add_u32 s61, s61, s63
s_mul_i32 s62, s56, 18
s_lshr_b32 s92, s60, 1
s_mul_i32 s63, s60, 74
s_add_u32 s63, s63, s62
s_lshl_b32 s63, s63, 12
s_add_u32 s89, s63, 2359296
s_mul_i32 s63, s61, 74
s_add_u32 s63, s63, s62
s_mul_i32 s63, s63, 5120
s_add_u32 s90, s63, 12582912
s_lshl_b32 s63, s62, 3
s_add_u32 s63, s63, s61
s_lshl_b32 s63, s63, 7
s_add_u32 s93, s63, 16252928
s_lshl_b32 s63, s60, 2
s_add_u32 s63, s63, s56
s_mul_i32 s63, s63, 20480
s_mul_i32 s62, s61, 160
s_add_u32 s91, s63, s62
v_lshrrev_b32 v3, 3, v1
v_and_b32_e64 v4, 7, v1
v_mul_u32_u24 v2, 1280, v3
v_lshl_add_u32 v2, v4, 4, v2
s_waitcnt lgkmcnt(0)
s_mov_b32 s24, s4
s_and_b32 s25, s5, 0xffff
s_mov_b32 s26, 2621440
s_mov_b32 s27, 0x20000
s_mov_b32 s28, s6
s_and_b32 s29, s7, 0xffff
s_mov_b32 s30, 2457600
s_mov_b32 s31, 0x20000
s_mov_b32 s32, s8
s_and_b32 s33, s9, 0xffff
s_mov_b32 s34, 25600
s_mov_b32 s35, 0x20000
s_mov_b32 s36, s12
s_and_b32 s37, s13, 0xffff
s_mov_b32 s38, 2211840
s_mov_b32 s39, 0x20000
s_mov_b32 s44, s20
s_and_b32 s45, s21, 0xffff
s_mov_b32 s46, 16777216
s_mov_b32 s47, 0x20000
s_mov_b32 s48, s18
s_and_b32 s49, s19, 0xffff
s_mov_b32 s50, 256
s_mov_b32 s51, 0x20000
s_mov_b32 s96, s16
s_and_b32 s97, s17, 0xffff
s_mov_b32 s98, 2621440
s_mov_b32 s99, 0x20000
s_mov_b32 s7, 0x200000
v_lshrrev_b32 v5, 1, v3
v_xor_b32 v5, v4, v5
v_mul_u32_u24 v2, 1280, v3
v_lshl_add_u32 v22, v5, 4, v2
v_xor_b32_e64 v5, 4, v5
v_lshl_add_u32 v23, v5, 4, v2
v_add_u32 v23, 10240, v23
v_add_u32 v26, 20480, v22
v_add_u32 v27, 20480, v23
s_mul_i32 s88, s56, 12288
s_add_u32 s88, s88, 98304
s_lshl_b32 s86, s85, 7
s_add_u32 s60, s70, s86
s_add_u32 m0, s88, 0
s_nop 0
buffer_load_dwordx4 v22, s[24:27], s60 offen lds
s_add_u32 s60, s70, s86
s_add_u32 m0, s88, 1024
s_nop 0
buffer_load_dwordx4 v23, s[24:27], s60 offen lds
s_add_u32 s60, s70, s86
s_add_u32 m0, s88, 2048
s_nop 0
buffer_load_dwordx4 v26, s[24:27], s60 offen lds
s_add_u32 s60, s70, s86
s_add_u32 m0, s88, 3072
s_nop 0
buffer_load_dwordx4 v27, s[24:27], s60 offen lds
s_add_u32 s86, s86, 128
s_cmp_ge_u32 s86, 1280
s_cselect_b32 s86, 0, s86
s_add_u32 s60, s70, s86
s_add_u32 m0, s88, 4096
s_nop 0
buffer_load_dwordx4 v22, s[24:27], s60 offen lds
s_add_u32 s60, s70, s86
s_add_u32 m0, s88, 5120
s_nop 0
buffer_load_dwordx4 v23, s[24:27], s60 offen lds
s_add_u32 s60, s70, s86
s_add_u32 m0, s88, 6144
s_nop 0
buffer_load_dwordx4 v26, s[24:27], s60 offen lds
s_add_u32 s60, s70, s86
s_add_u32 m0, s88, 7168
s_nop 0
buffer_load_dwordx4 v27, s[24:27], s60 offen lds
s_add_u32 s86, s86, 128
s_cmp_ge_u32 s86, 1280
s_cselect_b32 s86, 0, s86
s_add_u32 s60, s70, s86
s_add_u32 m0, s88, 8192
s_nop 0
buffer_load_dwordx4 v22, s[24:27], s60 offen lds
s_add_u32 s60, s70, s86
s_add_u32 m0, s88, 9216
s_nop 0
buffer_load_dwordx4 v23, s[24:27], s60 offen lds
s_add_u32 s60, s70, s86
s_add_u32 m0, s88, 10240
s_nop 0
buffer_load_dwordx4 v26, s[24:27], s60 offen lds
s_add_u32 s60, s70, s86
s_add_u32 m0, s88, 11264
s_nop 0
buffer_load_dwordx4 v27, s[24:27], s60 offen lds
s_add_u32 s86, s86, 128
s_cmp_ge_u32 s86, 1280
s_cselect_b32 s86, 0, s86
v_and_b32 v3, 31, v1
v_lshrrev_b32_e64 v4, 5, v1
v_bfe_u32 v5, v3, 1, 3
v_xor_b32 v5, v4, v5
v_lshlrev_b32 v5, 4, v5
v_lshl_add_u32 v16, v3, 7, v5
v_add_u32 v16, s88, v16
v_mov_b32 v5, v16
s_add_u32 s60, s56, 0
s_and_b32 s60, s60, 3
s_lshl_b32 s60, s60, 5
v_xor_b32 v16, s60, v5
s_add_u32 s60, s56, 1
s_and_b32 s60, s60, 3
s_lshl_b32 s60, s60, 5
v_xor_b32 v17, s60, v5
s_add_u32 s60, s56, 2
s_and_b32 s60, s60, 3
s_lshl_b32 s60, s60, 5
v_xor_b32 v18, s60, v5
s_add_u32 s60, s56, 3
s_and_b32 s60, s60, 3
s_lshl_b32 s60, s60, 5
v_xor_b32 v19, s60, v5
v_bfe_u32 v28, v1, 4, 1
v_lshrrev_b32_e64 v29, 5, v1
v_bfe_u32 v30, v1, 2, 2
v_lshl_add_u32 v29, v29, 3, v30
v_and_b32_e64 v30, 1, v1
v_lshl_add_u32 v28, v30, 1, v28
v_lshlrev_b32_e64 v28, 4, v28
v_bfe_u32 v30, v1, 1, 1
v_lshl_add_u32 v28, v30, 3, v28
v_mul_u32_u24 v2, 320, v29
v_add_u32_e64 v2, v2, v28
v_add_u32 v3, 49152, v2
v_mul_u32_u24 v4, 192, v29
v_add_u32_e64 v4, v4, v28
v_add_u32 v5, 49152, v4
s_cmp_ge_u32 s59, 8
s_cbranch_scc1 L1_typeB
s_mul_i32 s82, s58, 3
s_add_u32 s82, s82, 32
s_min_u32 s82, s82, 51
v_add_u32 v28, 0, v1
v_mul_u32_u24 v29, 3277, v28
v_lshrrev_b32 v29, 16, v29
v_mul_u32_u24 v30, 20, v29
v_sub_u32_e64 v30, v28, v30
v_mul_u32_u24 v6, 3840, v29
v_lshrrev_b32 v28, 2, v30
v_and_b32 v31, 1, v30
v_lshl_add_u32 v28, v28, 1, v31
v_bfe_u32 v31, v30, 1, 1
v_cmp_lt_u32 vcc, 4, v28
v_mov_b32 v29, 1280
v_mov_b32 v30, 2480
v_cndmask_b32 v29, v29, v30, vcc
v_add_u32_e64 v6, v6, v29
v_lshl_add_u32 v6, v28, 4, v6
v_mul_u32_u24 v31, 80, v31
v_add_u32_e64 v6, v6, v31
s_mul_i32 s60, s58, 160
v_add_u32 v6, s60, v6
v_add_u32 v28, 64, v1
v_mul_u32_u24 v29, 3277, v28
v_lshrrev_b32 v29, 16, v29
v_mul_u32_u24 v30, 20, v29
v_sub_u32_e64 v30, v28, v30
v_mul_u32_u24 v7, 3840, v29
v_lshrrev_b32 v28, 2, v30
v_and_b32 v31, 1, v30
v_lshl_add_u32 v28, v28, 1, v31
v_bfe_u32 v31, v30, 1, 1
v_cmp_lt_u32 vcc, 4, v28
v_mov_b32 v29, 1280
v_mov_b32 v30, 2480
v_cndmask_b32 v29, v29, v30, vcc
v_add_u32_e64 v7, v7, v29
v_lshl_add_u32 v7, v28, 4, v7
v_mul_u32_u24 v31, 80, v31
v_add_u32_e64 v7, v7, v31
s_mul_i32 s60, s58, 160
v_add_u32_e64 v7, s60, v7
v_add_u32 v28, 128, v1
v_mul_u32_u24 v29, 3277, v28
v_lshrrev_b32 v29, 16, v29
v_mul_u32_u24 v30, 20, v29
v_sub_u32_e64 v30, v28, v30
v_mul_u32_u24 v8, 3840, v29
v_lshrrev_b32 v28, 2, v30
v_and_b32 v31, 1, v30
v_lshl_add_u32 v28, v28, 1, v31
v_bfe_u32 v31, v30, 1, 1
v_cmp_lt_u32 vcc, 4, v28
v_mov_b32 v29, 1280
v_mov_b32 v30, 2480
v_cndmask_b32 v29, v29, v30, vcc
v_add_u32_e64 v8, v8, v29
v_lshl_add_u32 v8, v28, 4, v8
v_mul_u32_u24 v31, 80, v31
v_add_u32_e64 v8, v8, v31
s_mul_i32 s60, s58, 160
v_add_u32_e64 v8, s60, v8
v_add_u32 v28, 192, v1
v_mul_u32_u24 v29, 3277, v28
v_lshrrev_b32 v29, 16, v29
v_mul_u32_u24 v30, 20, v29
v_sub_u32_e64 v30, v28, v30
v_mul_u32_u24 v9, 3840, v29
v_lshrrev_b32 v28, 2, v30
v_and_b32 v31, 1, v30
v_lshl_add_u32 v28, v28, 1, v31
v_bfe_u32 v31, v30, 1, 1
v_cmp_lt_u32 vcc, 4, v28
v_mov_b32 v29, 1280
v_mov_b32 v30, 2480
v_cndmask_b32 v29, v29, v30, vcc
v_add_u32_e64 v9, v9, v29
v_lshl_add_u32 v9, v28, 4, v9
v_mul_u32_u24 v31, 80, v31
v_add_u32_e64 v9, v9, v31
s_mul_i32 s60, s58, 160
v_add_u32_e64 v9, s60, v9
v_add_u32 v28, 256, v1
v_mul_u32_u24 v29, 3277, v28
v_lshrrev_b32 v29, 16, v29
v_mul_u32_u24 v30, 20, v29
v_sub_u32_e64 v30, v28, v30
v_mul_u32_u24 v10, 3840, v29
v_lshrrev_b32 v28, 2, v30
v_and_b32 v31, 1, v30
v_lshl_add_u32 v28, v28, 1, v31
v_bfe_u32 v31, v30, 1, 1
v_cmp_lt_u32 vcc, 4, v28
v_mov_b32 v29, 1280
v_mov_b32 v30, 2480
v_cndmask_b32 v29, v29, v30, vcc
v_add_u32_e64 v10, v10, v29
v_lshl_add_u32 v10, v28, 4, v10
v_mul_u32_u24 v31, 80, v31
v_add_u32_e64 v10, v10, v31
s_mul_i32 s60, s58, 160
v_add_u32 v10, s60, v10
v_add_u32 v28, 0, v1
v_mul_u32_u24 v29, 5462, v28
v_lshrrev_b32 v29, 16, v29
v_mul_u32_u24 v30, 12, v29
v_sub_u32_e64 v30, v28, v30
v_mul_u32_u24 v11, 3456, v29
v_lshl_add_u32 v11, v30, 4, v11
s_lshl_b32 s60, s82, 6
v_add_u32 v11, s60, v11
v_add_u32_e64 v28, 64, v1
v_mul_u32_u24 v29, 5462, v28
v_lshrrev_b32 v29, 16, v29
v_mul_u32_u24 v30, 12, v29
v_sub_u32_e64 v30, v28, v30
v_mul_u32_u24 v12, 3456, v29
v_lshl_add_u32 v12, v30, 4, v12
s_lshl_b32 s60, s82, 6
v_add_u32 v12, s60, v12
v_add_u32 v28, 128, v1
v_mul_u32_u24 v29, 5462, v28
v_lshrrev_b32 v29, 16, v29
v_mul_u32_u24 v30, 12, v29
v_sub_u32_e64 v30, v28, v30
v_mul_u32_u24 v13, 3456, v29
v_lshl_add_u32 v13, v30, 4, v13
s_lshl_b32 s60, s82, 6
v_add_u32 v13, s60, v13
s_lshl_b32 s60, s85, 2
s_add_u32 s60, s60, s56
s_mul_i32 s76, s60, 61440
s_mul_i32 s77, s60, 55296
s_add_u32 s60, s56, 0
s_and_b32 s60, s60, 3
s_mul_i32 s60, s60, 5120
v_add_u32_e64 v144, s60, v2
v_add_u32 v145, 49152, v144
s_add_u32 s60, s56, 1
s_and_b32 s60, s60, 3
s_mul_i32 s60, s60, 5120
v_add_u32_e64 v146, s60, v2
v_add_u32 v147, 49152, v146
s_add_u32 s60, s56, 2
s_and_b32 s60, s60, 3
s_mul_i32 s60, s60, 5120
v_add_u32_e64 v148, s60, v2
v_add_u32 v149, 49152, v148
s_add_u32 s60, s56, 3
s_and_b32 s60, s60, 3
s_mul_i32 s60, s60, 5120
v_add_u32_e64 v150, s60, v2
v_add_u32 v151, 49152, v150
s_lshl_b32 s60, s57, 3
s_add_u32 s60, s60, s58
s_lshl_b32 s60, s60, 2
s_add_u32 s60, s60, s56
s_and_b32 s61, s60, 7
s_lshr_b32 s62, s60, 3
s_lshr_b32 s63, s62, 2
s_min_u32 s63, s63, 3
s_mul_i32 s63, s63, 14
s_add_u32 s63, s63, s62
s_add_u32 s63, s63, 14
s_lshl_b32 s63, s63, 3
s_add_u32 s63, s63, s61
s_cmp_lt_u32 s60, 144
s_cselect_b32 s79, s63, 592
s_mul_i32 s94, s56, 30720
s_add_u32 s94, s94, 24576
v_mov_b32 v20, 0
v_mov_b32 v21, 0
v_mov_b32 v14, 0
v_mov_b32 v15, 0
v_mov_b32 v24, 0
v_mov_b32 v25, 0
v_mov_b32 v192, 0
v_mov_b32 v193, 0
s_add_u32 m0, s74, 0
s_nop 0
buffer_load_dwordx4 v6, s[28:31], s76 offen lds
s_add_u32 m0, s74, 1024
s_nop 0
buffer_load_dwordx4 v7, s[28:31], s76 offen lds
s_add_u32 m0, s74, 2048
s_nop 0
buffer_load_dwordx4 v8, s[28:31], s76 offen lds
s_add_u32 m0, s74, 3072
s_nop 0
buffer_load_dwordx4 v9, s[28:31], s76 offen lds
s_add_u32 m0, s74, 4096
s_nop 0
buffer_load_dwordx4 v10, s[28:31], s76 offen lds
s_add_u32 s76, s76, 245760
s_sub_u32 s87, s76, 2457600
s_cmp_ge_u32 s76, 2457600
s_cselect_b32 s76, s87, s76
s_add_u32 m0, s74, 20480
s_nop 0
buffer_load_dwordx4 v6, s[28:31], s76 offen lds
s_add_u32 m0, s74, 21504
s_nop 0
buffer_load_dwordx4 v7, s[28:31], s76 offen lds
s_add_u32 m0, s74, 22528
s_nop 0
buffer_load_dwordx4 v8, s[28:31], s76 offen lds
s_add_u32 m0, s74, 23552
s_nop 0
buffer_load_dwordx4 v9, s[28:31], s76 offen lds
s_add_u32 m0, s74, 24576
s_nop 0
buffer_load_dwordx4 v10, s[28:31], s76 offen lds
s_add_u32 s76, s76, 245760
s_sub_u32 s87, s76, 2457600
s_cmp_ge_u32 s76, 2457600
s_cselect_b32 s76, s87, s76
s_add_u32 m0, s74, 40960
s_nop 0
buffer_load_dwordx4 v6, s[28:31], s76 offen lds
s_add_u32 m0, s74, 41984
s_nop 0
buffer_load_dwordx4 v7, s[28:31], s76 offen lds
s_add_u32 m0, s74, 43008
s_nop 0
buffer_load_dwordx4 v8, s[28:31], s76 offen lds
s_add_u32 m0, s74, 44032
s_nop 0
buffer_load_dwordx4 v9, s[28:31], s76 offen lds
s_add_u32 m0, s74, 45056
s_nop 0
buffer_load_dwordx4 v10, s[28:31], s76 offen lds
s_add_u32 s76, s76, 245760
s_sub_u32 s87, s76, 2457600
s_cmp_ge_u32 s76, 2457600
s_cselect_b32 s76, s87, s76
s_lshl_b32 s60, s58, 2
s_add_u32 s60, s60, s56
s_mul_i32 s60, s60, 800
v_lshlrev_b32_e64 v28, 3, v1
buffer_load_dwordx2 v[194:195], v28, s[32:35], s60 offen
buffer_load_dwordx2 v[196:197], v28, s[32:35], s60 offen offset:512
s_or_b32 s60, s2, s56
s_cmp_lg_u32 s60, 0
s_cbranch_scc1 L_nn_skip
s_memrealtime s[62:63]
s_waitcnt lgkmcnt(0)
s_or_b32 s62, s62, 1
v_mov_b32 v38, s62
s_mov_b64 exec, 1
buffer_store_dword v38, off, s[48:51], 0 sc1
s_mov_b64 exec, -1
L_nn_skip:
v_mov_b32 v44, 0
v_mov_b32 v45, 0
v_mov_b32 v46, 0
v_mov_b32 v47, 0
v_lshlrev_b32_e64 v48, 4, v0
v_add_u32 v48, 147456, v48
ds_write_b128 v48, v[44:47] offset:0
ds_write_b128 v48, v[44:47] offset:4096
ds_write_b128 v48, v[44:47] offset:8192
ds_write_b128 v48, v[44:47] offset:12288
v_bfe_u32 v28, v1, 4, 1
v_and_b32 v29, 15, v1
v_mov_b32 v246, s65
v_cmp_eq_u32 vcc, v28, v29
s_nop 1
v_cndmask_b32 v246, 0, v246, vcc
v_mov_b32 v247, v246
v_mov_b32 v248, v246
v_mov_b32 v249, v246
s_waitcnt vmcnt(25)
ds_read_b128 a[0:3], v16 offset:0
ds_read_b128 a[4:7], v17 offset:0
ds_read_b128 a[8:11], v18 offset:0
ds_read_b128 a[12:15], v19 offset:0
ds_read_b128 v[160:163], v16 offset:0
ds_read_b128 v[164:167], v17 offset:0
ds_read_b128 v[168:171], v18 offset:0
ds_read_b128 v[172:175], v19 offset:0
s_waitcnt lgkmcnt(0)
s_add_u32 s60, s70, s86
s_add_u32 m0, s88, 0
s_nop 0
buffer_load_dwordx4 v22, s[24:27], s60 offen lds
s_add_u32 s60, s70, s86
s_add_u32 m0, s88, 1024
s_nop 0
buffer_load_dwordx4 v23, s[24:27], s60 offen lds
s_add_u32 s60, s70, s86
s_add_u32 m0, s88, 2048
s_nop 0
buffer_load_dwordx4 v26, s[24:27], s60 offen lds
s_add_u32 s60, s70, s86
s_add_u32 m0, s88, 3072
s_nop 0
buffer_load_dwordx4 v27, s[24:27], s60 offen lds
s_add_u32 s86, s86, 128
s_cmp_ge_u32 s86, 1280
s_cselect_b32 s86, 0, s86
v_dot2c_f32_bf16 v20, s65, v160
v_dot2c_f32_bf16 v24, v160, v160
v_dot2c_f32_bf16 v21, s65, v161
v_dot2c_f32_bf16 v25, v161, v161
v_dot2c_f32_bf16 v14, s65, v162
v_dot2c_f32_bf16 v192, v162, v162
v_dot2c_f32_bf16 v15, s65, v163
v_dot2c_f32_bf16 v193, v163, v163
v_dot2c_f32_bf16 v20, s65, v164
v_dot2c_f32_bf16 v24, v164, v164
v_dot2c_f32_bf16 v21, s65, v165
v_dot2c_f32_bf16 v25, v165, v165
v_dot2c_f32_bf16 v14, s65, v166
v_dot2c_f32_bf16 v192, v166, v166
v_dot2c_f32_bf16 v15, s65, v167
v_dot2c_f32_bf16 v193, v167, v167
v_dot2c_f32_bf16 v20, s65, v168
v_dot2c_f32_bf16 v24, v168, v168
v_dot2c_f32_bf16 v21, s65, v169
v_dot2c_f32_bf16 v25, v169, v169
v_dot2c_f32_bf16 v14, s65, v170
v_dot2c_f32_bf16 v192, v170, v170
v_dot2c_f32_bf16 v15, s65, v171
v_dot2c_f32_bf16 v193, v171, v171
v_dot2c_f32_bf16 v20, s65, v172
v_dot2c_f32_bf16 v24, v172, v172
v_dot2c_f32_bf16 v21, s65, v173
v_dot2c_f32_bf16 v25, v173, v173
v_dot2c_f32_bf16 v14, s65, v174
v_dot2c_f32_bf16 v192, v174, v174
v_dot2c_f32_bf16 v15, s65, v175
v_dot2c_f32_bf16 v193, v175, v175
s_waitcnt vmcnt(16)
s_barrier
ds_read_b64_tr_b16 a[160:161], v144 offset:0
ds_read_b64_tr_b16 a[162:163], v144 offset:1280
ds_read_b64_tr_b16 a[164:165], v144 offset:64
ds_read_b64_tr_b16 a[166:167], v144 offset:1344
ds_read_b64_tr_b16 a[168:169], v144 offset:128
ds_read_b64_tr_b16 a[170:171], v144 offset:1408
ds_read_b64_tr_b16 a[172:173], v144 offset:192
ds_read_b64_tr_b16 a[174:175], v144 offset:1472
s_waitcnt lgkmcnt(6)
v_mfma_f32_32x32x16_bf16 v[32:47], a[160:163], a[0:3], 0
ds_read_b64_tr_b16 a[176:177], v144 offset:256
ds_read_b64_tr_b16 a[178:179], v144 offset:1536
v_mfma_f32_16x16x32_bf16 v[208:211], a[160:163], v[246:249], 0
s_add_u32 m0, s74, 61440
s_nop 0
buffer_load_dwordx4 v6, s[28:31], s76 offen lds
s_waitcnt lgkmcnt(6)
v_mfma_f32_32x32x16_bf16 v[48:63], a[164:167], a[0:3], 0
ds_read_b64_tr_b16 a[180:181], v146 offset:0
ds_read_b64_tr_b16 a[182:183], v146 offset:1280
v_mfma_f32_16x16x32_bf16 v[212:215], a[164:167], v[246:249], 0
s_waitcnt lgkmcnt(6)
v_mfma_f32_32x32x16_bf16 v[64:79], a[168:171], a[0:3], 0
ds_read_b64_tr_b16 a[184:185], v146 offset:64
ds_read_b64_tr_b16 a[186:187], v146 offset:1344
v_mfma_f32_16x16x32_bf16 v[216:219], a[168:171], v[246:249], 0
s_add_u32 m0, s74, 62464
s_nop 0
buffer_load_dwordx4 v7, s[28:31], s76 offen lds
s_waitcnt lgkmcnt(6)
v_mfma_f32_32x32x16_bf16 v[80:95], a[172:175], a[0:3], 0
ds_read_b64_tr_b16 a[188:189], v146 offset:128
ds_read_b64_tr_b16 a[190:191], v146 offset:1408
v_mfma_f32_16x16x32_bf16 v[220:223], a[172:175], v[246:249], 0
s_waitcnt lgkmcnt(6)
v_mfma_f32_32x32x16_bf16 v[96:111], a[176:179], a[0:3], 0
ds_read_b64_tr_b16 a[192:193], v146 offset:192
ds_read_b64_tr_b16 a[194:195], v146 offset:1472
v_mfma_f32_16x16x32_bf16 v[224:227], a[176:179], v[246:249], 0
s_add_u32 m0, s74, 63488
s_nop 0
buffer_load_dwordx4 v8, s[28:31], s76 offen lds
s_waitcnt lgkmcnt(6)
v_mfma_f32_32x32x16_bf16 v[32:47], a[180:183], a[4:7], v[32:47]
ds_read_b64_tr_b16 a[196:197], v146 offset:256
ds_read_b64_tr_b16 a[198:199], v146 offset:1536
ds_read_b128 a[16:19], v16 offset:4096
ds_read_b128 a[20:23], v17 offset:4096
ds_read_b128 a[24:27], v18 offset:4096
ds_read_b128 a[28:31], v19 offset:4096
ds_read_b128 v[176:179], v16 offset:4096
ds_read_b128 v[180:183], v17 offset:4096
ds_read_b128 v[184:187], v18 offset:4096
ds_read_b128 v[188:191], v19 offset:4096
s_waitcnt lgkmcnt(14)
v_mfma_f32_32x32x16_bf16 v[48:63], a[184:187], a[4:7], v[48:63]
ds_read_b64_tr_b16 a[200:201], v148 offset:0
ds_read_b64_tr_b16 a[202:203], v148 offset:1280
s_add_u32 m0, s74, 64512
s_nop 0
buffer_load_dwordx4 v9, s[28:31], s76 offen lds
s_waitcnt lgkmcnt(14)
v_mfma_f32_32x32x16_bf16 v[64:79], a[188:191], a[4:7], v[64:79]
ds_read_b64_tr_b16 a[204:205], v148 offset:64
ds_read_b64_tr_b16 a[206:207], v148 offset:1344
s_waitcnt lgkmcnt(14)
v_mfma_f32_32x32x16_bf16 v[80:95], a[192:195], a[4:7], v[80:95]
ds_read_b64_tr_b16 a[160:161], v148 offset:128
ds_read_b64_tr_b16 a[162:163], v148 offset:1408
s_add_u32 m0, s74, 65536
s_nop 0
buffer_load_dwordx4 v10, s[28:31], s76 offen lds
s_add_u32 s76, s76, 245760
s_sub_u32 s87, s76, 2457600
s_cmp_ge_u32 s76, 2457600
s_cselect_b32 s76, s87, s76
s_waitcnt lgkmcnt(14)
v_mfma_f32_32x32x16_bf16 v[96:111], a[196:199], a[4:7], v[96:111]
ds_read_b64_tr_b16 a[164:165], v148 offset:192
ds_read_b64_tr_b16 a[166:167], v148 offset:1472
s_waitcnt lgkmcnt(8)
v_dot2c_f32_bf16 v20, s65, v176
v_dot2c_f32_bf16 v24, v176, v176
v_dot2c_f32_bf16 v21, s65, v177
v_dot2c_f32_bf16 v25, v177, v177
v_dot2c_f32_bf16 v14, s65, v178
v_dot2c_f32_bf16 v192, v178, v178
v_dot2c_f32_bf16 v15, s65, v179
v_dot2c_f32_bf16 v193, v179, v179
v_dot2c_f32_bf16 v20, s65, v180
v_dot2c_f32_bf16 v24, v180, v180
v_dot2c_f32_bf16 v21, s65, v181
v_dot2c_f32_bf16 v25, v181, v181
v_dot2c_f32_bf16 v14, s65, v182
v_dot2c_f32_bf16 v192, v182, v182
v_dot2c_f32_bf16 v15, s65, v183
v_dot2c_f32_bf16 v193, v183, v183
v_dot2c_f32_bf16 v20, s65, v184
v_dot2c_f32_bf16 v24, v184, v184
v_dot2c_f32_bf16 v21, s65, v185
v_dot2c_f32_bf16 v25, v185, v185
v_dot2c_f32_bf16 v14, s65, v186
v_dot2c_f32_bf16 v192, v186, v186
v_dot2c_f32_bf16 v15, s65, v187
v_dot2c_f32_bf16 v193, v187, v187
v_dot2c_f32_bf16 v20, s65, v188
v_dot2c_f32_bf16 v24, v188, v188
v_dot2c_f32_bf16 v21, s65, v189
v_dot2c_f32_bf16 v25, v189, v189
v_dot2c_f32_bf16 v14, s65, v190
v_dot2c_f32_bf16 v192, v190, v190
v_dot2c_f32_bf16 v15, s65, v191
v_dot2c_f32_bf16 v193, v191, v191
s_waitcnt lgkmcnt(6)
v_mfma_f32_32x32x16_bf16 v[32:47], a[200:203], a[8:11], v[32:47]
ds_read_b64_tr_b16 a[168:169], v148 offset:256
ds_read_b64_tr_b16 a[170:171], v148 offset:1536
s_waitcnt lgkmcnt(6)
v_mfma_f32_32x32x16_bf16 v[48:63], a[204:207], a[8:11], v[48:63]
ds_read_b64_tr_b16 a[172:173], v150 offset:0
ds_read_b64_tr_b16 a[174:175], v150 offset:1280
s_add_u32 s60, s70, s86
s_add_u32 m0, s88, 4096
s_nop 0
buffer_load_dwordx4 v22, s[24:27], s60 offen lds
s_waitcnt lgkmcnt(6)
v_mfma_f32_32x32x16_bf16 v[64:79], a[160:163], a[8:11], v[64:79]
ds_read_b64_tr_b16 a[176:177], v150 offset:64
ds_read_b64_tr_b16 a[178:179], v150 offset:1344
s_waitcnt lgkmcnt(6)
v_mfma_f32_32x32x16_bf16 v[80:95], a[164:167], a[8:11], v[80:95]
ds_read_b64_tr_b16 a[180:181], v150 offset:128
ds_read_b64_tr_b16 a[182:183], v150 offset:1408
s_add_u32 s60, s70, s86
s_add_u32 m0, s88, 5120
s_nop 0
buffer_load_dwordx4 v23, s[24:27], s60 offen lds
s_waitcnt lgkmcnt(6)
v_mfma_f32_32x32x16_bf16 v[96:111], a[168:171], a[8:11], v[96:111]
ds_read_b64_tr_b16 a[184:185], v150 offset:192
ds_read_b64_tr_b16 a[186:187], v150 offset:1472
s_waitcnt lgkmcnt(6)
v_mfma_f32_32x32x16_bf16 v[32:47], a[172:175], a[12:15], v[32:47]
ds_read_b64_tr_b16 a[188:189], v150 offset:256
ds_read_b64_tr_b16 a[190:191], v150 offset:1536
s_add_u32 s60, s70, s86
s_add_u32 m0, s88, 6144
s_nop 0
buffer_load_dwordx4 v26, s[24:27], s60 offen lds
s_waitcnt lgkmcnt(6)
v_mfma_f32_32x32x16_bf16 v[48:63], a[176:179], a[12:15], v[48:63]
s_waitcnt lgkmcnt(4)
v_mfma_f32_32x32x16_bf16 v[64:79], a[180:183], a[12:15], v[64:79]
s_waitcnt lgkmcnt(0)
s_waitcnt vmcnt(19)
s_barrier
ds_read_b64_tr_b16 a[192:193], v144 offset:20480
ds_read_b64_tr_b16 a[194:195], v144 offset:21760
ds_read_b64_tr_b16 a[196:197], v144 offset:20544
ds_read_b64_tr_b16 a[198:199], v144 offset:21824
s_add_u32 s60, s70, s86
s_add_u32 m0, s88, 7168
s_nop 0
buffer_load_dwordx4 v27, s[24:27], s60 offen lds
s_add_u32 s86, s86, 128
s_cmp_ge_u32 s86, 1280
s_cselect_b32 s86, 0, s86
v_mfma_f32_32x32x16_bf16 v[80:95], a[184:187], a[12:15], v[80:95]
ds_read_b64_tr_b16 a[200:201], v144 offset:20608
ds_read_b64_tr_b16 a[202:203], v144 offset:21888
s_add_u32 m0, s74, 0
s_nop 0
buffer_load_dwordx4 v6, s[28:31], s76 offen lds
v_mfma_f32_32x32x16_bf16 v[96:111], a[188:191], a[12:15], v[96:111]
ds_read_b64_tr_b16 a[204:205], v144 offset:20672
ds_read_b64_tr_b16 a[206:207], v144 offset:21952
s_waitcnt lgkmcnt(6)
v_mfma_f32_32x32x16_bf16 v[32:47], a[192:195], a[16:19], v[32:47]
ds_read_b64_tr_b16 a[160:161], v144 offset:20736
ds_read_b64_tr_b16 a[162:163], v144 offset:22016
v_mfma_f32_16x16x32_bf16 v[208:211], a[192:195], v[246:249], v[208:211]
s_add_u32 m0, s74, 1024
s_nop 0
buffer_load_dwordx4 v7, s[28:31], s76 offen lds
s_waitcnt lgkmcnt(6)
v_mfma_f32_32x32x16_bf16 v[48:63], a[196:199], a[16:19], v[48:63]
ds_read_b64_tr_b16 a[164:165], v146 offset:20480
ds_read_b64_tr_b16 a[166:167], v146 offset:21760
v_mfma_f32_16x16x32_bf16 v[212:215], a[196:199], v[246:249], v[212:215]
s_waitcnt lgkmcnt(6)
v_mfma_f32_32x32x16_bf16 v[64:79], a[200:203], a[16:19], v[64:79]
ds_read_b64_tr_b16 a[168:169], v146 offset:20544
ds_read_b64_tr_b16 a[170:171], v146 offset:21824
v_mfma_f32_16x16x32_bf16 v[216:219], a[200:203], v[246:249], v[216:219]
s_add_u32 m0, s74, 2048
s_nop 0
buffer_load_dwordx4 v8, s[28:31], s76 offen lds
buffer_load_dword v250, off, s[48:51], 0 sc1
s_waitcnt lgkmcnt(6)
v_mfma_f32_32x32x16_bf16 v[80:95], a[204:207], a[16:19], v[80:95]
ds_read_b64_tr_b16 a[172:173], v146 offset:20608
ds_read_b64_tr_b16 a[174:175], v146 offset:21888
v_mfma_f32_16x16x32_bf16 v[220:223], a[204:207], v[246:249], v[220:223]
s_waitcnt lgkmcnt(6)
v_mfma_f32_32x32x16_bf16 v[96:111], a[160:163], a[16:19], v[96:111]
ds_read_b64_tr_b16 a[176:177], v146 offset:20672
ds_read_b64_tr_b16 a[178:179], v146 offset:21952
v_mfma_f32_16x16x32_bf16 v[224:227], a[160:163], v[246:249], v[224:227]
s_add_u32 m0, s74, 3072
s_nop 0
buffer_load_dwordx4 v9, s[28:31], s76 offen lds
s_waitcnt lgkmcnt(6)
v_mfma_f32_32x32x16_bf16 v[32:47], a[164:167], a[20:23], v[32:47]
ds_read_b64_tr_b16 a[180:181], v146 offset:20736
ds_read_b64_tr_b16 a[182:183], v146 offset:22016
ds_read_b128 a[32:35], v16 offset:8192
ds_read_b128 a[36:39], v17 offset:8192
ds_read_b128 a[40:43], v18 offset:8192
ds_read_b128 a[44:47], v19 offset:8192
ds_read_b128 v[160:163], v16 offset:8192
ds_read_b128 v[164:167], v17 offset:8192
ds_read_b128 v[168:171], v18 offset:8192
ds_read_b128 v[172:175], v19 offset:8192
s_waitcnt lgkmcnt(14)
v_mfma_f32_32x32x16_bf16 v[48:63], a[168:171], a[20:23], v[48:63]
ds_read_b64_tr_b16 a[184:185], v148 offset:20480
ds_read_b64_tr_b16 a[186:187], v148 offset:21760
s_add_u32 m0, s74, 4096
s_nop 0
buffer_load_dwordx4 v10, s[28:31], s76 offen lds
s_add_u32 s76, s76, 245760
s_sub_u32 s87, s76, 2457600
s_cmp_ge_u32 s76, 2457600
s_cselect_b32 s76, s87, s76
s_waitcnt lgkmcnt(14)
v_mfma_f32_32x32x16_bf16 v[64:79], a[172:175], a[20:23], v[64:79]
ds_read_b64_tr_b16 a[188:189], v148 offset:20544
ds_read_b64_tr_b16 a[190:191], v148 offset:21824
s_waitcnt lgkmcnt(14)
v_mfma_f32_32x32x16_bf16 v[80:95], a[176:179], a[20:23], v[80:95]
ds_read_b64_tr_b16 a[192:193], v148 offset:20608
ds_read_b64_tr_b16 a[194:195], v148 offset:21888
s_waitcnt lgkmcnt(14)
v_mfma_f32_32x32x16_bf16 v[96:111], a[180:183], a[20:23], v[96:111]
ds_read_b64_tr_b16 a[196:197], v148 offset:20672
ds_read_b64_tr_b16 a[198:199], v148 offset:21952
s_waitcnt lgkmcnt(8)
v_dot2c_f32_bf16 v20, s65, v160
v_dot2c_f32_bf16 v24, v160, v160
v_dot2c_f32_bf16 v21, s65, v161
v_dot2c_f32_bf16 v25, v161, v161
v_dot2c_f32_bf16 v14, s65, v162
v_dot2c_f32_bf16 v192, v162, v162
v_dot2c_f32_bf16 v15, s65, v163
v_dot2c_f32_bf16 v193, v163, v163
v_dot2c_f32_bf16 v20, s65, v164
v_dot2c_f32_bf16 v24, v164, v164
v_dot2c_f32_bf16 v21, s65, v165
v_dot2c_f32_bf16 v25, v165, v165
v_dot2c_f32_bf16 v14, s65, v166
v_dot2c_f32_bf16 v192, v166, v166
v_dot2c_f32_bf16 v15, s65, v167
v_dot2c_f32_bf16 v193, v167, v167
v_dot2c_f32_bf16 v20, s65, v168
v_dot2c_f32_bf16 v24, v168, v168
v_dot2c_f32_bf16 v21, s65, v169
v_dot2c_f32_bf16 v25, v169, v169
v_dot2c_f32_bf16 v14, s65, v170
v_dot2c_f32_bf16 v192, v170, v170
v_dot2c_f32_bf16 v15, s65, v171
v_dot2c_f32_bf16 v193, v171, v171
v_dot2c_f32_bf16 v20, s65, v172
v_dot2c_f32_bf16 v24, v172, v172
v_dot2c_f32_bf16 v21, s65, v173
v_dot2c_f32_bf16 v25, v173, v173
v_dot2c_f32_bf16 v14, s65, v174
v_dot2c_f32_bf16 v192, v174, v174
v_dot2c_f32_bf16 v15, s65, v175
v_dot2c_f32_bf16 v193, v175, v175
s_waitcnt lgkmcnt(6)
v_mfma_f32_32x32x16_bf16 v[32:47], a[184:187], a[24:27], v[32:47]
ds_read_b64_tr_b16 a[200:201], v148 offset:20736
ds_read_b64_tr_b16 a[202:203], v148 offset:22016
s_waitcnt lgkmcnt(6)
v_mfma_f32_32x32x16_bf16 v[48:63], a[188:191], a[24:27], v[48:63]
ds_read_b64_tr_b16 a[204:205], v150 offset:20480
ds_read_b64_tr_b16 a[206:207], v150 offset:21760
s_add_u32 s60, s70, s86
s_add_u32 m0, s88, 8192
s_nop 0
buffer_load_dwordx4 v22, s[24:27], s60 offen lds
s_waitcnt lgkmcnt(6)
v_mfma_f32_32x32x16_bf16 v[64:79], a[192:195], a[24:27], v[64:79]
ds_read_b64_tr_b16 a[160:161], v150 offset:20544
ds_read_b64_tr_b16 a[162:163], v150 offset:21824
s_waitcnt lgkmcnt(6)
v_mfma_f32_32x32x16_bf16 v[80:95], a[196:199], a[24:27], v[80:95]
ds_read_b64_tr_b16 a[164:165], v150 offset:20608
ds_read_b64_tr_b16 a[166:167], v150 offset:21888
s_add_u32 s60, s70, s86
s_add_u32 m0, s88, 9216
s_nop 0
buffer_load_dwordx4 v23, s[24:27], s60 offen lds
s_waitcnt lgkmcnt(6)
v_mfma_f32_32x32x16_bf16 v[96:111], a[200:203], a[24:27], v[96:111]
ds_read_b64_tr_b16 a[168:169], v150 offset:20672
ds_read_b64_tr_b16 a[170:171], v150 offset:21952
s_waitcnt lgkmcnt(6)
v_mfma_f32_32x32x16_bf16 v[32:47], a[204:207], a[28:31], v[32:47]
ds_read_b64_tr_b16 a[172:173], v150 offset:20736
ds_read_b64_tr_b16 a[174:175], v150 offset:22016
s_add_u32 s60, s70, s86
s_add_u32 m0, s88, 10240
s_nop 0
buffer_load_dwordx4 v26, s[24:27], s60 offen lds
s_waitcnt lgkmcnt(6)
v_mfma_f32_32x32x16_bf16 v[48:63], a[160:163], a[28:31], v[48:63]
s_waitcnt lgkmcnt(4)
v_mfma_f32_32x32x16_bf16 v[64:79], a[164:167], a[28:31], v[64:79]
s_waitcnt lgkmcnt(0)
s_waitcnt vmcnt(24)
s_barrier
ds_read_b64_tr_b16 a[176:177], v144 offset:40960
ds_read_b64_tr_b16 a[178:179], v144 offset:42240
ds_read_b64_tr_b16 a[180:181], v144 offset:41024
ds_read_b64_tr_b16 a[182:183], v144 offset:42304
s_add_u32 s60, s70, s86
s_add_u32 m0, s88, 11264
s_nop 0
buffer_load_dwordx4 v27, s[24:27], s60 offen lds
s_add_u32 s86, s86, 128
s_cmp_ge_u32 s86, 1280
s_cselect_b32 s86, 0, s86
v_mfma_f32_32x32x16_bf16 v[80:95], a[168:171], a[28:31], v[80:95]
ds_read_b64_tr_b16 a[184:185], v144 offset:41088
ds_read_b64_tr_b16 a[186:187], v144 offset:42368
s_add_u32 m0, s74, 20480
s_nop 0
buffer_load_dwordx4 v6, s[28:31], s76 offen lds
v_mfma_f32_32x32x16_bf16 v[96:111], a[172:175], a[28:31], v[96:111]
ds_read_b64_tr_b16 a[188:189], v144 offset:41152
ds_read_b64_tr_b16 a[190:191], v144 offset:42432
s_waitcnt lgkmcnt(6)
v_mfma_f32_32x32x16_bf16 v[32:47], a[176:179], a[32:35], v[32:47]
ds_read_b64_tr_b16 a[192:193], v144 offset:41216
ds_read_b64_tr_b16 a[194:195], v144 offset:42496
v_mfma_f32_16x16x32_bf16 v[208:211], a[176:179], v[246:249], v[208:211]
s_add_u32 m0, s74, 21504
s_nop 0
buffer_load_dwordx4 v7, s[28:31], s76 offen lds
s_waitcnt lgkmcnt(6)
v_mfma_f32_32x32x16_bf16 v[48:63], a[180:183], a[32:35], v[48:63]
ds_read_b64_tr_b16 a[196:197], v146 offset:40960
ds_read_b64_tr_b16 a[198:199], v146 offset:42240
v_mfma_f32_16x16x32_bf16 v[212:215], a[180:183], v[246:249], v[212:215]
s_waitcnt lgkmcnt(6)
v_mfma_f32_32x32x16_bf16 v[64:79], a[184:187], a[32:35], v[64:79]
ds_read_b64_tr_b16 a[200:201], v146 offset:41024
ds_read_b64_tr_b16 a[202:203], v146 offset:42304
v_mfma_f32_16x16x32_bf16 v[216:219], a[184:187], v[246:249], v[216:219]
s_add_u32 m0, s74, 22528
s_nop 0
buffer_load_dwordx4 v8, s[28:31], s76 offen lds
s_waitcnt vmcnt(9)
L_ng_A:
v_readfirstlane_b32 s84, v250
s_cmp_lg_u32 s84, 0
s_cbranch_scc1 L_ngok_A
s_sub_u32 s7, s7, 1
s_cbranch_scc1 L_ngok_A
s_sleep 2
buffer_load_dword v250, off, s[48:51], 0 sc1
s_waitcnt vmcnt(0)
s_branch L_ng_A
L_ngok_A:
s_waitcnt lgkmcnt(6)
v_mfma_f32_32x32x16_bf16 v[80:95], a[188:191], a[32:35], v[80:95]
ds_read_b64_tr_b16 a[204:205], v146 offset:41088
ds_read_b64_tr_b16 a[206:207], v146 offset:42368
v_mfma_f32_16x16x32_bf16 v[220:223], a[188:191], v[246:249], v[220:223]
s_waitcnt lgkmcnt(6)
v_mfma_f32_32x32x16_bf16 v[96:111], a[192:195], a[32:35], v[96:111]
ds_read_b64_tr_b16 a[160:161], v146 offset:41152
ds_read_b64_tr_b16 a[162:163], v146 offset:42432
v_mfma_f32_16x16x32_bf16 v[224:227], a[192:195], v[246:249], v[224:227]
s_add_u32 m0, s74, 23552
s_nop 0
buffer_load_dwordx4 v9, s[28:31], s76 offen lds
s_waitcnt lgkmcnt(6)
v_mfma_f32_32x32x16_bf16 v[32:47], a[196:199], a[36:39], v[32:47]
ds_read_b64_tr_b16 a[164:165], v146 offset:41216
ds_read_b64_tr_b16 a[166:167], v146 offset:42496
ds_read_b128 a[48:51], v16 offset:0
ds_read_b128 a[52:55], v17 offset:0
ds_read_b128 a[56:59], v18 offset:0
ds_read_b128 a[60:63], v19 offset:0
ds_read_b128 v[176:179], v16 offset:0
ds_read_b128 v[180:183], v17 offset:0
ds_read_b128 v[184:187], v18 offset:0
ds_read_b128 v[188:191], v19 offset:0
s_waitcnt lgkmcnt(14)
v_mfma_f32_32x32x16_bf16 v[48:63], a[200:203], a[36:39], v[48:63]
ds_read_b64_tr_b16 a[168:169], v148 offset:40960
ds_read_b64_tr_b16 a[170:171], v148 offset:42240
s_add_u32 m0, s74, 24576
s_nop 0
buffer_load_dwordx4 v10, s[28:31], s76 offen lds
s_add_u32 s76, s76, 245760
s_sub_u32 s87, s76, 2457600
s_cmp_ge_u32 s76, 2457600
s_cselect_b32 s76, s87, s76
s_waitcnt lgkmcnt(14)
v_mfma_f32_32x32x16_bf16 v[64:79], a[204:207], a[36:39], v[64:79]
ds_read_b64_tr_b16 a[172:173], v148 offset:41024
ds_read_b64_tr_b16 a[174:175], v148 offset:42304
s_waitcnt lgkmcnt(14)
v_mfma_f32_32x32x16_bf16 v[80:95], a[160:163], a[36:39], v[80:95]
ds_read_b64_tr_b16 a[176:177], v148 offset:41088
ds_read_b64_tr_b16 a[178:179], v148 offset:42368
s_waitcnt lgkmcnt(14)
v_mfma_f32_32x32x16_bf16 v[96:111], a[164:167], a[36:39], v[96:111]
ds_read_b64_tr_b16 a[180:181], v148 offset:41152
ds_read_b64_tr_b16 a[182:183], v148 offset:42432
s_waitcnt lgkmcnt(8)
v_dot2c_f32_bf16 v20, s65, v176
v_dot2c_f32_bf16 v24, v176, v176
v_dot2c_f32_bf16 v21, s65, v177
v_dot2c_f32_bf16 v25, v177, v177
v_dot2c_f32_bf16 v14, s65, v178
v_dot2c_f32_bf16 v192, v178, v178
v_dot2c_f32_bf16 v15, s65, v179
v_dot2c_f32_bf16 v193, v179, v179
v_dot2c_f32_bf16 v20, s65, v180
v_dot2c_f32_bf16 v24, v180, v180
v_dot2c_f32_bf16 v21, s65, v181
v_dot2c_f32_bf16 v25, v181, v181
v_dot2c_f32_bf16 v14, s65, v182
v_dot2c_f32_bf16 v192, v182, v182
v_dot2c_f32_bf16 v15, s65, v183
v_dot2c_f32_bf16 v193, v183, v183
v_dot2c_f32_bf16 v20, s65, v184
v_dot2c_f32_bf16 v24, v184, v184
v_dot2c_f32_bf16 v21, s65, v185
v_dot2c_f32_bf16 v25, v185, v185
v_dot2c_f32_bf16 v14, s65, v186
v_dot2c_f32_bf16 v192, v186, v186
v_dot2c_f32_bf16 v15, s65, v187
v_dot2c_f32_bf16 v193, v187, v187
v_dot2c_f32_bf16 v20, s65, v188
v_dot2c_f32_bf16 v24, v188, v188
v_dot2c_f32_bf16 v21, s65, v189
v_dot2c_f32_bf16 v25, v189, v189
v_dot2c_f32_bf16 v14, s65, v190
v_dot2c_f32_bf16 v192, v190, v190
v_dot2c_f32_bf16 v15, s65, v191
v_dot2c_f32_bf16 v193, v191, v191
s_waitcnt lgkmcnt(6)
v_mfma_f32_32x32x16_bf16 v[32:47], a[168:171], a[40:43], v[32:47]
ds_read_b64_tr_b16 a[184:185], v148 offset:41216
ds_read_b64_tr_b16 a[186:187], v148 offset:42496
s_waitcnt lgkmcnt(6)
v_mfma_f32_32x32x16_bf16 v[48:63], a[172:175], a[40:43], v[48:63]
ds_read_b64_tr_b16 a[188:189], v150 offset:40960
ds_read_b64_tr_b16 a[190:191], v150 offset:42240
s_add_u32 s60, s70, s86
s_add_u32 m0, s88, 0
s_nop 0
buffer_load_dwordx4 v22, s[24:27], s60 offen lds
s_waitcnt lgkmcnt(6)
v_mfma_f32_32x32x16_bf16 v[64:79], a[176:179], a[40:43], v[64:79]
ds_read_b64_tr_b16 a[192:193], v150 offset:41024
ds_read_b64_tr_b16 a[194:195], v150 offset:42304
s_waitcnt lgkmcnt(6)
v_mfma_f32_32x32x16_bf16 v[80:95], a[180:183], a[40:43], v[80:95]
ds_read_b64_tr_b16 a[196:197], v150 offset:41088
ds_read_b64_tr_b16 a[198:199], v150 offset:42368
s_add_u32 s60, s70, s86
s_add_u32 m0, s88, 1024
s_nop 0
buffer_load_dwordx4 v23, s[24:27], s60 offen lds
s_waitcnt lgkmcnt(6)
v_mfma_f32_32x32x16_bf16 v[96:111], a[184:187], a[40:43], v[96:111]
ds_read_b64_tr_b16 a[200:201], v150 offset:41152
ds_read_b64_tr_b16 a[202:203], v150 offset:42432
s_waitcnt lgkmcnt(6)
v_mfma_f32_32x32x16_bf16 v[32:47], a[188:191], a[44:47], v[32:47]
ds_read_b64_tr_b16 a[204:205], v150 offset:41216
ds_read_b64_tr_b16 a[206:207], v150 offset:42496
s_add_u32 s60, s70, s86
s_add_u32 m0, s88, 2048
s_nop 0
buffer_load_dwordx4 v26, s[24:27], s60 offen lds
s_waitcnt lgkmcnt(6)
v_mfma_f32_32x32x16_bf16 v[48:63], a[192:195], a[44:47], v[48:63]
s_waitcnt lgkmcnt(4)
v_mfma_f32_32x32x16_bf16 v[64:79], a[196:199], a[44:47], v[64:79]
s_waitcnt lgkmcnt(0)
s_barrier
ds_read_b64_tr_b16 a[160:161], v145 offset:12288
ds_read_b64_tr_b16 a[162:163], v145 offset:13568
ds_read_b64_tr_b16 a[164:165], v145 offset:12352
ds_read_b64_tr_b16 a[166:167], v145 offset:13632
s_add_u32 s60, s70, s86
s_add_u32 m0, s88, 3072
s_nop 0
buffer_load_dwordx4 v27, s[24:27], s60 offen lds
s_add_u32 s86, s86, 128
s_cmp_ge_u32 s86, 1280
s_cselect_b32 s86, 0, s86
v_mfma_f32_32x32x16_bf16 v[80:95], a[200:203], a[44:47], v[80:95]
ds_read_b64_tr_b16 a[168:169], v145 offset:12416
ds_read_b64_tr_b16 a[170:171], v145 offset:13696
s_add_u32 m0, s74, 40960
s_nop 0
buffer_load_dwordx4 v6, s[28:31], s76 offen lds
v_mfma_f32_32x32x16_bf16 v[96:111], a[204:207], a[44:47], v[96:111]
ds_read_b64_tr_b16 a[172:173], v145 offset:12480
ds_read_b64_tr_b16 a[174:175], v145 offset:13760
s_waitcnt lgkmcnt(6)
v_mfma_f32_32x32x16_bf16 v[32:47], a[160:163], a[48:51], v[32:47]
ds_read_b64_tr_b16 a[176:177], v145 offset:12544
ds_read_b64_tr_b16 a[178:179], v145 offset:13824
v_mfma_f32_16x16x32_bf16 v[208:211], a[160:163], v[246:249], v[208:211]
s_add_u32 m0, s74, 41984
s_nop 0
buffer_load_dwordx4 v7, s[28:31], s76 offen lds
s_waitcnt lgkmcnt(6)
v_mfma_f32_32x32x16_bf16 v[48:63], a[164:167], a[48:51], v[48:63]
ds_read_b64_tr_b16 a[180:181], v147 offset:12288
ds_read_b64_tr_b16 a[182:183], v147 offset:13568
v_mfma_f32_16x16x32_bf16 v[212:215], a[164:167], v[246:249], v[212:215]
s_waitcnt lgkmcnt(6)
v_mfma_f32_32x32x16_bf16 v[64:79], a[168:171], a[48:51], v[64:79]
ds_read_b64_tr_b16 a[184:185], v147 offset:12352
ds_read_b64_tr_b16 a[186:187], v147 offset:13632
v_mfma_f32_16x16x32_bf16 v[216:219], a[168:171], v[246:249], v[216:219]
s_add_u32 m0, s74, 43008
s_nop 0
buffer_load_dwordx4 v8, s[28:31], s76 offen lds
s_lshr_b32 s60, s56, 1
s_and_b32 s61, s56, 1
s_mul_i32 s62, s61, 5
v_add_u32_e64 v198, 0, v1
v_mul_u32_u24 v199, 13108, v198
v_lshrrev_b32 v199, 16, v199
v_mul_u32_u24 v200, 5, v199
v_sub_u32 v200, v198, v200
v_lshrrev_b32 v201, 2, v199
v_add_u32 v201, s62, v201
v_and_b32 v202, 1, v201
v_lshlrev_b32 v202, 2, v202
v_and_b32 v199, 3, v199
v_add_u32 v202, v202, v199
v_lshrrev_b32 v201, 1, v201
v_cmp_gt_u32 vcc, 4, v200
v_mov_b32 v199, 6
v_mov_b32 v203, s61
v_cndmask_b32 v199, v199, v203, vcc
v_add_u32 v201, v201, v199
v_cndmask_b32 v200, v203, v200, vcc
v_lshlrev_b32_e64 v201, 10, v201
v_lshl_add_u32 v201, v200, 7, v201
v_lshl_add_u32 v201, v202, 1, v201
s_mul_i32 s63, s60, 576
s_add_u32 s63, s63, 147456
v_add_u32_e64 v201, s63, v201
ds_write_b16 v201, v194
ds_write_b16_d16_hi v201, v194 offset:16
ds_write_b16 v201, v195 offset:32
ds_write_b16_d16_hi v201, v195 offset:48
v_add_u32_e64 v198, 64, v1
v_mul_u32_u24 v199, 13108, v198
v_lshrrev_b32 v199, 16, v199
v_mul_u32_u24 v200, 5, v199
v_sub_u32 v200, v198, v200
v_lshrrev_b32 v201, 2, v199
v_add_u32 v201, s62, v201
v_and_b32 v202, 1, v201
v_lshlrev_b32 v202, 2, v202
v_and_b32 v199, 3, v199
v_add_u32 v202, v202, v199
v_lshrrev_b32 v201, 1, v201
v_cmp_gt_u32 vcc, 4, v200
v_mov_b32 v199, 6
v_mov_b32 v203, s61
v_cndmask_b32 v199, v199, v203, vcc
v_add_u32 v201, v201, v199
v_cndmask_b32 v200, v203, v200, vcc
v_lshlrev_b32_e64 v201, 10, v201
v_lshl_add_u32 v201, v200, 7, v201
v_lshl_add_u32 v201, v202, 1, v201
s_mul_i32 s63, s60, 576
s_add_u32 s63, s63, 147456
v_add_u32_e64 v201, s63, v201
v_cmp_gt_u32 vcc, 100, v198
v_mov_b32 v199, 158976
s_nop 0
v_cndmask_b32 v201, v199, v201, vcc
ds_write_b16 v201, v196
ds_write_b16_d16_hi v201, v196 offset:16
ds_write_b16 v201, v197 offset:32
ds_write_b16_d16_hi v201, v197 offset:48
s_waitcnt lgkmcnt(14)
v_mfma_f32_32x32x16_bf16 v[80:95], a[172:175], a[48:51], v[80:95]
ds_read_b64_tr_b16 a[188:189], v147 offset:12416
ds_read_b64_tr_b16 a[190:191], v147 offset:13696
v_mfma_f32_16x16x32_bf16 v[220:223], a[172:175], v[246:249], v[220:223]
s_waitcnt lgkmcnt(14)
v_mfma_f32_32x32x16_bf16 v[96:111], a[176:179], a[48:51], v[96:111]
ds_read_b64_tr_b16 a[192:193], v147 offset:12480
ds_read_b64_tr_b16 a[194:195], v147 offset:13760
v_mfma_f32_16x16x32_bf16 v[224:227], a[176:179], v[246:249], v[224:227]
s_add_u32 m0, s74, 44032
s_nop 0
buffer_load_dwordx4 v9, s[28:31], s76 offen lds
s_waitcnt lgkmcnt(14)
v_mfma_f32_32x32x16_bf16 v[32:47], a[180:183], a[52:55], v[32:47]
ds_read_b64_tr_b16 a[196:197], v147 offset:12544
ds_read_b64_tr_b16 a[198:199], v147 offset:13824
ds_read_b128 a[64:67], v16 offset:4096
ds_read_b128 a[68:71], v17 offset:4096
ds_read_b128 a[72:75], v18 offset:4096
ds_read_b128 a[76:79], v19 offset:4096
ds_read_b128 v[160:163], v16 offset:4096
ds_read_b128 v[164:167], v17 offset:4096
ds_read_b128 v[168:171], v18 offset:4096
ds_read_b128 v[172:175], v19 offset:4096
s_waitcnt lgkmcnt(15)
v_mfma_f32_32x32x16_bf16 v[48:63], a[184:187], a[52:55], v[48:63]
ds_read_b64_tr_b16 a[200:201], v149 offset:12288
ds_read_b64_tr_b16 a[202:203], v149 offset:13568
s_add_u32 m0, s74, 45056
s_nop 0
buffer_load_dwordx4 v10, s[28:31], s76 offen lds
s_add_u32 s76, s76, 245760
s_sub_u32 s87, s76, 2457600
s_cmp_ge_u32 s76, 2457600
s_cselect_b32 s76, s87, s76
s_waitcnt lgkmcnt(14)
v_mfma_f32_32x32x16_bf16 v[64:79], a[188:191], a[52:55], v[64:79]
ds_read_b64_tr_b16 a[204:205], v149 offset:12352
ds_read_b64_tr_b16 a[206:207], v149 offset:13632
s_waitcnt lgkmcnt(14)
v_mfma_f32_32x32x16_bf16 v[80:95], a[192:195], a[52:55], v[80:95]
ds_read_b64_tr_b16 a[160:161], v149 offset:12416
ds_read_b64_tr_b16 a[162:163], v149 offset:13696
s_waitcnt lgkmcnt(14)
v_mfma_f32_32x32x16_bf16 v[96:111], a[196:199], a[52:55], v[96:111]
ds_read_b64_tr_b16 a[164:165], v149 offset:12480
ds_read_b64_tr_b16 a[166:167], v149 offset:13760
s_waitcnt lgkmcnt(8)
v_dot2c_f32_bf16 v20, s65, v160
v_dot2c_f32_bf16 v24, v160, v160
v_dot2c_f32_bf16 v21, s65, v161
v_dot2c_f32_bf16 v25, v161, v161
v_dot2c_f32_bf16 v14, s65, v162
v_dot2c_f32_bf16 v192, v162, v162
v_dot2c_f32_bf16 v15, s65, v163
v_dot2c_f32_bf16 v193, v163, v163
v_dot2c_f32_bf16 v20, s65, v164
v_dot2c_f32_bf16 v24, v164, v164
v_dot2c_f32_bf16 v21, s65, v165
v_dot2c_f32_bf16 v25, v165, v165
v_dot2c_f32_bf16 v14, s65, v166
v_dot2c_f32_bf16 v192, v166, v166
v_dot2c_f32_bf16 v15, s65, v167
v_dot2c_f32_bf16 v193, v167, v167
v_dot2c_f32_bf16 v20, s65, v168
v_dot2c_f32_bf16 v24, v168, v168
v_dot2c_f32_bf16 v21, s65, v169
v_dot2c_f32_bf16 v25, v169, v169
v_dot2c_f32_bf16 v14, s65, v170
v_dot2c_f32_bf16 v192, v170, v170
v_dot2c_f32_bf16 v15, s65, v171
v_dot2c_f32_bf16 v193, v171, v171
v_dot2c_f32_bf16 v20, s65, v172
v_dot2c_f32_bf16 v24, v172, v172
v_dot2c_f32_bf16 v21, s65, v173
v_dot2c_f32_bf16 v25, v173, v173
v_dot2c_f32_bf16 v14, s65, v174
v_dot2c_f32_bf16 v192, v174, v174
v_dot2c_f32_bf16 v15, s65, v175
v_dot2c_f32_bf16 v193, v175, v175
s_waitcnt lgkmcnt(6)
v_mfma_f32_32x32x16_bf16 v[32:47], a[200:203], a[56:59], v[32:47]
ds_read_b64_tr_b16 a[168:169], v149 offset:12544
ds_read_b64_tr_b16 a[170:171], v149 offset:13824
s_waitcnt lgkmcnt(6)
v_mfma_f32_32x32x16_bf16 v[48:63], a[204:207], a[56:59], v[48:63]
ds_read_b64_tr_b16 a[172:173], v151 offset:12288
ds_read_b64_tr_b16 a[174:175], v151 offset:13568
s_add_u32 s60, s70, s86
s_add_u32 m0, s88, 4096
s_nop 0
buffer_load_dwordx4 v22, s[24:27], s60 offen lds
s_waitcnt lgkmcnt(6)
v_mfma_f32_32x32x16_bf16 v[64:79], a[160:163], a[56:59], v[64:79]
ds_read_b64_tr_b16 a[176:177], v151 offset:12352
ds_read_b64_tr_b16 a[178:179], v151 offset:13632
s_waitcnt lgkmcnt(6)
v_mfma_f32_32x32x16_bf16 v[80:95], a[164:167], a[56:59], v[80:95]
ds_read_b64_tr_b16 a[180:181], v151 offset:12416
ds_read_b64_tr_b16 a[182:183], v151 offset:13696
s_add_u32 s60, s70, s86
s_add_u32 m0, s88, 5120
s_nop 0
buffer_load_dwordx4 v23, s[24:27], s60 offen lds
s_waitcnt lgkmcnt(6)
v_mfma_f32_32x32x16_bf16 v[96:111], a[168:171], a[56:59], v[96:111]
ds_read_b64_tr_b16 a[184:185], v151 offset:12480
ds_read_b64_tr_b16 a[186:187], v151 offset:13760
s_waitcnt lgkmcnt(6)
v_mfma_f32_32x32x16_bf16 v[32:47], a[172:175], a[60:63], v[32:47]
ds_read_b64_tr_b16 a[188:189], v151 offset:12544
ds_read_b64_tr_b16 a[190:191], v151 offset:13824
s_add_u32 s60, s70, s86
s_add_u32 m0, s88, 6144
s_nop 0
buffer_load_dwordx4 v26, s[24:27], s60 offen lds
s_waitcnt lgkmcnt(6)
v_mfma_f32_32x32x16_bf16 v[48:63], a[176:179], a[60:63], v[48:63]
s_waitcnt lgkmcnt(4)
v_mfma_f32_32x32x16_bf16 v[64:79], a[180:183], a[60:63], v[64:79]
s_waitcnt lgkmcnt(0)
s_waitcnt vmcnt(21)
s_barrier
ds_read_b64_tr_b16 a[192:193], v144 offset:0
ds_read_b64_tr_b16 a[194:195], v144 offset:1280
ds_read_b64_tr_b16 a[196:197], v144 offset:64
ds_read_b64_tr_b16 a[198:199], v144 offset:1344
s_add_u32 s60, s70, s86
s_add_u32 m0, s88, 7168
s_nop 0
buffer_load_dwordx4 v27, s[24:27], s60 offen lds
s_add_u32 s86, s86, 128
s_cmp_ge_u32 s86, 1280
s_cselect_b32 s86, 0, s86
v_mfma_f32_32x32x16_bf16 v[80:95], a[184:187], a[60:63], v[80:95]
ds_read_b64_tr_b16 a[200:201], v144 offset:128
ds_read_b64_tr_b16 a[202:203], v144 offset:1408
s_add_u32 m0, s74, 61440
s_nop 0
buffer_load_dwordx4 v6, s[28:31], s76 offen lds
v_mfma_f32_32x32x16_bf16 v[96:111], a[188:191], a[60:63], v[96:111]
ds_read_b64_tr_b16 a[204:205], v144 offset:192
ds_read_b64_tr_b16 a[206:207], v144 offset:1472
s_waitcnt lgkmcnt(6)
v_mfma_f32_32x32x16_bf16 v[32:47], a[192:195], a[64:67], v[32:47]
ds_read_b64_tr_b16 a[160:161], v144 offset:256
ds_read_b64_tr_b16 a[162:163], v144 offset:1536
v_mfma_f32_16x16x32_bf16 v[208:211], a[192:195], v[246:249], v[208:211]
s_add_u32 m0, s74, 62464
s_nop 0
buffer_load_dwordx4 v7, s[28:31], s76 offen lds
s_waitcnt lgkmcnt(6)
v_mfma_f32_32x32x16_bf16 v[48:63], a[196:199], a[64:67], v[48:63]
ds_read_b64_tr_b16 a[164:165], v146 offset:0
ds_read_b64_tr_b16 a[166:167], v146 offset:1280
v_mfma_f32_16x16x32_bf16 v[212:215], a[196:199], v[246:249], v[212:215]
s_waitcnt lgkmcnt(6)
v_mfma_f32_32x32x16_bf16 v[64:79], a[200:203], a[64:67], v[64:79]
ds_read_b64_tr_b16 a[168:169], v146 offset:64
ds_read_b64_tr_b16 a[170:171], v146 offset:1344
v_mfma_f32_16x16x32_bf16 v[216:219], a[200:203], v[246:249], v[216:219]
s_add_u32 m0, s74, 63488
s_nop 0
buffer_load_dwordx4 v8, s[28:31], s76 offen lds
s_waitcnt lgkmcnt(6)
v_mfma_f32_32x32x16_bf16 v[80:95], a[204:207], a[64:67], v[80:95]
ds_read_b64_tr_b16 a[172:173], v146 offset:128
ds_read_b64_tr_b16 a[174:175], v146 offset:1408
v_mfma_f32_16x16x32_bf16 v[220:223], a[204:207], v[246:249], v[220:223]
s_waitcnt lgkmcnt(6)
v_mfma_f32_32x32x16_bf16 v[96:111], a[160:163], a[64:67], v[96:111]
ds_read_b64_tr_b16 a[176:177], v146 offset:192
ds_read_b64_tr_b16 a[178:179], v146 offset:1472
v_mfma_f32_16x16x32_bf16 v[224:227], a[160:163], v[246:249], v[224:227]
s_add_u32 m0, s74, 64512
s_nop 0
buffer_load_dwordx4 v9, s[28:31], s76 offen lds
s_waitcnt lgkmcnt(6)
v_mfma_f32_32x32x16_bf16 v[32:47], a[164:167], a[68:71], v[32:47]
ds_read_b64_tr_b16 a[180:181], v146 offset:256
ds_read_b64_tr_b16 a[182:183], v146 offset:1536
s_waitcnt vmcnt(22)
ds_read_b128 a[80:83], v16 offset:8192
ds_read_b128 a[84:87], v17 offset:8192
ds_read_b128 a[88:91], v18 offset:8192
ds_read_b128 a[92:95], v19 offset:8192
ds_read_b128 v[176:179], v16 offset:8192
ds_read_b128 v[180:183], v17 offset:8192
ds_read_b128 v[184:187], v18 offset:8192
ds_read_b128 v[188:191], v19 offset:8192
s_waitcnt lgkmcnt(14)
v_mfma_f32_32x32x16_bf16 v[48:63], a[168:171], a[68:71], v[48:63]
ds_read_b64_tr_b16 a[184:185], v148 offset:0
ds_read_b64_tr_b16 a[186:187], v148 offset:1280
s_add_u32 m0, s74, 65536
s_nop 0
buffer_load_dwordx4 v10, s[28:31], s76 offen lds
s_add_u32 s76, s76, 245760
s_sub_u32 s87, s76, 2457600
s_cmp_ge_u32 s76, 2457600
s_cselect_b32 s76, s87, s76
s_waitcnt lgkmcnt(14)
v_mfma_f32_32x32x16_bf16 v[64:79], a[172:175], a[68:71], v[64:79]
ds_read_b64_tr_b16 a[188:189], v148 offset:64
ds_read_b64_tr_b16 a[190:191], v148 offset:1344
s_waitcnt lgkmcnt(14)
v_mfma_f32_32x32x16_bf16 v[80:95], a[176:179], a[68:71], v[80:95]
ds_read_b64_tr_b16 a[192:193], v148 offset:128
ds_read_b64_tr_b16 a[194:195], v148 offset:1408
s_waitcnt lgkmcnt(14)
v_mfma_f32_32x32x16_bf16 v[96:111], a[180:183], a[68:71], v[96:111]
ds_read_b64_tr_b16 a[196:197], v148 offset:192
ds_read_b64_tr_b16 a[198:199], v148 offset:1472
s_waitcnt lgkmcnt(8)
v_dot2c_f32_bf16 v20, s65, v176
v_dot2c_f32_bf16 v24, v176, v176
v_dot2c_f32_bf16 v21, s65, v177
v_dot2c_f32_bf16 v25, v177, v177
v_dot2c_f32_bf16 v14, s65, v178
v_dot2c_f32_bf16 v192, v178, v178
v_dot2c_f32_bf16 v15, s65, v179
v_dot2c_f32_bf16 v193, v179, v179
v_dot2c_f32_bf16 v20, s65, v180
v_dot2c_f32_bf16 v24, v180, v180
v_dot2c_f32_bf16 v21, s65, v181
v_dot2c_f32_bf16 v25, v181, v181
v_dot2c_f32_bf16 v14, s65, v182
v_dot2c_f32_bf16 v192, v182, v182
v_dot2c_f32_bf16 v15, s65, v183
v_dot2c_f32_bf16 v193, v183, v183
v_dot2c_f32_bf16 v20, s65, v184
v_dot2c_f32_bf16 v24, v184, v184
v_dot2c_f32_bf16 v21, s65, v185
v_dot2c_f32_bf16 v25, v185, v185
v_dot2c_f32_bf16 v14, s65, v186
v_dot2c_f32_bf16 v192, v186, v186
v_dot2c_f32_bf16 v15, s65, v187
v_dot2c_f32_bf16 v193, v187, v187
v_dot2c_f32_bf16 v20, s65, v188
v_dot2c_f32_bf16 v24, v188, v188
v_dot2c_f32_bf16 v21, s65, v189
v_dot2c_f32_bf16 v25, v189, v189
v_dot2c_f32_bf16 v14, s65, v190
v_dot2c_f32_bf16 v192, v190, v190
v_dot2c_f32_bf16 v15, s65, v191
v_dot2c_f32_bf16 v193, v191, v191
s_waitcnt lgkmcnt(6)
v_mfma_f32_32x32x16_bf16 v[32:47], a[184:187], a[72:75], v[32:47]
ds_read_b64_tr_b16 a[200:201], v148 offset:256
ds_read_b64_tr_b16 a[202:203], v148 offset:1536
s_waitcnt lgkmcnt(6)
v_mfma_f32_32x32x16_bf16 v[48:63], a[188:191], a[72:75], v[48:63]
ds_read_b64_tr_b16 a[204:205], v150 offset:0
ds_read_b64_tr_b16 a[206:207], v150 offset:1280
s_add_u32 s60, s70, s86
s_add_u32 m0, s88, 8192
s_nop 0
buffer_load_dwordx4 v22, s[24:27], s60 offen lds
s_waitcnt lgkmcnt(6)
v_mfma_f32_32x32x16_bf16 v[64:79], a[192:195], a[72:75], v[64:79]
ds_read_b64_tr_b16 a[160:161], v150 offset:64
ds_read_b64_tr_b16 a[162:163], v150 offset:1344
s_waitcnt lgkmcnt(6)
v_mfma_f32_32x32x16_bf16 v[80:95], a[196:199], a[72:75], v[80:95]
ds_read_b64_tr_b16 a[164:165], v150 offset:128
ds_read_b64_tr_b16 a[166:167], v150 offset:1408
s_add_u32 s60, s70, s86
s_add_u32 m0, s88, 9216
s_nop 0
buffer_load_dwordx4 v23, s[24:27], s60 offen lds
s_waitcnt lgkmcnt(6)
v_mfma_f32_32x32x16_bf16 v[96:111], a[200:203], a[72:75], v[96:111]
ds_read_b64_tr_b16 a[168:169], v150 offset:192
ds_read_b64_tr_b16 a[170:171], v150 offset:1472
s_waitcnt lgkmcnt(6)
v_mfma_f32_32x32x16_bf16 v[32:47], a[204:207], a[76:79], v[32:47]
ds_read_b64_tr_b16 a[172:173], v150 offset:256
ds_read_b64_tr_b16 a[174:175], v150 offset:1536
s_add_u32 s60, s70, s86
s_add_u32 m0, s88, 10240
s_nop 0
buffer_load_dwordx4 v26, s[24:27], s60 offen lds
s_waitcnt lgkmcnt(6)
v_mfma_f32_32x32x16_bf16 v[48:63], a[160:163], a[76:79], v[48:63]
s_waitcnt lgkmcnt(4)
v_mfma_f32_32x32x16_bf16 v[64:79], a[164:167], a[76:79], v[64:79]
s_waitcnt lgkmcnt(0)
s_waitcnt vmcnt(21)
s_barrier
ds_read_b64_tr_b16 a[176:177], v144 offset:20480
ds_read_b64_tr_b16 a[178:179], v144 offset:21760
ds_read_b64_tr_b16 a[180:181], v144 offset:20544
ds_read_b64_tr_b16 a[182:183], v144 offset:21824
s_add_u32 s60, s70, s86
s_add_u32 m0, s88, 11264
s_nop 0
buffer_load_dwordx4 v27, s[24:27], s60 offen lds
s_add_u32 s86, s86, 128
s_cmp_ge_u32 s86, 1280
s_cselect_b32 s86, 0, s86
v_mfma_f32_32x32x16_bf16 v[80:95], a[168:171], a[76:79], v[80:95]
ds_read_b64_tr_b16 a[184:185], v144 offset:20608
ds_read_b64_tr_b16 a[186:187], v144 offset:21888
s_add_u32 m0, s74, 0
s_nop 0
buffer_load_dwordx4 v6, s[28:31], s76 offen lds
v_mfma_f32_32x32x16_bf16 v[96:111], a[172:175], a[76:79], v[96:111]
ds_read_b64_tr_b16 a[188:189], v144 offset:20672
ds_read_b64_tr_b16 a[190:191], v144 offset:21952
s_waitcnt lgkmcnt(6)
v_mfma_f32_32x32x16_bf16 v[32:47], a[176:179], a[80:83], v[32:47]
ds_read_b64_tr_b16 a[192:193], v144 offset:20736
ds_read_b64_tr_b16 a[194:195], v144 offset:22016
v_mfma_f32_16x16x32_bf16 v[208:211], a[176:179], v[246:249], v[208:211]
s_add_u32 m0, s74, 1024
s_nop 0
buffer_load_dwordx4 v7, s[28:31], s76 offen lds
s_waitcnt lgkmcnt(6)
v_mfma_f32_32x32x16_bf16 v[48:63], a[180:183], a[80:83], v[48:63]
ds_read_b64_tr_b16 a[196:197], v146 offset:20480
ds_read_b64_tr_b16 a[198:199], v146 offset:21760
v_mfma_f32_16x16x32_bf16 v[212:215], a[180:183], v[246:249], v[212:215]
s_waitcnt lgkmcnt(6)
v_mfma_f32_32x32x16_bf16 v[64:79], a[184:187], a[80:83], v[64:79]
ds_read_b64_tr_b16 a[200:201], v146 offset:20544
ds_read_b64_tr_b16 a[202:203], v146 offset:21824
v_mfma_f32_16x16x32_bf16 v[216:219], a[184:187], v[246:249], v[216:219]
s_add_u32 m0, s74, 2048
s_nop 0
buffer_load_dwordx4 v8, s[28:31], s76 offen lds
s_waitcnt lgkmcnt(6)
v_mfma_f32_32x32x16_bf16 v[80:95], a[188:191], a[80:83], v[80:95]
ds_read_b64_tr_b16 a[204:205], v146 offset:20608
ds_read_b64_tr_b16 a[206:207], v146 offset:21888
v_mfma_f32_16x16x32_bf16 v[220:223], a[188:191], v[246:249], v[220:223]
s_waitcnt lgkmcnt(6)
v_mfma_f32_32x32x16_bf16 v[96:111], a[192:195], a[80:83], v[96:111]
ds_read_b64_tr_b16 a[160:161], v146 offset:20672
ds_read_b64_tr_b16 a[162:163], v146 offset:21952
v_mfma_f32_16x16x32_bf16 v[224:227], a[192:195], v[246:249], v[224:227]
s_add_u32 m0, s74, 3072
s_nop 0
buffer_load_dwordx4 v9, s[28:31], s76 offen lds
s_waitcnt lgkmcnt(6)
v_mfma_f32_32x32x16_bf16 v[32:47], a[196:199], a[84:87], v[32:47]
ds_read_b64_tr_b16 a[164:165], v146 offset:20736
ds_read_b64_tr_b16 a[166:167], v146 offset:22016
s_waitcnt vmcnt(22)
ds_read_b128 a[96:99], v16 offset:0
ds_read_b128 a[100:103], v17 offset:0
ds_read_b128 a[104:107], v18 offset:0
ds_read_b128 a[108:111], v19 offset:0
ds_read_b128 v[160:163], v16 offset:0
ds_read_b128 v[164:167], v17 offset:0
ds_read_b128 v[168:171], v18 offset:0
ds_read_b128 v[172:175], v19 offset:0
s_waitcnt lgkmcnt(14)
v_mfma_f32_32x32x16_bf16 v[48:63], a[200:203], a[84:87], v[48:63]
ds_read_b64_tr_b16 a[168:169], v148 offset:20480
ds_read_b64_tr_b16 a[170:171], v148 offset:21760
s_add_u32 m0, s74, 4096
s_nop 0
buffer_load_dwordx4 v10, s[28:31], s76 offen lds
s_add_u32 s76, s76, 245760
s_sub_u32 s87, s76, 2457600
s_cmp_ge_u32 s76, 2457600
s_cselect_b32 s76, s87, s76
s_waitcnt lgkmcnt(14)
v_mfma_f32_32x32x16_bf16 v[64:79], a[204:207], a[84:87], v[64:79]
ds_read_b64_tr_b16 a[172:173], v148 offset:20544
ds_read_b64_tr_b16 a[174:175], v148 offset:21824
s_waitcnt lgkmcnt(14)
v_mfma_f32_32x32x16_bf16 v[80:95], a[160:163], a[84:87], v[80:95]
ds_read_b64_tr_b16 a[176:177], v148 offset:20608
ds_read_b64_tr_b16 a[178:179], v148 offset:21888
s_waitcnt lgkmcnt(14)
v_mfma_f32_32x32x16_bf16 v[96:111], a[164:167], a[84:87], v[96:111]
ds_read_b64_tr_b16 a[180:181], v148 offset:20672
ds_read_b64_tr_b16 a[182:183], v148 offset:21952
s_waitcnt lgkmcnt(8)
v_dot2c_f32_bf16 v20, s65, v160
v_dot2c_f32_bf16 v24, v160, v160
v_dot2c_f32_bf16 v21, s65, v161
v_dot2c_f32_bf16 v25, v161, v161
v_dot2c_f32_bf16 v14, s65, v162
v_dot2c_f32_bf16 v192, v162, v162
v_dot2c_f32_bf16 v15, s65, v163
v_dot2c_f32_bf16 v193, v163, v163
v_dot2c_f32_bf16 v20, s65, v164
v_dot2c_f32_bf16 v24, v164, v164
v_dot2c_f32_bf16 v21, s65, v165
v_dot2c_f32_bf16 v25, v165, v165
v_dot2c_f32_bf16 v14, s65, v166
v_dot2c_f32_bf16 v192, v166, v166
v_dot2c_f32_bf16 v15, s65, v167
v_dot2c_f32_bf16 v193, v167, v167
v_dot2c_f32_bf16 v20, s65, v168
v_dot2c_f32_bf16 v24, v168, v168
v_dot2c_f32_bf16 v21, s65, v169
v_dot2c_f32_bf16 v25, v169, v169
v_dot2c_f32_bf16 v14, s65, v170
v_dot2c_f32_bf16 v192, v170, v170
v_dot2c_f32_bf16 v15, s65, v171
v_dot2c_f32_bf16 v193, v171, v171
v_dot2c_f32_bf16 v20, s65, v172
v_dot2c_f32_bf16 v24, v172, v172
v_dot2c_f32_bf16 v21, s65, v173
v_dot2c_f32_bf16 v25, v173, v173
v_dot2c_f32_bf16 v14, s65, v174
v_dot2c_f32_bf16 v192, v174, v174
v_dot2c_f32_bf16 v15, s65, v175
v_dot2c_f32_bf16 v193, v175, v175
s_waitcnt lgkmcnt(6)
v_mfma_f32_32x32x16_bf16 v[32:47], a[168:171], a[88:91], v[32:47]
ds_read_b64_tr_b16 a[184:185], v148 offset:20736
ds_read_b64_tr_b16 a[186:187], v148 offset:22016
s_waitcnt lgkmcnt(6)
v_mfma_f32_32x32x16_bf16 v[48:63], a[172:175], a[88:91], v[48:63]
ds_read_b64_tr_b16 a[188:189], v150 offset:20480
ds_read_b64_tr_b16 a[190:191], v150 offset:21760
s_add_u32 s60, s70, s86
s_add_u32 m0, s88, 0
s_nop 0
buffer_load_dwordx4 v22, s[24:27], s60 offen lds
s_waitcnt lgkmcnt(6)
v_mfma_f32_32x32x16_bf16 v[64:79], a[176:179], a[88:91], v[64:79]
ds_read_b64_tr_b16 a[192:193], v150 offset:20544
ds_read_b64_tr_b16 a[194:195], v150 offset:21824
s_waitcnt lgkmcnt(6)
v_mfma_f32_32x32x16_bf16 v[80:95], a[180:183], a[88:91], v[80:95]
ds_read_b64_tr_b16 a[196:197], v150 offset:20608
ds_read_b64_tr_b16 a[198:199], v150 offset:21888
s_add_u32 s60, s70, s86
s_add_u32 m0, s88, 1024
s_nop 0
buffer_load_dwordx4 v23, s[24:27], s60 offen lds
s_waitcnt lgkmcnt(6)
v_mfma_f32_32x32x16_bf16 v[96:111], a[184:187], a[88:91], v[96:111]
ds_read_b64_tr_b16 a[200:201], v150 offset:20672
ds_read_b64_tr_b16 a[202:203], v150 offset:21952
s_waitcnt lgkmcnt(6)
v_mfma_f32_32x32x16_bf16 v[32:47], a[188:191], a[92:95], v[32:47]
ds_read_b64_tr_b16 a[204:205], v150 offset:20736
ds_read_b64_tr_b16 a[206:207], v150 offset:22016
s_add_u32 s60, s70, s86
s_add_u32 m0, s88, 2048
s_nop 0
buffer_load_dwordx4 v26, s[24:27], s60 offen lds
s_waitcnt lgkmcnt(6)
v_mfma_f32_32x32x16_bf16 v[48:63], a[192:195], a[92:95], v[48:63]
s_waitcnt lgkmcnt(4)
v_mfma_f32_32x32x16_bf16 v[64:79], a[196:199], a[92:95], v[64:79]
s_waitcnt lgkmcnt(0)
s_waitcnt vmcnt(21)
s_barrier
ds_read_b64_tr_b16 a[160:161], v144 offset:40960
ds_read_b64_tr_b16 a[162:163], v144 offset:42240
ds_read_b64_tr_b16 a[164:165], v144 offset:41024
ds_read_b64_tr_b16 a[166:167], v144 offset:42304
s_add_u32 s60, s70, s86
s_add_u32 m0, s88, 3072
s_nop 0
buffer_load_dwordx4 v27, s[24:27], s60 offen lds
v_mfma_f32_32x32x16_bf16 v[80:95], a[200:203], a[92:95], v[80:95]
ds_read_b64_tr_b16 a[168:169], v144 offset:41088
ds_read_b64_tr_b16 a[170:171], v144 offset:42368
s_add_u32 m0, s74, 20480
s_nop 0
buffer_load_dwordx4 v6, s[28:31], s76 offen lds
v_mfma_f32_32x32x16_bf16 v[96:111], a[204:207], a[92:95], v[96:111]
ds_read_b64_tr_b16 a[172:173], v144 offset:41152
ds_read_b64_tr_b16 a[174:175], v144 offset:42432
s_waitcnt lgkmcnt(6)
v_mfma_f32_32x32x16_bf16 v[32:47], a[160:163], a[96:99], v[32:47]
ds_read_b64_tr_b16 a[176:177], v144 offset:41216
ds_read_b64_tr_b16 a[178:179], v144 offset:42496
v_mfma_f32_16x16x32_bf16 v[208:211], a[160:163], v[246:249], v[208:211]
s_add_u32 m0, s74, 21504
s_nop 0
buffer_load_dwordx4 v7, s[28:31], s76 offen lds
s_waitcnt lgkmcnt(6)
v_mfma_f32_32x32x16_bf16 v[48:63], a[164:167], a[96:99], v[48:63]
ds_read_b64_tr_b16 a[180:181], v146 offset:40960
ds_read_b64_tr_b16 a[182:183], v146 offset:42240
v_mfma_f32_16x16x32_bf16 v[212:215], a[164:167], v[246:249], v[212:215]
s_waitcnt lgkmcnt(6)
v_mfma_f32_32x32x16_bf16 v[64:79], a[168:171], a[96:99], v[64:79]
ds_read_b64_tr_b16 a[184:185], v146 offset:41024
ds_read_b64_tr_b16 a[186:187], v146 offset:42304
v_mfma_f32_16x16x32_bf16 v[216:219], a[168:171], v[246:249], v[216:219]
s_add_u32 m0, s74, 22528
s_nop 0
buffer_load_dwordx4 v8, s[28:31], s76 offen lds
s_waitcnt lgkmcnt(6)
v_mfma_f32_32x32x16_bf16 v[80:95], a[172:175], a[96:99], v[80:95]
ds_read_b64_tr_b16 a[188:189], v146 offset:41088
ds_read_b64_tr_b16 a[190:191], v146 offset:42368
v_mfma_f32_16x16x32_bf16 v[220:223], a[172:175], v[246:249], v[220:223]
s_waitcnt lgkmcnt(6)
v_mfma_f32_32x32x16_bf16 v[96:111], a[176:179], a[96:99], v[96:111]
ds_read_b64_tr_b16 a[192:193], v146 offset:41152
ds_read_b64_tr_b16 a[194:195], v146 offset:42432
v_mfma_f32_16x16x32_bf16 v[224:227], a[176:179], v[246:249], v[224:227]
s_add_u32 m0, s74, 23552
s_nop 0
buffer_load_dwordx4 v9, s[28:31], s76 offen lds
s_waitcnt lgkmcnt(6)
v_mfma_f32_32x32x16_bf16 v[32:47], a[180:183], a[100:103], v[32:47]
ds_read_b64_tr_b16 a[196:197], v146 offset:41216
ds_read_b64_tr_b16 a[198:199], v146 offset:42496
s_waitcnt vmcnt(22)
ds_read_b128 a[112:115], v16 offset:4096
ds_read_b128 a[116:119], v17 offset:4096
ds_read_b128 a[120:123], v18 offset:4096
ds_read_b128 a[124:127], v19 offset:4096
ds_read_b128 v[176:179], v16 offset:4096
ds_read_b128 v[180:183], v17 offset:4096
ds_read_b128 v[184:187], v18 offset:4096
ds_read_b128 v[188:191], v19 offset:4096
s_waitcnt lgkmcnt(14)
v_mfma_f32_32x32x16_bf16 v[48:63], a[184:187], a[100:103], v[48:63]
ds_read_b64_tr_b16 a[200:201], v148 offset:40960
ds_read_b64_tr_b16 a[202:203], v148 offset:42240
s_add_u32 m0, s74, 24576
s_nop 0
buffer_load_dwordx4 v10, s[28:31], s76 offen lds
s_add_u32 s76, s76, 245760
s_sub_u32 s87, s76, 2457600
s_cmp_ge_u32 s76, 2457600
s_cselect_b32 s76, s87, s76
s_waitcnt lgkmcnt(14)
v_mfma_f32_32x32x16_bf16 v[64:79], a[188:191], a[100:103], v[64:79]
ds_read_b64_tr_b16 a[204:205], v148 offset:41024
ds_read_b64_tr_b16 a[206:207], v148 offset:42304
s_waitcnt lgkmcnt(14)
v_mfma_f32_32x32x16_bf16 v[80:95], a[192:195], a[100:103], v[80:95]
ds_read_b64_tr_b16 a[160:161], v148 offset:41088
ds_read_b64_tr_b16 a[162:163], v148 offset:42368
s_waitcnt lgkmcnt(14)
v_mfma_f32_32x32x16_bf16 v[96:111], a[196:199], a[100:103], v[96:111]
ds_read_b64_tr_b16 a[164:165], v148 offset:41152
ds_read_b64_tr_b16 a[166:167], v148 offset:42432
s_waitcnt lgkmcnt(8)
v_dot2c_f32_bf16 v20, s65, v176
v_dot2c_f32_bf16 v24, v176, v176
v_dot2c_f32_bf16 v21, s65, v177
v_dot2c_f32_bf16 v25, v177, v177
v_dot2c_f32_bf16 v14, s65, v178
v_dot2c_f32_bf16 v192, v178, v178
v_dot2c_f32_bf16 v15, s65, v179
v_dot2c_f32_bf16 v193, v179, v179
v_dot2c_f32_bf16 v20, s65, v180
v_dot2c_f32_bf16 v24, v180, v180
v_dot2c_f32_bf16 v21, s65, v181
v_dot2c_f32_bf16 v25, v181, v181
v_dot2c_f32_bf16 v14, s65, v182
v_dot2c_f32_bf16 v192, v182, v182
v_dot2c_f32_bf16 v15, s65, v183
v_dot2c_f32_bf16 v193, v183, v183
v_dot2c_f32_bf16 v20, s65, v184
v_dot2c_f32_bf16 v24, v184, v184
v_dot2c_f32_bf16 v21, s65, v185
v_dot2c_f32_bf16 v25, v185, v185
v_dot2c_f32_bf16 v14, s65, v186
v_dot2c_f32_bf16 v192, v186, v186
v_dot2c_f32_bf16 v15, s65, v187
v_dot2c_f32_bf16 v193, v187, v187
v_dot2c_f32_bf16 v20, s65, v188
v_dot2c_f32_bf16 v24, v188, v188
v_dot2c_f32_bf16 v21, s65, v189
v_dot2c_f32_bf16 v25, v189, v189
v_dot2c_f32_bf16 v14, s65, v190
v_dot2c_f32_bf16 v192, v190, v190
v_dot2c_f32_bf16 v15, s65, v191
v_dot2c_f32_bf16 v193, v191, v191
s_waitcnt lgkmcnt(6)
v_mfma_f32_32x32x16_bf16 v[32:47], a[200:203], a[104:107], v[32:47]
ds_read_b64_tr_b16 a[168:169], v148 offset:41216
ds_read_b64_tr_b16 a[170:171], v148 offset:42496
s_waitcnt lgkmcnt(6)
v_mfma_f32_32x32x16_bf16 v[48:63], a[204:207], a[104:107], v[48:63]
ds_read_b64_tr_b16 a[172:173], v150 offset:40960
ds_read_b64_tr_b16 a[174:175], v150 offset:42240
s_waitcnt lgkmcnt(6)
v_mfma_f32_32x32x16_bf16 v[64:79], a[160:163], a[104:107], v[64:79]
ds_read_b64_tr_b16 a[176:177], v150 offset:41024
ds_read_b64_tr_b16 a[178:179], v150 offset:42304
s_waitcnt lgkmcnt(6)
v_mfma_f32_32x32x16_bf16 v[80:95], a[164:167], a[104:107], v[80:95]
ds_read_b64_tr_b16 a[180:181], v150 offset:41088
ds_read_b64_tr_b16 a[182:183], v150 offset:42368
s_waitcnt lgkmcnt(6)
v_mfma_f32_32x32x16_bf16 v[96:111], a[168:171], a[104:107], v[96:111]
ds_read_b64_tr_b16 a[184:185], v150 offset:41152
ds_read_b64_tr_b16 a[186:187], v150 offset:42432
s_waitcnt lgkmcnt(6)
v_mfma_f32_32x32x16_bf16 v[32:47], a[172:175], a[108:111], v[32:47]
ds_read_b64_tr_b16 a[188:189], v150 offset:41216
ds_read_b64_tr_b16 a[190:191], v150 offset:42496
s_waitcnt lgkmcnt(6)
v_mfma_f32_32x32x16_bf16 v[48:63], a[176:179], a[108:111], v[48:63]
s_waitcnt lgkmcnt(4)
v_mfma_f32_32x32x16_bf16 v[64:79], a[180:183], a[108:111], v[64:79]
s_waitcnt lgkmcnt(0)
s_waitcnt vmcnt(18)
s_barrier
ds_read_b64_tr_b16 a[192:193], v145 offset:12288
ds_read_b64_tr_b16 a[194:195], v145 offset:13568
ds_read_b64_tr_b16 a[196:197], v145 offset:12352
ds_read_b64_tr_b16 a[198:199], v145 offset:13632
v_mfma_f32_32x32x16_bf16 v[80:95], a[184:187], a[108:111], v[80:95]
ds_read_b64_tr_b16 a[200:201], v145 offset:12416
ds_read_b64_tr_b16 a[202:203], v145 offset:13696
s_add_u32 m0, s75, 40960
s_nop 0
buffer_load_dwordx4 v11, s[36:39], s77 offen lds
v_mfma_f32_32x32x16_bf16 v[96:111], a[188:191], a[108:111], v[96:111]
ds_read_b64_tr_b16 a[204:205], v145 offset:12480
ds_read_b64_tr_b16 a[206:207], v145 offset:13760
s_waitcnt lgkmcnt(6)
v_mfma_f32_32x32x16_bf16 v[32:47], a[192:195], a[112:115], v[32:47]
ds_read_b64_tr_b16 a[160:161], v145 offset:12544
ds_read_b64_tr_b16 a[162:163], v145 offset:13824
v_mfma_f32_16x16x32_bf16 v[208:211], a[192:195], v[246:249], v[208:211]
s_waitcnt lgkmcnt(6)
v_mfma_f32_32x32x16_bf16 v[48:63], a[196:199], a[112:115], v[48:63]
ds_read_b64_tr_b16 a[164:165], v147 offset:12288
ds_read_b64_tr_b16 a[166:167], v147 offset:13568
v_mfma_f32_16x16x32_bf16 v[212:215], a[196:199], v[246:249], v[212:215]
s_waitcnt lgkmcnt(6)
v_mfma_f32_32x32x16_bf16 v[64:79], a[200:203], a[112:115], v[64:79]
ds_read_b64_tr_b16 a[168:169], v147 offset:12352
ds_read_b64_tr_b16 a[170:171], v147 offset:13632
v_mfma_f32_16x16x32_bf16 v[216:219], a[200:203], v[246:249], v[216:219]
s_add_u32 m0, s75, 41984
s_nop 0
buffer_load_dwordx4 v12, s[36:39], s77 offen lds
s_waitcnt lgkmcnt(6)
v_mfma_f32_32x32x16_bf16 v[80:95], a[204:207], a[112:115], v[80:95]
ds_read_b64_tr_b16 a[172:173], v147 offset:12416
ds_read_b64_tr_b16 a[174:175], v147 offset:13696
v_mfma_f32_16x16x32_bf16 v[220:223], a[204:207], v[246:249], v[220:223]
s_waitcnt lgkmcnt(6)
v_mfma_f32_32x32x16_bf16 v[96:111], a[160:163], a[112:115], v[96:111]
ds_read_b64_tr_b16 a[176:177], v147 offset:12480
ds_read_b64_tr_b16 a[178:179], v147 offset:13760
v_mfma_f32_16x16x32_bf16 v[224:227], a[160:163], v[246:249], v[224:227]
s_waitcnt lgkmcnt(6)
v_mfma_f32_32x32x16_bf16 v[32:47], a[164:167], a[116:119], v[32:47]
ds_read_b64_tr_b16 a[180:181], v147 offset:12544
ds_read_b64_tr_b16 a[182:183], v147 offset:13824
s_waitcnt vmcnt(16)
ds_read_b128 a[128:131], v16 offset:8192
ds_read_b128 a[132:135], v17 offset:8192
ds_read_b128 a[136:139], v18 offset:8192
ds_read_b128 a[140:143], v19 offset:8192
ds_read_b128 v[160:163], v16 offset:8192
ds_read_b128 v[164:167], v17 offset:8192
ds_read_b128 v[168:171], v18 offset:8192
ds_read_b128 v[172:175], v19 offset:8192
s_waitcnt lgkmcnt(14)
v_mfma_f32_32x32x16_bf16 v[48:63], a[168:171], a[116:119], v[48:63]
ds_read_b64_tr_b16 a[184:185], v149 offset:12288
ds_read_b64_tr_b16 a[186:187], v149 offset:13568
s_add_u32 m0, s75, 43008
s_nop 0
buffer_load_dwordx4 v13, s[36:39], s77 offen lds
s_add_u32 s77, s77, 221184
s_sub_u32 s87, s77, 2211840
s_cmp_ge_u32 s77, 2211840
s_cselect_b32 s77, s87, s77
s_waitcnt lgkmcnt(14)
v_mfma_f32_32x32x16_bf16 v[64:79], a[172:175], a[116:119], v[64:79]
ds_read_b64_tr_b16 a[188:189], v149 offset:12352
ds_read_b64_tr_b16 a[190:191], v149 offset:13632
s_waitcnt lgkmcnt(14)
v_mfma_f32_32x32x16_bf16 v[80:95], a[176:179], a[116:119], v[80:95]
ds_read_b64_tr_b16 a[192:193], v149 offset:12416
ds_read_b64_tr_b16 a[194:195], v149 offset:13696
s_waitcnt lgkmcnt(14)
v_mfma_f32_32x32x16_bf16 v[96:111], a[180:183], a[116:119], v[96:111]
ds_read_b64_tr_b16 a[196:197], v149 offset:12480
ds_read_b64_tr_b16 a[198:199], v149 offset:13760
s_waitcnt lgkmcnt(8)
v_dot2c_f32_bf16 v20, s65, v160
v_dot2c_f32_bf16 v24, v160, v160
v_dot2c_f32_bf16 v21, s65, v161
v_dot2c_f32_bf16 v25, v161, v161
v_dot2c_f32_bf16 v14, s65, v162
v_dot2c_f32_bf16 v192, v162, v162
v_dot2c_f32_bf16 v15, s65, v163
v_dot2c_f32_bf16 v193, v163, v163
v_dot2c_f32_bf16 v20, s65, v164
v_dot2c_f32_bf16 v24, v164, v164
v_dot2c_f32_bf16 v21, s65, v165
v_dot2c_f32_bf16 v25, v165, v165
v_dot2c_f32_bf16 v14, s65, v166
v_dot2c_f32_bf16 v192, v166, v166
v_dot2c_f32_bf16 v15, s65, v167
v_dot2c_f32_bf16 v193, v167, v167
v_dot2c_f32_bf16 v20, s65, v168
v_dot2c_f32_bf16 v24, v168, v168
v_dot2c_f32_bf16 v21, s65, v169
v_dot2c_f32_bf16 v25, v169, v169
v_dot2c_f32_bf16 v14, s65, v170
v_dot2c_f32_bf16 v192, v170, v170
v_dot2c_f32_bf16 v15, s65, v171
v_dot2c_f32_bf16 v193, v171, v171
v_dot2c_f32_bf16 v20, s65, v172
v_dot2c_f32_bf16 v24, v172, v172
v_dot2c_f32_bf16 v21, s65, v173
v_dot2c_f32_bf16 v25, v173, v173
v_dot2c_f32_bf16 v14, s65, v174
v_dot2c_f32_bf16 v192, v174, v174
v_dot2c_f32_bf16 v15, s65, v175
v_dot2c_f32_bf16 v193, v175, v175
s_waitcnt lgkmcnt(6)
v_mfma_f32_32x32x16_bf16 v[32:47], a[184:187], a[120:123], v[32:47]
ds_read_b64_tr_b16 a[200:201], v149 offset:12544
ds_read_b64_tr_b16 a[202:203], v149 offset:13824
s_waitcnt lgkmcnt(6)
v_mfma_f32_32x32x16_bf16 v[48:63], a[188:191], a[120:123], v[48:63]
ds_read_b64_tr_b16 a[204:205], v151 offset:12288
ds_read_b64_tr_b16 a[206:207], v151 offset:13568
s_waitcnt lgkmcnt(6)
v_mfma_f32_32x32x16_bf16 v[64:79], a[192:195], a[120:123], v[64:79]
ds_read_b64_tr_b16 a[160:161], v151 offset:12352
ds_read_b64_tr_b16 a[162:163], v151 offset:13632
s_waitcnt lgkmcnt(6)
v_mfma_f32_32x32x16_bf16 v[80:95], a[196:199], a[120:123], v[80:95]
ds_read_b64_tr_b16 a[164:165], v151 offset:12416
ds_read_b64_tr_b16 a[166:167], v151 offset:13696
s_waitcnt lgkmcnt(6)
v_mfma_f32_32x32x16_bf16 v[96:111], a[200:203], a[120:123], v[96:111]
ds_read_b64_tr_b16 a[168:169], v151 offset:12480
ds_read_b64_tr_b16 a[170:171], v151 offset:13760
s_waitcnt lgkmcnt(6)
v_mfma_f32_32x32x16_bf16 v[32:47], a[204:207], a[124:127], v[32:47]
ds_read_b64_tr_b16 a[172:173], v151 offset:12544
ds_read_b64_tr_b16 a[174:175], v151 offset:13824
s_waitcnt lgkmcnt(6)
v_mfma_f32_32x32x16_bf16 v[48:63], a[160:163], a[124:127], v[48:63]
s_waitcnt lgkmcnt(4)
v_mfma_f32_32x32x16_bf16 v[64:79], a[164:167], a[124:127], v[64:79]
s_waitcnt lgkmcnt(0)
s_waitcnt vmcnt(12)
s_barrier
ds_read_b64_tr_b16 a[176:177], v144 offset:0
ds_read_b64_tr_b16 a[178:179], v144 offset:1280
ds_read_b64_tr_b16 a[180:181], v144 offset:64
ds_read_b64_tr_b16 a[182:183], v144 offset:1344
v_mfma_f32_32x32x16_bf16 v[80:95], a[168:171], a[124:127], v[80:95]
ds_read_b64_tr_b16 a[184:185], v144 offset:128
ds_read_b64_tr_b16 a[186:187], v144 offset:1408
s_add_u32 m0, s75, 61440
s_nop 0
buffer_load_dwordx4 v11, s[36:39], s77 offen lds
v_mfma_f32_32x32x16_bf16 v[96:111], a[172:175], a[124:127], v[96:111]
ds_read_b64_tr_b16 a[188:189], v144 offset:192
ds_read_b64_tr_b16 a[190:191], v144 offset:1472
s_waitcnt lgkmcnt(6)
v_mfma_f32_32x32x16_bf16 v[32:47], a[176:179], a[128:131], v[32:47]
ds_read_b64_tr_b16 a[192:193], v144 offset:256
ds_read_b64_tr_b16 a[194:195], v144 offset:1536
v_mfma_f32_16x16x32_bf16 v[208:211], a[176:179], v[246:249], v[208:211]
s_waitcnt lgkmcnt(6)
v_mfma_f32_32x32x16_bf16 v[48:63], a[180:183], a[128:131], v[48:63]
ds_read_b64_tr_b16 a[196:197], v146 offset:0
ds_read_b64_tr_b16 a[198:199], v146 offset:1280
v_mfma_f32_16x16x32_bf16 v[212:215], a[180:183], v[246:249], v[212:215]
s_waitcnt lgkmcnt(6)
v_mfma_f32_32x32x16_bf16 v[64:79], a[184:187], a[128:131], v[64:79]
ds_read_b64_tr_b16 a[200:201], v146 offset:64
ds_read_b64_tr_b16 a[202:203], v146 offset:1344
v_mfma_f32_16x16x32_bf16 v[216:219], a[184:187], v[246:249], v[216:219]
s_add_u32 m0, s75, 62464
s_nop 0
buffer_load_dwordx4 v12, s[36:39], s77 offen lds
s_waitcnt lgkmcnt(6)
v_mfma_f32_32x32x16_bf16 v[80:95], a[188:191], a[128:131], v[80:95]
ds_read_b64_tr_b16 a[204:205], v146 offset:128
ds_read_b64_tr_b16 a[206:207], v146 offset:1408
v_mfma_f32_16x16x32_bf16 v[220:223], a[188:191], v[246:249], v[220:223]
s_waitcnt lgkmcnt(6)
v_mfma_f32_32x32x16_bf16 v[96:111], a[192:195], a[128:131], v[96:111]
ds_read_b64_tr_b16 a[160:161], v146 offset:192
ds_read_b64_tr_b16 a[162:163], v146 offset:1472
v_mfma_f32_16x16x32_bf16 v[224:227], a[192:195], v[246:249], v[224:227]
s_waitcnt lgkmcnt(6)
v_mfma_f32_32x32x16_bf16 v[32:47], a[196:199], a[132:135], v[32:47]
ds_read_b64_tr_b16 a[164:165], v146 offset:256
ds_read_b64_tr_b16 a[166:167], v146 offset:1536
s_waitcnt vmcnt(10)
ds_read_b128 a[144:147], v16 offset:0
ds_read_b128 a[148:151], v17 offset:0
ds_read_b128 a[152:155], v18 offset:0
ds_read_b128 a[156:159], v19 offset:0
ds_read_b128 v[176:179], v16 offset:0
ds_read_b128 v[180:183], v17 offset:0
ds_read_b128 v[184:187], v18 offset:0
ds_read_b128 v[188:191], v19 offset:0
s_waitcnt lgkmcnt(14)
v_mfma_f32_32x32x16_bf16 v[48:63], a[200:203], a[132:135], v[48:63]
ds_read_b64_tr_b16 a[168:169], v148 offset:0
ds_read_b64_tr_b16 a[170:171], v148 offset:1280
s_add_u32 m0, s75, 63488
s_nop 0
buffer_load_dwordx4 v13, s[36:39], s77 offen lds
s_add_u32 s77, s77, 221184
s_sub_u32 s87, s77, 2211840
s_cmp_ge_u32 s77, 2211840
s_cselect_b32 s77, s87, s77
s_waitcnt lgkmcnt(14)
v_mfma_f32_32x32x16_bf16 v[64:79], a[204:207], a[132:135], v[64:79]
ds_read_b64_tr_b16 a[172:173], v148 offset:64
ds_read_b64_tr_b16 a[174:175], v148 offset:1344
s_waitcnt lgkmcnt(14)
v_mfma_f32_32x32x16_bf16 v[80:95], a[160:163], a[132:135], v[80:95]
ds_read_b64_tr_b16 a[176:177], v148 offset:128
ds_read_b64_tr_b16 a[178:179], v148 offset:1408
s_waitcnt lgkmcnt(14)
v_mfma_f32_32x32x16_bf16 v[96:111], a[164:167], a[132:135], v[96:111]
ds_read_b64_tr_b16 a[180:181], v148 offset:192
ds_read_b64_tr_b16 a[182:183], v148 offset:1472
s_waitcnt lgkmcnt(8)
v_dot2c_f32_bf16 v20, s65, v176
v_dot2c_f32_bf16 v24, v176, v176
v_dot2c_f32_bf16 v21, s65, v177
v_dot2c_f32_bf16 v25, v177, v177
v_dot2c_f32_bf16 v14, s65, v178
v_dot2c_f32_bf16 v192, v178, v178
v_dot2c_f32_bf16 v15, s65, v179
v_dot2c_f32_bf16 v193, v179, v179
v_dot2c_f32_bf16 v20, s65, v180
v_dot2c_f32_bf16 v24, v180, v180
v_dot2c_f32_bf16 v21, s65, v181
v_dot2c_f32_bf16 v25, v181, v181
v_dot2c_f32_bf16 v14, s65, v182
v_dot2c_f32_bf16 v192, v182, v182
v_dot2c_f32_bf16 v15, s65, v183
v_dot2c_f32_bf16 v193, v183, v183
v_dot2c_f32_bf16 v20, s65, v184
v_dot2c_f32_bf16 v24, v184, v184
v_dot2c_f32_bf16 v21, s65, v185
v_dot2c_f32_bf16 v25, v185, v185
v_dot2c_f32_bf16 v14, s65, v186
v_dot2c_f32_bf16 v192, v186, v186
v_dot2c_f32_bf16 v15, s65, v187
v_dot2c_f32_bf16 v193, v187, v187
v_dot2c_f32_bf16 v20, s65, v188
v_dot2c_f32_bf16 v24, v188, v188
v_dot2c_f32_bf16 v21, s65, v189
v_dot2c_f32_bf16 v25, v189, v189
v_dot2c_f32_bf16 v14, s65, v190
v_dot2c_f32_bf16 v192, v190, v190
v_dot2c_f32_bf16 v15, s65, v191
v_dot2c_f32_bf16 v193, v191, v191
v_add_f32 v20, v20, v14
s_nop 0
v_add_f32 v21, v21, v15
v_add_f32 v24, v24, v192
v_add_f32 v25, v25, v193
s_waitcnt lgkmcnt(6)
v_mfma_f32_32x32x16_bf16 v[32:47], a[168:171], a[136:139], v[32:47]
ds_read_b64_tr_b16 a[184:185], v148 offset:256
ds_read_b64_tr_b16 a[186:187], v148 offset:1536
s_waitcnt lgkmcnt(6)
v_mfma_f32_32x32x16_bf16 v[48:63], a[172:175], a[136:139], v[48:63]
ds_read_b64_tr_b16 a[188:189], v150 offset:0
ds_read_b64_tr_b16 a[190:191], v150 offset:1280
s_waitcnt lgkmcnt(6)
v_mfma_f32_32x32x16_bf16 v[64:79], a[176:179], a[136:139], v[64:79]
ds_read_b64_tr_b16 a[192:193], v150 offset:64
ds_read_b64_tr_b16 a[194:195], v150 offset:1344
s_waitcnt lgkmcnt(6)
v_mfma_f32_32x32x16_bf16 v[80:95], a[180:183], a[136:139], v[80:95]
ds_read_b64_tr_b16 a[196:197], v150 offset:128
ds_read_b64_tr_b16 a[198:199], v150 offset:1408
s_waitcnt lgkmcnt(6)
v_mfma_f32_32x32x16_bf16 v[96:111], a[184:187], a[136:139], v[96:111]
ds_read_b64_tr_b16 a[200:201], v150 offset:192
ds_read_b64_tr_b16 a[202:203], v150 offset:1472
s_waitcnt lgkmcnt(6)
v_mfma_f32_32x32x16_bf16 v[32:47], a[188:191], a[140:143], v[32:47]
ds_read_b64_tr_b16 a[204:205], v150 offset:256
ds_read_b64_tr_b16 a[206:207], v150 offset:1536
s_waitcnt lgkmcnt(6)
v_mfma_f32_32x32x16_bf16 v[48:63], a[192:195], a[140:143], v[48:63]
s_waitcnt lgkmcnt(4)
v_mfma_f32_32x32x16_bf16 v[64:79], a[196:199], a[140:143], v[64:79]
s_waitcnt lgkmcnt(0)
s_waitcnt vmcnt(6)
s_barrier
ds_read_b64_tr_b16 a[160:161], v144 offset:20480
ds_read_b64_tr_b16 a[162:163], v144 offset:21760
ds_read_b64_tr_b16 a[164:165], v144 offset:20544
ds_read_b64_tr_b16 a[166:167], v144 offset:21824
v_mfma_f32_32x32x16_bf16 v[80:95], a[200:203], a[140:143], v[80:95]
ds_read_b64_tr_b16 a[168:169], v144 offset:20608
ds_read_b64_tr_b16 a[170:171], v144 offset:21888
s_add_u32 m0, s75, 0
s_nop 0
buffer_load_dwordx4 v11, s[36:39], s77 offen lds
v_mfma_f32_32x32x16_bf16 v[96:111], a[204:207], a[140:143], v[96:111]
ds_read_b64_tr_b16 a[172:173], v144 offset:20672
ds_read_b64_tr_b16 a[174:175], v144 offset:21952
s_waitcnt lgkmcnt(6)
v_mfma_f32_32x32x16_bf16 v[32:47], a[160:163], a[144:147], v[32:47]
ds_read_b64_tr_b16 a[176:177], v144 offset:20736
ds_read_b64_tr_b16 a[178:179], v144 offset:22016
v_mfma_f32_16x16x32_bf16 v[208:211], a[160:163], v[246:249], v[208:211]
s_waitcnt lgkmcnt(6)
v_mfma_f32_32x32x16_bf16 v[48:63], a[164:167], a[144:147], v[48:63]
ds_read_b64_tr_b16 a[180:181], v146 offset:20480
ds_read_b64_tr_b16 a[182:183], v146 offset:21760
v_mfma_f32_16x16x32_bf16 v[212:215], a[164:167], v[246:249], v[212:215]
s_waitcnt lgkmcnt(6)
v_mfma_f32_32x32x16_bf16 v[64:79], a[168:171], a[144:147], v[64:79]
ds_read_b64_tr_b16 a[184:185], v146 offset:20544
ds_read_b64_tr_b16 a[186:187], v146 offset:21824
v_mfma_f32_16x16x32_bf16 v[216:219], a[168:171], v[246:249], v[216:219]
s_add_u32 m0, s75, 1024
s_nop 0
buffer_load_dwordx4 v12, s[36:39], s77 offen lds
s_waitcnt lgkmcnt(6)
v_mfma_f32_32x32x16_bf16 v[80:95], a[172:175], a[144:147], v[80:95]
ds_read_b64_tr_b16 a[188:189], v146 offset:20608
ds_read_b64_tr_b16 a[190:191], v146 offset:21888
v_mfma_f32_16x16x32_bf16 v[220:223], a[172:175], v[246:249], v[220:223]
s_waitcnt lgkmcnt(6)
v_mfma_f32_32x32x16_bf16 v[96:111], a[176:179], a[144:147], v[96:111]
ds_read_b64_tr_b16 a[192:193], v146 offset:20672
ds_read_b64_tr_b16 a[194:195], v146 offset:21952
v_mfma_f32_16x16x32_bf16 v[224:227], a[176:179], v[246:249], v[224:227]
s_waitcnt lgkmcnt(6)
v_mfma_f32_32x32x16_bf16 v[32:47], a[180:183], a[148:151], v[32:47]
ds_read_b64_tr_b16 a[196:197], v146 offset:20736
ds_read_b64_tr_b16 a[198:199], v146 offset:22016
s_waitcnt lgkmcnt(6)
v_mfma_f32_32x32x16_bf16 v[48:63], a[184:187], a[148:151], v[48:63]
ds_read_b64_tr_b16 a[200:201], v148 offset:20480
ds_read_b64_tr_b16 a[202:203], v148 offset:21760
s_add_u32 m0, s75, 2048
s_nop 0
buffer_load_dwordx4 v13, s[36:39], s77 offen lds
s_add_u32 s77, s77, 221184
s_sub_u32 s87, s77, 2211840
s_cmp_ge_u32 s77, 2211840
s_cselect_b32 s77, s87, s77
s_waitcnt lgkmcnt(6)
v_mfma_f32_32x32x16_bf16 v[64:79], a[188:191], a[148:151], v[64:79]
ds_read_b64_tr_b16 a[204:205], v148 offset:20544
ds_read_b64_tr_b16 a[206:207], v148 offset:21824
s_waitcnt lgkmcnt(6)
v_mfma_f32_32x32x16_bf16 v[80:95], a[192:195], a[148:151], v[80:95]
ds_read_b64_tr_b16 a[160:161], v148 offset:20608
ds_read_b64_tr_b16 a[162:163], v148 offset:21888
s_waitcnt lgkmcnt(6)
v_mfma_f32_32x32x16_bf16 v[96:111], a[196:199], a[148:151], v[96:111]
ds_read_b64_tr_b16 a[164:165], v148 offset:20672
ds_read_b64_tr_b16 a[166:167], v148 offset:21952
s_waitcnt lgkmcnt(6)
v_mfma_f32_32x32x16_bf16 v[32:47], a[200:203], a[152:155], v[32:47]
ds_read_b64_tr_b16 a[168:169], v148 offset:20736
ds_read_b64_tr_b16 a[170:171], v148 offset:22016
s_waitcnt lgkmcnt(6)
v_mfma_f32_32x32x16_bf16 v[48:63], a[204:207], a[152:155], v[48:63]
ds_read_b64_tr_b16 a[172:173], v150 offset:20480
ds_read_b64_tr_b16 a[174:175], v150 offset:21760
s_waitcnt lgkmcnt(6)
v_mfma_f32_32x32x16_bf16 v[64:79], a[160:163], a[152:155], v[64:79]
ds_read_b64_tr_b16 a[176:177], v150 offset:20544
ds_read_b64_tr_b16 a[178:179], v150 offset:21824
s_waitcnt lgkmcnt(6)
v_mfma_f32_32x32x16_bf16 v[80:95], a[164:167], a[152:155], v[80:95]
ds_read_b64_tr_b16 a[180:181], v150 offset:20608
ds_read_b64_tr_b16 a[182:183], v150 offset:21888
s_waitcnt lgkmcnt(6)
v_mfma_f32_32x32x16_bf16 v[96:111], a[168:171], a[152:155], v[96:111]
ds_read_b64_tr_b16 a[184:185], v150 offset:20672
ds_read_b64_tr_b16 a[186:187], v150 offset:21952
s_waitcnt lgkmcnt(6)
v_mfma_f32_32x32x16_bf16 v[32:47], a[172:175], a[156:159], v[32:47]
ds_read_b64_tr_b16 a[188:189], v150 offset:20736
ds_read_b64_tr_b16 a[190:191], v150 offset:22016
s_waitcnt lgkmcnt(6)
v_mfma_f32_32x32x16_bf16 v[48:63], a[176:179], a[156:159], v[48:63]
s_waitcnt lgkmcnt(4)
v_mfma_f32_32x32x16_bf16 v[64:79], a[180:183], a[156:159], v[64:79]
s_waitcnt lgkmcnt(2)
v_mfma_f32_32x32x16_bf16 v[80:95], a[184:187], a[156:159], v[80:95]
s_waitcnt lgkmcnt(0)
v_mfma_f32_32x32x16_bf16 v[96:111], a[188:191], a[156:159], v[96:111]
v_add_f32 v20, v20, v21
v_add_f32 v24, v24, v25
v_mov_b32 v21, v20
v_mov_b32 v25, v24
s_nop 0
v_permlane32_swap_b32 v20, v21
v_permlane32_swap_b32 v24, v25
v_add_f32 v20, v20, v21
v_add_f32 v24, v24, v25
s_mov_b32 s60, 0x3acccccd
s_mov_b32 s61, 0x3727c5ac
v_mul_f32 v20, s60, v20
v_mul_f32 v24, s60, v24
v_fma_f32 v24, -v20, v20, v24
v_max_f32_e64 v24, 0, v24
v_cvt_pk_bf16_f32 v28, v20, v24
v_lshlrev_b32 v20, 16, v28
v_and_b32 v24, s64, v28
v_add_f32_e64 v24, s61, v24
v_cvt_pk_bf16_f32 v28, v24, v24
v_and_b32 v24, s64, v28
v_sqrt_f32 v24, v24
s_nop 0
v_cvt_pk_bf16_f32 v28, v24, v24
v_and_b32 v24, s64, v28
v_rcp_f32 v28, v24
s_nop 0
v_mul_f32 v24, v20, v28
v_sub_f32 v21, 0, v24
v_mov_b32 v20, v28
v_and_b32 v160, 15, v1
v_lshlrev_b32 v160, 6, v160
v_lshrrev_b32 v161, 4, v1
v_lshl_add_u32 v160, v161, 4, v160
s_lshl_b32 s60, s56, 10
s_add_u32 s60, s60, 159744
v_add_u32 v160, s60, v160
s_mov_b32 exec_lo, 0x00030003
s_mov_b32 exec_hi, 0x00030003
ds_write_b128 v160, v[208:211] offset:0
ds_write_b128 v160, v[212:215] offset:128
ds_write_b128 v160, v[216:219] offset:256
ds_write_b128 v160, v[220:223] offset:384
ds_write_b128 v160, v[224:227] offset:512
s_mov_b64 exec, -1
v_lshlrev_b32 v160, 4, v1
v_add_u32 v160, 159744, v160
s_waitcnt lgkmcnt(0)
s_barrier
s_cmp_lg_u32 s56, 0
s_cbranch_scc1 L_csr_A_5
ds_read_b128 v[162:165], v160 offset:0
ds_read_b128 v[166:169], v160 offset:1024
ds_read_b128 v[170:173], v160 offset:2048
ds_read_b128 v[174:177], v160 offset:3072
s_waitcnt lgkmcnt(0)
v_pk_add_f32 v[162:163], v[162:163], v[166:167]
v_pk_add_f32 v[164:165], v[164:165], v[168:169]
v_pk_add_f32 v[170:171], v[170:171], v[174:175]
v_pk_add_f32 v[172:173], v[172:173], v[176:177]
v_pk_add_f32 v[162:163], v[162:163], v[170:171]
v_pk_add_f32 v[164:165], v[164:165], v[172:173]
ds_write_b128 v160, v[162:165]
s_waitcnt lgkmcnt(0)
L_csr_A_5:
s_barrier
v_lshrrev_b32 v28, 5, v1
v_lshlrev_b32_e64 v28, 4, v28
v_add_u32 v28, 159744, v28
ds_read_b128 v[160:163], v28 offset:0
ds_read_b128 v[164:167], v28 offset:32
ds_read_b128 v[168:171], v28 offset:64
ds_read_b128 v[172:175], v28 offset:96
ds_read_b128 v[176:179], v28 offset:128
ds_read_b128 v[180:183], v28 offset:160
ds_read_b128 v[184:187], v28 offset:192
ds_read_b128 v[188:191], v28 offset:224
s_waitcnt lgkmcnt(4)
v_pk_mul_f32 v[160:161], v[160:161], v[20:21] op_sel:[0,1] op_sel_hi:[1,1]
v_pk_mul_f32 v[162:163], v[162:163], v[20:21] op_sel:[0,1] op_sel_hi:[1,1]
v_pk_mul_f32 v[164:165], v[164:165], v[20:21] op_sel:[0,1] op_sel_hi:[1,1]
v_pk_mul_f32 v[166:167], v[166:167], v[20:21] op_sel:[0,1] op_sel_hi:[1,1]
v_pk_mul_f32 v[168:169], v[168:169], v[20:21] op_sel:[0,1] op_sel_hi:[1,1]
v_pk_mul_f32 v[170:171], v[170:171], v[20:21] op_sel:[0,1] op_sel_hi:[1,1]
v_pk_mul_f32 v[172:173], v[172:173], v[20:21] op_sel:[0,1] op_sel_hi:[1,1]
v_pk_mul_f32 v[174:175], v[174:175], v[20:21] op_sel:[0,1] op_sel_hi:[1,1]
v_pk_fma_f32 v[32:33], v[32:33], v[20:21], v[160:161] op_sel_hi:[1,0,1]
v_pk_fma_f32 v[34:35], v[34:35], v[20:21], v[162:163] op_sel_hi:[1,0,1]
v_pk_fma_f32 v[36:37], v[36:37], v[20:21], v[164:165] op_sel_hi:[1,0,1]
v_pk_fma_f32 v[38:39], v[38:39], v[20:21], v[166:167] op_sel_hi:[1,0,1]
v_pk_fma_f32 v[40:41], v[40:41], v[20:21], v[168:169] op_sel_hi:[1,0,1]
v_pk_fma_f32 v[42:43], v[42:43], v[20:21], v[170:171] op_sel_hi:[1,0,1]
v_pk_fma_f32 v[44:45], v[44:45], v[20:21], v[172:173] op_sel_hi:[1,0,1]
v_pk_fma_f32 v[46:47], v[46:47], v[20:21], v[174:175] op_sel_hi:[1,0,1]
ds_read_b128 v[160:163], v28 offset:256
ds_read_b128 v[164:167], v28 offset:288
ds_read_b128 v[168:171], v28 offset:320
ds_read_b128 v[172:175], v28 offset:352
s_waitcnt lgkmcnt(4)
v_pk_mul_f32 v[176:177], v[176:177], v[20:21] op_sel:[0,1] op_sel_hi:[1,1]
v_pk_mul_f32 v[178:179], v[178:179], v[20:21] op_sel:[0,1] op_sel_hi:[1,1]
v_pk_mul_f32 v[180:181], v[180:181], v[20:21] op_sel:[0,1] op_sel_hi:[1,1]
v_pk_mul_f32 v[182:183], v[182:183], v[20:21] op_sel:[0,1] op_sel_hi:[1,1]
v_pk_mul_f32 v[184:185], v[184:185], v[20:21] op_sel:[0,1] op_sel_hi:[1,1]
v_pk_mul_f32 v[186:187], v[186:187], v[20:21] op_sel:[0,1] op_sel_hi:[1,1]
v_pk_mul_f32 v[188:189], v[188:189], v[20:21] op_sel:[0,1] op_sel_hi:[1,1]
v_pk_mul_f32 v[190:191], v[190:191], v[20:21] op_sel:[0,1] op_sel_hi:[1,1]
v_pk_fma_f32 v[48:49], v[48:49], v[20:21], v[176:177] op_sel_hi:[1,0,1]
v_pk_fma_f32 v[50:51], v[50:51], v[20:21], v[178:179] op_sel_hi:[1,0,1]
v_pk_fma_f32 v[52:53], v[52:53], v[20:21], v[180:181] op_sel_hi:[1,0,1]
v_pk_fma_f32 v[54:55], v[54:55], v[20:21], v[182:183] op_sel_hi:[1,0,1]
v_pk_fma_f32 v[56:57], v[56:57], v[20:21], v[184:185] op_sel_hi:[1,0,1]
v_pk_fma_f32 v[58:59], v[58:59], v[20:21], v[186:187] op_sel_hi:[1,0,1]
v_pk_fma_f32 v[60:61], v[60:61], v[20:21], v[188:189] op_sel_hi:[1,0,1]
v_pk_fma_f32 v[62:63], v[62:63], v[20:21], v[190:191] op_sel_hi:[1,0,1]
ds_read_b128 v[176:179], v28 offset:384
ds_read_b128 v[180:183], v28 offset:416
ds_read_b128 v[184:187], v28 offset:448
ds_read_b128 v[188:191], v28 offset:480
s_waitcnt lgkmcnt(4)
v_pk_mul_f32 v[160:161], v[160:161], v[20:21] op_sel:[0,1] op_sel_hi:[1,1]
v_pk_mul_f32 v[162:163], v[162:163], v[20:21] op_sel:[0,1] op_sel_hi:[1,1]
v_pk_mul_f32 v[164:165], v[164:165], v[20:21] op_sel:[0,1] op_sel_hi:[1,1]
v_pk_mul_f32 v[166:167], v[166:167], v[20:21] op_sel:[0,1] op_sel_hi:[1,1]
v_pk_mul_f32 v[168:169], v[168:169], v[20:21] op_sel:[0,1] op_sel_hi:[1,1]
v_pk_mul_f32 v[170:171], v[170:171], v[20:21] op_sel:[0,1] op_sel_hi:[1,1]
v_pk_mul_f32 v[172:173], v[172:173], v[20:21] op_sel:[0,1] op_sel_hi:[1,1]
v_pk_mul_f32 v[174:175], v[174:175], v[20:21] op_sel:[0,1] op_sel_hi:[1,1]
v_pk_fma_f32 v[64:65], v[64:65], v[20:21], v[160:161] op_sel_hi:[1,0,1]
v_pk_fma_f32 v[66:67], v[66:67], v[20:21], v[162:163] op_sel_hi:[1,0,1]
v_pk_fma_f32 v[68:69], v[68:69], v[20:21], v[164:165] op_sel_hi:[1,0,1]
v_pk_fma_f32 v[70:71], v[70:71], v[20:21], v[166:167] op_sel_hi:[1,0,1]
v_pk_fma_f32 v[72:73], v[72:73], v[20:21], v[168:169] op_sel_hi:[1,0,1]
v_pk_fma_f32 v[74:75], v[74:75], v[20:21], v[170:171] op_sel_hi:[1,0,1]
v_pk_fma_f32 v[76:77], v[76:77], v[20:21], v[172:173] op_sel_hi:[1,0,1]
v_pk_fma_f32 v[78:79], v[78:79], v[20:21], v[174:175] op_sel_hi:[1,0,1]
ds_read_b128 v[160:163], v28 offset:512
ds_read_b128 v[164:167], v28 offset:544
ds_read_b128 v[168:171], v28 offset:576
ds_read_b128 v[172:175], v28 offset:608
s_waitcnt lgkmcnt(4)
v_pk_mul_f32 v[176:177], v[176:177], v[20:21] op_sel:[0,1] op_sel_hi:[1,1]
v_pk_mul_f32 v[178:179], v[178:179], v[20:21] op_sel:[0,1] op_sel_hi:[1,1]
v_pk_mul_f32 v[180:181], v[180:181], v[20:21] op_sel:[0,1] op_sel_hi:[1,1]
v_pk_mul_f32 v[182:183], v[182:183], v[20:21] op_sel:[0,1] op_sel_hi:[1,1]
v_pk_mul_f32 v[184:185], v[184:185], v[20:21] op_sel:[0,1] op_sel_hi:[1,1]
v_pk_mul_f32 v[186:187], v[186:187], v[20:21] op_sel:[0,1] op_sel_hi:[1,1]
v_pk_mul_f32 v[188:189], v[188:189], v[20:21] op_sel:[0,1] op_sel_hi:[1,1]
v_pk_mul_f32 v[190:191], v[190:191], v[20:21] op_sel:[0,1] op_sel_hi:[1,1]
v_pk_fma_f32 v[80:81], v[80:81], v[20:21], v[176:177] op_sel_hi:[1,0,1]
v_pk_fma_f32 v[82:83], v[82:83], v[20:21], v[178:179] op_sel_hi:[1,0,1]
v_pk_fma_f32 v[84:85], v[84:85], v[20:21], v[180:181] op_sel_hi:[1,0,1]
v_pk_fma_f32 v[86:87], v[86:87], v[20:21], v[182:183] op_sel_hi:[1,0,1]
v_pk_fma_f32 v[88:89], v[88:89], v[20:21], v[184:185] op_sel_hi:[1,0,1]
v_pk_fma_f32 v[90:91], v[90:91], v[20:21], v[186:187] op_sel_hi:[1,0,1]
v_pk_fma_f32 v[92:93], v[92:93], v[20:21], v[188:189] op_sel_hi:[1,0,1]
v_pk_fma_f32 v[94:95], v[94:95], v[20:21], v[190:191] op_sel_hi:[1,0,1]
s_waitcnt lgkmcnt(0)
v_pk_mul_f32 v[160:161], v[160:161], v[20:21] op_sel:[0,1] op_sel_hi:[1,1]
v_pk_mul_f32 v[162:163], v[162:163], v[20:21] op_sel:[0,1] op_sel_hi:[1,1]
v_pk_mul_f32 v[164:165], v[164:165], v[20:21] op_sel:[0,1] op_sel_hi:[1,1]
v_pk_mul_f32 v[166:167], v[166:167], v[20:21] op_sel:[0,1] op_sel_hi:[1,1]
v_pk_mul_f32 v[168:169], v[168:169], v[20:21] op_sel:[0,1] op_sel_hi:[1,1]
v_pk_mul_f32 v[170:171], v[170:171], v[20:21] op_sel:[0,1] op_sel_hi:[1,1]
v_pk_mul_f32 v[172:173], v[172:173], v[20:21] op_sel:[0,1] op_sel_hi:[1,1]
v_pk_mul_f32 v[174:175], v[174:175], v[20:21] op_sel:[0,1] op_sel_hi:[1,1]
v_pk_fma_f32 v[96:97], v[96:97], v[20:21], v[160:161] op_sel_hi:[1,0,1]
v_pk_fma_f32 v[98:99], v[98:99], v[20:21], v[162:163] op_sel_hi:[1,0,1]
v_pk_fma_f32 v[100:101], v[100:101], v[20:21], v[164:165] op_sel_hi:[1,0,1]
v_pk_fma_f32 v[102:103], v[102:103], v[20:21], v[166:167] op_sel_hi:[1,0,1]
v_pk_fma_f32 v[104:105], v[104:105], v[20:21], v[168:169] op_sel_hi:[1,0,1]
v_pk_fma_f32 v[106:107], v[106:107], v[20:21], v[170:171] op_sel_hi:[1,0,1]
v_pk_fma_f32 v[108:109], v[108:109], v[20:21], v[172:173] op_sel_hi:[1,0,1]
v_pk_fma_f32 v[110:111], v[110:111], v[20:21], v[174:175] op_sel_hi:[1,0,1]
v_lshlrev_b32 v245, 10, v1
v_mov_b32 v251, 0x7f000000
v_cmp_gt_u32 vcc, 14, v1
s_nop 1
v_cndmask_b32_e64 v245, v251, v245, vcc
buffer_load_dword v251, v245, s[44:47], s93 offen sc1
v_lshlrev_b32_e64 v244, 4, v1
v_add_u32 v244, 147456, v244
v_cvt_pk_bf16_f32 v112, v32, v33
v_cvt_pk_bf16_f32 v113, v34, v35
v_cvt_pk_bf16_f32 v114, v36, v37
v_cvt_pk_bf16_f32 v115, v38, v39
v_cvt_pk_bf16_f32 v116, v40, v41
v_cvt_pk_bf16_f32 v117, v42, v43
v_cvt_pk_bf16_f32 v118, v44, v45
v_cvt_pk_bf16_f32 v119, v46, v47
v_cvt_pk_bf16_f32 v120, v48, v49
v_cvt_pk_bf16_f32 v121, v50, v51
v_cvt_pk_bf16_f32 v122, v52, v53
v_cvt_pk_bf16_f32 v123, v54, v55
v_cvt_pk_bf16_f32 v124, v56, v57
v_cvt_pk_bf16_f32 v125, v58, v59
v_cvt_pk_bf16_f32 v126, v60, v61
v_cvt_pk_bf16_f32 v127, v62, v63
v_cvt_pk_bf16_f32 v128, v64, v65
v_cvt_pk_bf16_f32 v129, v66, v67
v_cvt_pk_bf16_f32 v130, v68, v69
v_cvt_pk_bf16_f32 v131, v70, v71
v_cvt_pk_bf16_f32 v152, v72, v73
v_cvt_pk_bf16_f32 v153, v74, v75
v_cvt_pk_bf16_f32 v154, v76, v77
v_cvt_pk_bf16_f32 v155, v78, v79
v_cvt_pk_bf16_f32 v156, v80, v81
v_cvt_pk_bf16_f32 v157, v82, v83
v_cvt_pk_bf16_f32 v158, v84, v85
v_cvt_pk_bf16_f32 v159, v86, v87
v_cvt_pk_bf16_f32 v160, v88, v89
v_cvt_pk_bf16_f32 v161, v90, v91
v_cvt_pk_bf16_f32 v184, v92, v93
v_cvt_pk_bf16_f32 v185, v94, v95
v_cvt_pk_bf16_f32 v186, v96, v97
v_cvt_pk_bf16_f32 v187, v98, v99
v_cvt_pk_bf16_f32 v188, v100, v101
v_cvt_pk_bf16_f32 v189, v102, v103
v_cvt_pk_bf16_f32 v190, v104, v105
v_cvt_pk_bf16_f32 v191, v106, v107
v_cvt_pk_bf16_f32 v192, v108, v109
v_cvt_pk_bf16_f32 v193, v110, v111
v_mov_b32 v162, 0x3f80
v_mov_b32_e64 v163, 0
v_mov_b32 v194, 0x3f80
v_mov_b32 v195, 0
v_and_b32 v28, 31, v1
v_lshrrev_b32_e64 v29, 5, v1
v_bfe_u32 v30, v28, 1, 1
v_lshlrev_b32_e64 v30, 2, v30
v_bfe_u32 v31, v28, 2, 1
v_lshl_add_u32 v30, v31, 1, v30
v_and_b32 v31, 1, v28
v_add_u32 v30, v30, v31
v_lshlrev_b32_e64 v80, 4, v30
v_lshl_add_u32 v80, v28, 7, v80
v_lshl_add_u32 v80, v29, 15, v80
s_lshl_b32 s60, s56, 12
s_add_u32 s60, s60, 81920
v_add_u32 v80, s60, v80
v_xor_b32 v81, 16, v80
v_xor_b32 v82, 32, v80
v_xor_b32 v83, 48, v80
v_xor_b32 v84, 64, v80
v_xor_b32 v85, 80, v80
v_xor_b32 v86, 96, v80
v_xor_b32 v87, 112, v80
ds_read_b128 v[32:35], v244 offset:0
ds_read_b128 v[36:39], v244 offset:1024
ds_read_b128 v[40:43], v244 offset:2048
ds_read_b128 v[44:47], v244 offset:3072
ds_read_b128 v[48:51], v244 offset:4096
ds_read_b128 v[52:55], v244 offset:5120
ds_read_b128 v[56:59], v244 offset:6144
ds_read_b128 v[60:63], v244 offset:7168
ds_read_b128 v[64:67], v244 offset:8192
ds_read_b128 v[68:71], v244 offset:9216
ds_read_b128 v[72:75], v244 offset:10240
s_waitcnt lgkmcnt(10)
v_mfma_f32_32x32x16_bf16 v[196:211], v[32:35], v[112:115], 0
s_waitcnt lgkmcnt(9)
v_mfma_f32_32x32x16_bf16 v[196:211], v[36:39], v[116:119], v[196:211]
s_waitcnt lgkmcnt(8)
v_mfma_f32_32x32x16_bf16 v[196:211], v[40:43], v[120:123], v[196:211]
s_waitcnt lgkmcnt(7)
v_mfma_f32_32x32x16_bf16 v[212:227], v[44:47], v[120:123], 0
s_waitcnt lgkmcnt(6)
v_mfma_f32_32x32x16_bf16 v[212:227], v[48:51], v[124:127], v[212:227]
s_waitcnt lgkmcnt(5)
v_mfma_f32_32x32x16_bf16 v[212:227], v[52:55], v[128:131], v[212:227]
s_waitcnt lgkmcnt(4)
v_mfma_f32_32x32x16_bf16 v[228:243], v[56:59], v[112:115], 0
s_waitcnt lgkmcnt(3)
v_mfma_f32_32x32x16_bf16 v[228:243], v[60:63], v[116:119], v[228:243]
s_waitcnt lgkmcnt(2)
v_mfma_f32_32x32x16_bf16 v[228:243], v[64:67], v[120:123], v[228:243]
s_waitcnt lgkmcnt(1)
v_mfma_f32_32x32x16_bf16 v[228:243], v[68:71], v[124:127], v[228:243]
s_waitcnt lgkmcnt(0)
v_mfma_f32_32x32x16_bf16 v[228:243], v[72:75], v[128:131], v[228:243]
ds_write_b128 v85, v[152:155] offset:0
ds_write_b128 v86, v[156:159] offset:0
ds_write_b128 v87, v[160:163] offset:0
ds_write_b128 v85, v[184:187] offset:16384
ds_write_b128 v86, v[188:191] offset:16384
ds_write_b128 v87, v[192:195] offset:16384
v_max3_f32 v72, v196, v197, v198
v_min3_f32 v73, v196, v197, v198
v_max3_f32 v72, v72, v199, v200
v_min3_f32 v73, v73, v199, v200
v_max3_f32 v72, v72, v201, v202
v_min3_f32 v73, v73, v201, v202
v_max3_f32 v72, v72, v203, v204
v_min3_f32 v73, v73, v203, v204
v_max3_f32 v72, v72, v205, v206
v_min3_f32 v73, v73, v205, v206
v_max3_f32 v72, v72, v207, v208
v_min3_f32 v73, v73, v207, v208
v_max3_f32 v72, v72, v209, v210
v_min3_f32 v73, v73, v209, v210
v_max3_f32 v72, v72, v211, v228
v_min3_f32 v73, v73, v211, v228
v_max3_f32 v72, v72, v229, v230
v_min3_f32 v73, v73, v229, v230
v_max_f32 v72, v72, v231
v_min_f32 v73, v73, v231
v_mul_f32 v72, s68, v72
v_mul_f32_e64 v73, s66, v73
v_pk_fma_f32 v[32:33], v[196:197], s[66:67], v[72:73] op_sel_hi:[1,1,0]
v_pk_fma_f32 v[52:53], v[196:197], s[68:69], v[72:73] op_sel:[0,0,1] op_sel_hi:[1,1,1]
v_pk_fma_f32 v[34:35], v[198:199], s[66:67], v[72:73] op_sel_hi:[1,1,0]
v_pk_fma_f32 v[54:55], v[198:199], s[68:69], v[72:73] op_sel:[0,0,1] op_sel_hi:[1,1,1]
v_pk_fma_f32 v[36:37], v[200:201], s[66:67], v[72:73] op_sel_hi:[1,1,0]
v_pk_fma_f32 v[56:57], v[200:201], s[68:69], v[72:73] op_sel:[0,0,1] op_sel_hi:[1,1,1]
v_pk_fma_f32 v[38:39], v[202:203], s[66:67], v[72:73] op_sel_hi:[1,1,0]
v_pk_fma_f32 v[58:59], v[202:203], s[68:69], v[72:73] op_sel:[0,0,1] op_sel_hi:[1,1,1]
v_pk_fma_f32 v[40:41], v[204:205], s[66:67], v[72:73] op_sel_hi:[1,1,0]
v_pk_fma_f32 v[60:61], v[204:205], s[68:69], v[72:73] op_sel:[0,0,1] op_sel_hi:[1,1,1]
v_pk_fma_f32 v[42:43], v[206:207], s[66:67], v[72:73] op_sel_hi:[1,1,0]
v_pk_fma_f32 v[62:63], v[206:207], s[68:69], v[72:73] op_sel:[0,0,1] op_sel_hi:[1,1,1]
v_pk_fma_f32 v[44:45], v[208:209], s[66:67], v[72:73] op_sel_hi:[1,1,0]
v_pk_fma_f32 v[64:65], v[208:209], s[68:69], v[72:73] op_sel:[0,0,1] op_sel_hi:[1,1,1]
v_pk_fma_f32 v[46:47], v[210:211], s[66:67], v[72:73] op_sel_hi:[1,1,0]
v_pk_fma_f32 v[66:67], v[210:211], s[68:69], v[72:73] op_sel:[0,0,1] op_sel_hi:[1,1,1]
v_pk_fma_f32 v[48:49], v[228:229], s[66:67], v[72:73] op_sel_hi:[1,1,0]
v_pk_fma_f32 v[68:69], v[228:229], s[68:69], v[72:73] op_sel:[0,0,1] op_sel_hi:[1,1,1]
v_pk_fma_f32 v[50:51], v[230:231], s[66:67], v[72:73] op_sel_hi:[1,1,0]
v_pk_fma_f32 v[70:71], v[230:231], s[68:69], v[72:73] op_sel:[0,0,1] op_sel_hi:[1,1,1]
v_exp_f32 v32, v32
v_exp_f32 v33, v33
v_exp_f32 v34, v34
v_exp_f32 v35, v35
v_exp_f32 v36, v36
v_exp_f32 v37, v37
v_exp_f32 v38, v38
v_exp_f32 v39, v39
v_exp_f32 v40, v40
v_exp_f32 v41, v41
v_exp_f32 v42, v42
v_exp_f32 v43, v43
v_exp_f32 v44, v44
v_exp_f32 v45, v45
v_exp_f32 v46, v46
v_exp_f32 v47, v47
v_exp_f32 v48, v48
v_exp_f32 v49, v49
v_exp_f32 v50, v50
v_exp_f32 v51, v51
v_exp_f32 v52, v52
v_exp_f32 v53, v53
v_exp_f32 v54, v54
v_exp_f32 v55, v55
v_exp_f32 v56, v56
v_exp_f32 v57, v57
v_exp_f32 v58, v58
v_exp_f32 v59, v59
v_exp_f32 v60, v60
v_exp_f32 v61, v61
v_exp_f32 v62, v62
v_exp_f32 v63, v63
v_exp_f32 v64, v64
v_exp_f32 v65, v65
v_exp_f32 v66, v66
v_exp_f32 v67, v67
v_exp_f32 v68, v68
v_exp_f32 v69, v69
v_exp_f32 v70, v70
v_exp_f32 v71, v71
v_pk_add_f32 v[74:75], v[32:33], v[34:35]
v_pk_add_f32 v[76:77], v[52:53], v[54:55]
v_pk_add_f32 v[74:75], v[74:75], v[36:37]
v_pk_add_f32 v[76:77], v[76:77], v[56:57]
v_pk_add_f32 v[74:75], v[74:75], v[38:39]
v_pk_add_f32 v[76:77], v[76:77], v[58:59]
v_pk_add_f32 v[74:75], v[74:75], v[40:41]
v_pk_add_f32 v[76:77], v[76:77], v[60:61]
v_pk_add_f32 v[74:75], v[74:75], v[42:43]
v_pk_add_f32 v[76:77], v[76:77], v[62:63]
v_pk_add_f32 v[74:75], v[74:75], v[44:45]
v_pk_add_f32 v[76:77], v[76:77], v[64:65]
v_pk_add_f32 v[74:75], v[74:75], v[46:47]
v_pk_add_f32 v[76:77], v[76:77], v[66:67]
v_pk_add_f32 v[74:75], v[74:75], v[48:49]
v_pk_add_f32 v[76:77], v[76:77], v[68:69]
v_pk_add_f32 v[74:75], v[74:75], v[50:51]
v_pk_add_f32 v[76:77], v[76:77], v[70:71]
v_add_f32 v74, v74, v75
v_add_f32 v76, v76, v77
v_rcp_f32 v74, v74
v_rcp_f32 v76, v76
v_pk_mul_f32 v[32:33], v[32:33], v[74:75] op_sel_hi:[1,0]
v_pk_mul_f32 v[52:53], v[52:53], v[76:77] op_sel_hi:[1,0]
v_pk_mul_f32 v[34:35], v[34:35], v[74:75] op_sel_hi:[1,0]
v_pk_mul_f32 v[54:55], v[54:55], v[76:77] op_sel_hi:[1,0]
v_pk_mul_f32 v[36:37], v[36:37], v[74:75] op_sel_hi:[1,0]
v_pk_mul_f32 v[56:57], v[56:57], v[76:77] op_sel_hi:[1,0]
v_pk_mul_f32 v[38:39], v[38:39], v[74:75] op_sel_hi:[1,0]
v_pk_mul_f32 v[58:59], v[58:59], v[76:77] op_sel_hi:[1,0]
v_pk_mul_f32 v[40:41], v[40:41], v[74:75] op_sel_hi:[1,0]
v_pk_mul_f32 v[60:61], v[60:61], v[76:77] op_sel_hi:[1,0]
v_pk_mul_f32 v[42:43], v[42:43], v[74:75] op_sel_hi:[1,0]
v_pk_mul_f32 v[62:63], v[62:63], v[76:77] op_sel_hi:[1,0]
v_pk_mul_f32 v[44:45], v[44:45], v[74:75] op_sel_hi:[1,0]
v_pk_mul_f32 v[64:65], v[64:65], v[76:77] op_sel_hi:[1,0]
v_pk_mul_f32 v[46:47], v[46:47], v[74:75] op_sel_hi:[1,0]
v_pk_mul_f32 v[66:67], v[66:67], v[76:77] op_sel_hi:[1,0]
v_pk_mul_f32 v[48:49], v[48:49], v[74:75] op_sel_hi:[1,0]
v_pk_mul_f32 v[68:69], v[68:69], v[76:77] op_sel_hi:[1,0]
v_pk_mul_f32 v[50:51], v[50:51], v[74:75] op_sel_hi:[1,0]
v_pk_mul_f32 v[70:71], v[70:71], v[76:77] op_sel_hi:[1,0]
v_cvt_pk_bf16_f32 v132, v32, v33
v_cvt_pk_bf16_f32 v133, v34, v35
v_cvt_pk_bf16_f32 v134, v36, v37
v_cvt_pk_bf16_f32 v135, v38, v39
v_cvt_pk_bf16_f32 v136, v40, v41
v_cvt_pk_bf16_f32 v137, v42, v43
v_cvt_pk_bf16_f32 v138, v44, v45
v_cvt_pk_bf16_f32 v139, v46, v47
v_cvt_pk_bf16_f32 v140, v48, v49
v_cvt_pk_bf16_f32 v141, v50, v51
v_cvt_pk_bf16_f32 v142, v52, v53
v_cvt_pk_bf16_f32 v143, v54, v55
v_cvt_pk_bf16_f32 v144, v56, v57
v_cvt_pk_bf16_f32 v145, v58, v59
v_cvt_pk_bf16_f32 v146, v60, v61
v_cvt_pk_bf16_f32 v147, v62, v63
v_cvt_pk_bf16_f32 v148, v64, v65
v_cvt_pk_bf16_f32 v149, v66, v67
v_cvt_pk_bf16_f32 v150, v68, v69
v_cvt_pk_bf16_f32 v151, v70, v71
ds_write_b128 v80, v[132:135] offset:0
ds_write_b128 v81, v[136:139] offset:0
ds_write_b128 v82, v[140:143] offset:0
ds_write_b128 v83, v[144:147] offset:0
ds_write_b128 v84, v[148:151] offset:0
v_max3_f32 v72, v212, v213, v214
v_min3_f32 v73, v212, v213, v214
v_max3_f32 v72, v72, v215, v216
v_min3_f32 v73, v73, v215, v216
v_max3_f32 v72, v72, v217, v218
v_min3_f32 v73, v73, v217, v218
v_max3_f32 v72, v72, v219, v220
v_min3_f32 v73, v73, v219, v220
v_max3_f32 v72, v72, v221, v222
v_min3_f32 v73, v73, v221, v222
v_max3_f32 v72, v72, v223, v224
v_min3_f32 v73, v73, v223, v224
v_max3_f32 v72, v72, v225, v226
v_min3_f32 v73, v73, v225, v226
v_max3_f32 v72, v72, v227, v232
v_min3_f32 v73, v73, v227, v232
v_max3_f32 v72, v72, v233, v234
v_min3_f32 v73, v73, v233, v234
v_max_f32 v72, v72, v235
v_min_f32 v73, v73, v235
v_mul_f32 v72, s68, v72
v_mul_f32 v73, s66, v73
v_pk_fma_f32 v[32:33], v[212:213], s[66:67], v[72:73] op_sel_hi:[1,1,0]
v_pk_fma_f32 v[52:53], v[212:213], s[68:69], v[72:73] op_sel:[0,0,1] op_sel_hi:[1,1,1]
v_pk_fma_f32 v[34:35], v[214:215], s[66:67], v[72:73] op_sel_hi:[1,1,0]
v_pk_fma_f32 v[54:55], v[214:215], s[68:69], v[72:73] op_sel:[0,0,1] op_sel_hi:[1,1,1]
v_pk_fma_f32 v[36:37], v[216:217], s[66:67], v[72:73] op_sel_hi:[1,1,0]
v_pk_fma_f32 v[56:57], v[216:217], s[68:69], v[72:73] op_sel:[0,0,1] op_sel_hi:[1,1,1]
v_pk_fma_f32 v[38:39], v[218:219], s[66:67], v[72:73] op_sel_hi:[1,1,0]
v_pk_fma_f32 v[58:59], v[218:219], s[68:69], v[72:73] op_sel:[0,0,1] op_sel_hi:[1,1,1]
v_pk_fma_f32 v[40:41], v[220:221], s[66:67], v[72:73] op_sel_hi:[1,1,0]
v_pk_fma_f32 v[60:61], v[220:221], s[68:69], v[72:73] op_sel:[0,0,1] op_sel_hi:[1,1,1]
v_pk_fma_f32 v[42:43], v[222:223], s[66:67], v[72:73] op_sel_hi:[1,1,0]
v_pk_fma_f32 v[62:63], v[222:223], s[68:69], v[72:73] op_sel:[0,0,1] op_sel_hi:[1,1,1]
v_pk_fma_f32 v[44:45], v[224:225], s[66:67], v[72:73] op_sel_hi:[1,1,0]
v_pk_fma_f32 v[64:65], v[224:225], s[68:69], v[72:73] op_sel:[0,0,1] op_sel_hi:[1,1,1]
v_pk_fma_f32 v[46:47], v[226:227], s[66:67], v[72:73] op_sel_hi:[1,1,0]
v_pk_fma_f32 v[66:67], v[226:227], s[68:69], v[72:73] op_sel:[0,0,1] op_sel_hi:[1,1,1]
v_pk_fma_f32 v[48:49], v[232:233], s[66:67], v[72:73] op_sel_hi:[1,1,0]
v_pk_fma_f32 v[68:69], v[232:233], s[68:69], v[72:73] op_sel:[0,0,1] op_sel_hi:[1,1,1]
v_pk_fma_f32 v[50:51], v[234:235], s[66:67], v[72:73] op_sel_hi:[1,1,0]
v_pk_fma_f32 v[70:71], v[234:235], s[68:69], v[72:73] op_sel:[0,0,1] op_sel_hi:[1,1,1]
v_exp_f32 v32, v32
v_exp_f32 v33, v33
v_exp_f32 v34, v34
v_exp_f32 v35, v35
v_exp_f32 v36, v36
v_exp_f32 v37, v37
v_exp_f32 v38, v38
v_exp_f32 v39, v39
v_exp_f32 v40, v40
v_exp_f32 v41, v41
v_exp_f32 v42, v42
v_exp_f32 v43, v43
v_exp_f32 v44, v44
v_exp_f32 v45, v45
v_exp_f32 v46, v46
v_exp_f32 v47, v47
v_exp_f32 v48, v48
v_exp_f32 v49, v49
v_exp_f32 v50, v50
v_exp_f32 v51, v51
v_exp_f32 v52, v52
v_exp_f32 v53, v53
v_exp_f32 v54, v54
v_exp_f32 v55, v55
v_exp_f32 v56, v56
v_exp_f32 v57, v57
v_exp_f32 v58, v58
v_exp_f32 v59, v59
v_exp_f32 v60, v60
v_exp_f32 v61, v61
v_exp_f32 v62, v62
v_exp_f32 v63, v63
v_exp_f32 v64, v64
v_exp_f32 v65, v65
v_exp_f32 v66, v66
v_exp_f32 v67, v67
v_exp_f32 v68, v68
v_exp_f32 v69, v69
v_exp_f32 v70, v70
v_exp_f32 v71, v71
v_pk_add_f32 v[74:75], v[32:33], v[34:35]
v_pk_add_f32 v[76:77], v[52:53], v[54:55]
v_pk_add_f32 v[74:75], v[74:75], v[36:37]
v_pk_add_f32 v[76:77], v[76:77], v[56:57]
v_pk_add_f32 v[74:75], v[74:75], v[38:39]
v_pk_add_f32 v[76:77], v[76:77], v[58:59]
v_pk_add_f32 v[74:75], v[74:75], v[40:41]
v_pk_add_f32 v[76:77], v[76:77], v[60:61]
v_pk_add_f32 v[74:75], v[74:75], v[42:43]
v_pk_add_f32 v[76:77], v[76:77], v[62:63]
v_pk_add_f32 v[74:75], v[74:75], v[44:45]
v_pk_add_f32 v[76:77], v[76:77], v[64:65]
v_pk_add_f32 v[74:75], v[74:75], v[46:47]
v_pk_add_f32 v[76:77], v[76:77], v[66:67]
v_pk_add_f32 v[74:75], v[74:75], v[48:49]
v_pk_add_f32 v[76:77], v[76:77], v[68:69]
v_pk_add_f32 v[74:75], v[74:75], v[50:51]
v_pk_add_f32 v[76:77], v[76:77], v[70:71]
v_add_f32 v74, v74, v75
v_add_f32 v76, v76, v77
v_rcp_f32 v74, v74
v_rcp_f32 v76, v76
v_pk_mul_f32 v[32:33], v[32:33], v[74:75] op_sel_hi:[1,0]
v_pk_mul_f32 v[52:53], v[52:53], v[76:77] op_sel_hi:[1,0]
v_pk_mul_f32 v[34:35], v[34:35], v[74:75] op_sel_hi:[1,0]
v_pk_mul_f32 v[54:55], v[54:55], v[76:77] op_sel_hi:[1,0]
v_pk_mul_f32 v[36:37], v[36:37], v[74:75] op_sel_hi:[1,0]
v_pk_mul_f32 v[56:57], v[56:57], v[76:77] op_sel_hi:[1,0]
v_pk_mul_f32 v[38:39], v[38:39], v[74:75] op_sel_hi:[1,0]
v_pk_mul_f32 v[58:59], v[58:59], v[76:77] op_sel_hi:[1,0]
v_pk_mul_f32 v[40:41], v[40:41], v[74:75] op_sel_hi:[1,0]
v_pk_mul_f32 v[60:61], v[60:61], v[76:77] op_sel_hi:[1,0]
v_pk_mul_f32 v[42:43], v[42:43], v[74:75] op_sel_hi:[1,0]
v_pk_mul_f32 v[62:63], v[62:63], v[76:77] op_sel_hi:[1,0]
v_pk_mul_f32 v[44:45], v[44:45], v[74:75] op_sel_hi:[1,0]
v_pk_mul_f32 v[64:65], v[64:65], v[76:77] op_sel_hi:[1,0]
v_pk_mul_f32 v[46:47], v[46:47], v[74:75] op_sel_hi:[1,0]
v_pk_mul_f32 v[66:67], v[66:67], v[76:77] op_sel_hi:[1,0]
v_pk_mul_f32 v[48:49], v[48:49], v[74:75] op_sel_hi:[1,0]
v_pk_mul_f32 v[68:69], v[68:69], v[76:77] op_sel_hi:[1,0]
v_pk_mul_f32 v[50:51], v[50:51], v[74:75] op_sel_hi:[1,0]
v_pk_mul_f32 v[70:71], v[70:71], v[76:77] op_sel_hi:[1,0]
v_cvt_pk_bf16_f32 v164, v32, v33
v_cvt_pk_bf16_f32 v165, v34, v35
v_cvt_pk_bf16_f32 v166, v36, v37
v_cvt_pk_bf16_f32 v167, v38, v39
v_cvt_pk_bf16_f32 v168, v40, v41
v_cvt_pk_bf16_f32 v169, v42, v43
v_cvt_pk_bf16_f32 v170, v44, v45
v_cvt_pk_bf16_f32 v171, v46, v47
v_cvt_pk_bf16_f32 v172, v48, v49
v_cvt_pk_bf16_f32 v173, v50, v51
v_cvt_pk_bf16_f32 v174, v52, v53
v_cvt_pk_bf16_f32 v175, v54, v55
v_cvt_pk_bf16_f32 v176, v56, v57
v_cvt_pk_bf16_f32 v177, v58, v59
v_cvt_pk_bf16_f32 v178, v60, v61
v_cvt_pk_bf16_f32 v179, v62, v63
v_cvt_pk_bf16_f32 v180, v64, v65
v_cvt_pk_bf16_f32 v181, v66, v67
v_cvt_pk_bf16_f32 v182, v68, v69
v_cvt_pk_bf16_f32 v183, v70, v71
ds_write_b128 v80, v[164:167] offset:16384
ds_write_b128 v81, v[168:171] offset:16384
ds_write_b128 v82, v[172:175] offset:16384
ds_write_b128 v83, v[176:179] offset:16384
ds_write_b128 v84, v[180:183] offset:16384
v_bfe_u32 v28, v1, 2, 2
v_lshrrev_b32 v29, 1, v28
v_lshlrev_b32 v29, 2, v29
v_bfe_u32 v30, v1, 4, 1
v_lshl_add_u32 v29, v30, 1, v29
v_bfe_u32 v30, v1, 1, 1
v_and_b32 v31, 1, v28
v_xor_b32 v30, v30, v31
v_add_u32 v29, v29, v30
v_lshlrev_b32 v88, 4, v29
v_and_b32_e64 v30, 1, v1
v_lshl_add_u32 v88, v30, 3, v88
v_lshrrev_b32_e64 v30, 5, v1
v_lshl_add_u32 v30, v30, 3, v28
v_lshl_add_u32 v88, v30, 7, v88
s_lshl_b32 s60, s56, 14
s_add_u32 s60, s60, 81920
v_add_u32 v88, s60, v88
v_xor_b32_e64 v89, 32, v88
v_add_u32 v89, 512, v89
v_xor_b32 v90, 64, v88
v_xor_b32 v91, 64, v89
s_waitcnt lgkmcnt(0)
s_barrier
ds_read_b64_tr_b16 v[112:113], v88 offset:0
ds_read_b64_tr_b16 v[114:115], v89 offset:0
ds_read_b64_tr_b16 v[116:117], v90 offset:0
ds_read_b64_tr_b16 v[118:119], v91 offset:0
ds_read_b64_tr_b16 v[120:121], v88 offset:2048
ds_read_b64_tr_b16 v[122:123], v89 offset:2048
ds_read_b64_tr_b16 v[124:125], v90 offset:2048
ds_read_b64_tr_b16 v[126:127], v91 offset:2048
ds_read_b64_tr_b16 v[128:129], v88 offset:4096
ds_read_b64_tr_b16 v[130:131], v89 offset:4096
ds_read_b64_tr_b16 v[132:133], v90 offset:4096
ds_read_b64_tr_b16 v[134:135], v91 offset:4096
s_waitcnt lgkmcnt(8)
v_mfma_f32_32x32x16_bf16 v[176:191], v[116:119], v[112:115], 0
v_mfma_f32_32x32x16_bf16 v[192:207], v[116:119], v[116:119], 0
ds_read_b64_tr_b16 v[136:137], v88 offset:6144
ds_read_b64_tr_b16 v[138:139], v89 offset:6144
ds_read_b64_tr_b16 v[140:141], v90 offset:6144
ds_read_b64_tr_b16 v[142:143], v91 offset:6144
s_waitcnt lgkmcnt(8)
v_mfma_f32_32x32x16_bf16 v[176:191], v[124:127], v[120:123], v[176:191]
v_mfma_f32_32x32x16_bf16 v[192:207], v[124:127], v[124:127], v[192:207]
ds_read_b64_tr_b16 v[144:145], v88 offset:8192
ds_read_b64_tr_b16 v[146:147], v89 offset:8192
ds_read_b64_tr_b16 v[148:149], v90 offset:8192
ds_read_b64_tr_b16 v[150:151], v91 offset:8192
s_waitcnt lgkmcnt(8)
v_mfma_f32_32x32x16_bf16 v[176:191], v[132:135], v[128:131], v[176:191]
v_mfma_f32_32x32x16_bf16 v[192:207], v[132:135], v[132:135], v[192:207]
ds_read_b64_tr_b16 v[152:153], v88 offset:10240
ds_read_b64_tr_b16 v[154:155], v89 offset:10240
ds_read_b64_tr_b16 v[156:157], v90 offset:10240
ds_read_b64_tr_b16 v[158:159], v91 offset:10240
s_waitcnt lgkmcnt(8)
v_mfma_f32_32x32x16_bf16 v[176:191], v[140:143], v[136:139], v[176:191]
v_mfma_f32_32x32x16_bf16 v[192:207], v[140:143], v[140:143], v[192:207]
ds_read_b64_tr_b16 v[160:161], v88 offset:12288
ds_read_b64_tr_b16 v[162:163], v89 offset:12288
ds_read_b64_tr_b16 v[164:165], v90 offset:12288
ds_read_b64_tr_b16 v[166:167], v91 offset:12288
s_waitcnt lgkmcnt(8)
v_mfma_f32_32x32x16_bf16 v[176:191], v[148:151], v[144:147], v[176:191]
v_mfma_f32_32x32x16_bf16 v[192:207], v[148:151], v[148:151], v[192:207]
ds_read_b64_tr_b16 v[168:169], v88 offset:14336
ds_read_b64_tr_b16 v[170:171], v89 offset:14336
ds_read_b64_tr_b16 v[172:173], v90 offset:14336
ds_read_b64_tr_b16 v[174:175], v91 offset:14336
s_waitcnt lgkmcnt(8)
v_mfma_f32_32x32x16_bf16 v[176:191], v[156:159], v[152:155], v[176:191]
v_mfma_f32_32x32x16_bf16 v[192:207], v[156:159], v[156:159], v[192:207]
s_waitcnt lgkmcnt(4)
v_mfma_f32_32x32x16_bf16 v[176:191], v[164:167], v[160:163], v[176:191]
v_mfma_f32_32x32x16_bf16 v[192:207], v[164:167], v[164:167], v[192:207]
s_waitcnt lgkmcnt(0)
v_mfma_f32_32x32x16_bf16 v[176:191], v[172:175], v[168:171], v[176:191]
v_mfma_f32_32x32x16_bf16 v[192:207], v[172:175], v[172:175], v[192:207]
v_and_b32 v28, 31, v1
v_lshrrev_b32 v29, 5, v1
v_lshlrev_b32 v80, 4, v1
v_lshlrev_b32 v30, 4, v28
v_lshl_add_u32 v30, v29, 7, v30
v_add_u32 v30, 3072, v30
v_mov_b32 v31, 0x7f000000
v_cmp_gt_u32 vcc, 8, v28
s_nop 1
v_cndmask_b32 v81, v31, v30, vcc
s_lshl_b32 s60, s58, 4
s_add_u32 s60, s60, s57
s_lshl_b32 s60, s60, 2
s_add_u32 s60, s60, s56
s_mul_i32 s60, s60, 3840
s_add_u32 s60, s60, 262144
buffer_store_dwordx4 v[180:183], v80, s[44:47], s60 offen offset:0 sc1
buffer_store_dwordx4 v[196:199], v81, s[44:47], s60 offen offset:0 sc1
buffer_store_dwordx4 v[184:187], v80, s[44:47], s60 offen offset:1024 sc1
buffer_store_dwordx4 v[200:203], v81, s[44:47], s60 offen offset:256 sc1
buffer_store_dwordx4 v[188:191], v80, s[44:47], s60 offen offset:2048 sc1
buffer_store_dwordx4 v[204:207], v81, s[44:47], s60 offen offset:512 sc1
s_waitcnt vmcnt(13)
s_barrier
s_add_u32 s60, s56, 0
s_and_b32 s60, s60, 3
s_mul_i32 s60, s60, 3072
v_add_u32 v232, s60, v4
v_add_u32 v233, 49152, v232
s_add_u32 s60, s56, 1
s_and_b32 s60, s60, 3
s_mul_i32 s60, s60, 3072
v_add_u32_e64 v234, s60, v4
v_add_u32 v235, 49152, v234
s_add_u32 s60, s56, 2
s_and_b32 s60, s60, 3
s_mul_i32 s60, s60, 3072
v_add_u32_e64 v236, s60, v4
v_add_u32 v237, 49152, v236
s_add_u32 s60, s56, 3
s_and_b32 s60, s60, 3
s_mul_i32 s60, s60, 3072
v_add_u32_e64 v238, s60, v4
v_add_u32 v239, 49152, v238
ds_read_b64_tr_b16 a[192:193], v232 offset:40960
ds_read_b64_tr_b16 a[194:195], v232 offset:41728
ds_read_b64_tr_b16 a[196:197], v232 offset:41024
ds_read_b64_tr_b16 a[198:199], v232 offset:41792
ds_read_b64_tr_b16 a[200:201], v232 offset:41088
ds_read_b64_tr_b16 a[202:203], v232 offset:41856
ds_read_b64_tr_b16 a[204:205], v234 offset:40960
ds_read_b64_tr_b16 a[206:207], v234 offset:41728
s_waitcnt lgkmcnt(6)
v_mfma_f32_32x32x16_bf16 v[32:47], a[192:195], a[0:3], 0
ds_read_b64_tr_b16 a[160:161], v234 offset:41024
ds_read_b64_tr_b16 a[162:163], v234 offset:41792
v_mfma_f32_16x16x32_bf16 v[208:211], a[192:195], v[246:249], 0
s_add_u32 m0, s75, 20480
s_nop 0
buffer_load_dwordx4 v11, s[36:39], s77 offen lds
s_waitcnt lgkmcnt(6)
v_mfma_f32_32x32x16_bf16 v[48:63], a[196:199], a[0:3], 0
ds_read_b64_tr_b16 a[164:165], v234 offset:41088
ds_read_b64_tr_b16 a[166:167], v234 offset:41856
v_mfma_f32_16x16x32_bf16 v[212:215], a[196:199], v[246:249], 0
s_waitcnt lgkmcnt(6)
v_mfma_f32_32x32x16_bf16 v[64:79], a[200:203], a[0:3], 0
ds_read_b64_tr_b16 a[168:169], v236 offset:40960
ds_read_b64_tr_b16 a[170:171], v236 offset:41728
v_mfma_f32_16x16x32_bf16 v[216:219], a[200:203], v[246:249], 0
s_add_u32 m0, s75, 21504
s_nop 0
buffer_load_dwordx4 v12, s[36:39], s77 offen lds
s_mov_b32 s62, 16383
s_waitcnt vmcnt(8)
L_wp_A:
v_cmp_eq_u32 vcc, s84, v251
s_and_b32 s60, vcc_lo, s62
s_cmp_eq_u32 s60, s62
s_cbranch_scc1 L_wpok_A
s_sub_u32 s7, s7, 1
s_cbranch_scc1 L_wpok_A
s_sleep 2
buffer_load_dword v251, v245, s[44:47], s93 offen sc1
s_waitcnt vmcnt(0)
s_branch L_wp_A
L_wpok_A:
v_lshlrev_b32 v240, 4, v1
v_add_u32 v241, 4096, v240
s_waitcnt lgkmcnt(6)
v_mfma_f32_32x32x16_bf16 v[32:47], a[204:207], a[4:7], v[32:47]
ds_read_b64_tr_b16 a[172:173], v236 offset:41024
ds_read_b64_tr_b16 a[174:175], v236 offset:41792
s_waitcnt lgkmcnt(6)
v_mfma_f32_32x32x16_bf16 v[48:63], a[160:163], a[4:7], v[48:63]
ds_read_b64_tr_b16 a[176:177], v236 offset:41088
ds_read_b64_tr_b16 a[178:179], v236 offset:41856
s_add_u32 m0, s75, 22528
s_nop 0
buffer_load_dwordx4 v13, s[36:39], s77 offen lds
s_add_u32 s77, s77, 221184
s_sub_u32 s87, s77, 2211840
s_cmp_ge_u32 s77, 2211840
s_cselect_b32 s77, s87, s77
s_waitcnt lgkmcnt(6)
v_mfma_f32_32x32x16_bf16 v[64:79], a[164:167], a[4:7], v[64:79]
ds_read_b64_tr_b16 a[180:181], v238 offset:40960
ds_read_b64_tr_b16 a[182:183], v238 offset:41728
s_waitcnt lgkmcnt(6)
v_mfma_f32_32x32x16_bf16 v[32:47], a[168:171], a[8:11], v[32:47]
ds_read_b64_tr_b16 a[184:185], v238 offset:41024
ds_read_b64_tr_b16 a[186:187], v238 offset:41792
s_waitcnt lgkmcnt(6)
v_mfma_f32_32x32x16_bf16 v[48:63], a[172:175], a[8:11], v[48:63]
ds_read_b64_tr_b16 a[188:189], v238 offset:41088
ds_read_b64_tr_b16 a[190:191], v238 offset:41856
s_waitcnt lgkmcnt(6)
v_mfma_f32_32x32x16_bf16 v[64:79], a[176:179], a[8:11], v[64:79]
s_waitcnt vmcnt(3)
s_waitcnt lgkmcnt(4)
v_mfma_f32_32x32x16_bf16 v[32:47], a[180:183], a[12:15], v[32:47]
s_waitcnt lgkmcnt(0)
s_barrier
ds_read_b64_tr_b16 a[192:193], v233 offset:12288
ds_read_b64_tr_b16 a[194:195], v233 offset:13056
ds_read_b64_tr_b16 a[196:197], v233 offset:12352
ds_read_b64_tr_b16 a[198:199], v233 offset:13120
v_mfma_f32_32x32x16_bf16 v[48:63], a[184:187], a[12:15], v[48:63]
ds_read_b64_tr_b16 a[200:201], v233 offset:12416
ds_read_b64_tr_b16 a[202:203], v233 offset:13184
s_add_u32 m0, s75, 40960
s_nop 0
buffer_load_dwordx4 v11, s[36:39], s77 offen lds
s_cmp_lg_u32 s56, 0
s_cbranch_scc1 L_f1_skip
v_mov_b32 v96, s84
s_lshl_b32 s60, s58, 4
s_add_u32 s60, s60, s57
s_lshl_b32 s60, s60, 7
s_add_u32 s60, s60, 2228224
s_mov_b64 exec, 1
buffer_store_dword v96, off, s[44:47], s60 sc1
s_mov_b64 exec, -1
L_f1_skip:
v_mfma_f32_32x32x16_bf16 v[64:79], a[188:191], a[12:15], v[64:79]
ds_read_b64_tr_b16 a[204:205], v235 offset:12288
ds_read_b64_tr_b16 a[206:207], v235 offset:13056
s_waitcnt lgkmcnt(6)
v_mfma_f32_32x32x16_bf16 v[32:47], a[192:195], a[16:19], v[32:47]
ds_read_b64_tr_b16 a[160:161], v235 offset:12352
ds_read_b64_tr_b16 a[162:163], v235 offset:13120
v_mfma_f32_16x16x32_bf16 v[208:211], a[192:195], v[246:249], v[208:211]
s_add_u32 m0, s75, 41984
s_nop 0
buffer_load_dwordx4 v12, s[36:39], s77 offen lds
buffer_load_dwordx4 a[0:3], v240, s[44:47], s90 offen offset:0 sc1
s_waitcnt lgkmcnt(6)
v_mfma_f32_32x32x16_bf16 v[48:63], a[196:199], a[16:19], v[48:63]
ds_read_b64_tr_b16 a[164:165], v235 offset:12416
ds_read_b64_tr_b16 a[166:167], v235 offset:13184
v_mfma_f32_16x16x32_bf16 v[212:215], a[196:199], v[246:249], v[212:215]
s_waitcnt lgkmcnt(6)
v_mfma_f32_32x32x16_bf16 v[64:79], a[200:203], a[16:19], v[64:79]
ds_read_b64_tr_b16 a[168:169], v237 offset:12288
ds_read_b64_tr_b16 a[170:171], v237 offset:13056
v_mfma_f32_16x16x32_bf16 v[216:219], a[200:203], v[246:249], v[216:219]
s_add_u32 m0, s75, 43008
s_nop 0
buffer_load_dwordx4 v13, s[36:39], s77 offen lds
s_add_u32 s77, s77, 221184
s_sub_u32 s87, s77, 2211840
s_cmp_ge_u32 s77, 2211840
s_cselect_b32 s77, s87, s77
s_waitcnt lgkmcnt(6)
v_mfma_f32_32x32x16_bf16 v[32:47], a[204:207], a[20:23], v[32:47]
ds_read_b64_tr_b16 a[172:173], v237 offset:12352
ds_read_b64_tr_b16 a[174:175], v237 offset:13120
buffer_load_dwordx4 a[4:7], v240, s[44:47], s90 offen offset:1024 sc1
s_waitcnt lgkmcnt(6)
v_mfma_f32_32x32x16_bf16 v[48:63], a[160:163], a[20:23], v[48:63]
ds_read_b64_tr_b16 a[176:177], v237 offset:12416
ds_read_b64_tr_b16 a[178:179], v237 offset:13184
s_waitcnt lgkmcnt(6)
v_mfma_f32_32x32x16_bf16 v[64:79], a[164:167], a[20:23], v[64:79]
ds_read_b64_tr_b16 a[180:181], v239 offset:12288
ds_read_b64_tr_b16 a[182:183], v239 offset:13056
s_waitcnt lgkmcnt(6)
v_mfma_f32_32x32x16_bf16 v[32:47], a[168:171], a[24:27], v[32:47]
ds_read_b64_tr_b16 a[184:185], v239 offset:12352
ds_read_b64_tr_b16 a[186:187], v239 offset:13120
s_cmp_ge_u32 s79, 592
s_cbranch_scc1 L_tj1_skip_A
s_lshr_b32 s60, s79, 3
s_and_b32 s61, s79, 7
s_mov_b32 s63, 819200
s_cmp_lt_u32 s60, 54
s_cselect_b32 s40, s14, s10
s_cselect_b32 s41, s15, s11
s_cselect_b32 s42, 2211840, s63
s_cselect_b32 s62, 0, 54
s_and_b32 s41, s41, 0xffff
s_mov_b32 s43, 0x20000
s_sub_u32 s60, s60, s62
s_mul_i32 s60, s60, 40960
s_mul_i32 s61, s61, 160
s_add_u32 s60, s60, s61
v_add_u32_e64 v28, 0, v1
v_mul_u32_u24 v29, 6554, v28
v_lshrrev_b32 v29, 16, v29
v_mul_u32_u24 v30, 10, v29
v_sub_u32_e64 v30, v28, v30
v_mul_u32_u24 v29, 1280, v29
v_lshl_add_u32 v29, v30, 4, v29
s_add_u32 m0, s74, 81920
s_nop 0
buffer_load_dwordx4 v29, s[40:43], s60 offen lds
v_add_u32 v28, 64, v1
v_mul_u32_u24 v29, 6554, v28
v_lshrrev_b32 v29, 16, v29
v_mul_u32_u24 v30, 10, v29
v_sub_u32_e64 v30, v28, v30
v_mul_u32_u24 v29, 1280, v29
v_lshl_add_u32 v29, v30, 4, v29
s_add_u32 m0, s74, 82944
s_nop 0
buffer_load_dwordx4 v29, s[40:43], s60 offen lds
v_add_u32 v28, 128, v1
v_mul_u32_u24 v29, 6554, v28
v_lshrrev_b32 v29, 16, v29
v_mul_u32_u24 v30, 10, v29
v_sub_u32 v30, v28, v30
v_mul_u32_u24 v29, 1280, v29
v_lshl_add_u32 v29, v30, 4, v29
s_add_u32 m0, s74, 83968
s_nop 0
buffer_load_dwordx4 v29, s[40:43], s60 offen lds
v_add_u32 v28, 192, v1
v_mul_u32_u24 v29, 6554, v28
v_lshrrev_b32 v29, 16, v29
v_mul_u32_u24 v30, 10, v29
v_sub_u32 v30, v28, v30
v_mul_u32_u24 v29, 1280, v29
v_lshl_add_u32 v29, v30, 4, v29
s_add_u32 m0, s74, 84992
s_nop 0
buffer_load_dwordx4 v29, s[40:43], s60 offen lds
v_add_u32 v28, 256, v1
v_mul_u32_u24 v29, 6554, v28
v_lshrrev_b32 v29, 16, v29
v_mul_u32_u24 v30, 10, v29
v_sub_u32 v30, v28, v30
v_mul_u32_u24 v29, 1280, v29
v_lshl_add_u32 v29, v30, 4, v29
s_add_u32 m0, s74, 86016
s_nop 0
buffer_load_dwordx4 v29, s[40:43], s60 offen lds
L_tj1_skip_A:
buffer_load_dwordx4 a[8:11], v240, s[44:47], s90 offen offset:2048 sc1
s_waitcnt lgkmcnt(6)
v_mfma_f32_32x32x16_bf16 v[48:63], a[172:175], a[24:27], v[48:63]
ds_read_b64_tr_b16 a[188:189], v239 offset:12416
ds_read_b64_tr_b16 a[190:191], v239 offset:13184
s_waitcnt lgkmcnt(6)
v_mfma_f32_32x32x16_bf16 v[64:79], a[176:179], a[24:27], v[64:79]
s_waitcnt lgkmcnt(4)
v_mfma_f32_32x32x16_bf16 v[32:47], a[180:183], a[28:31], v[32:47]
s_waitcnt lgkmcnt(0)
s_barrier
ds_read_b64_tr_b16 a[192:193], v232 offset:0
ds_read_b64_tr_b16 a[194:195], v232 offset:768
ds_read_b64_tr_b16 a[196:197], v232 offset:64
ds_read_b64_tr_b16 a[198:199], v232 offset:832
buffer_load_dwordx4 a[12:15], v240, s[44:47], s90 offen offset:3072 sc1
v_mfma_f32_32x32x16_bf16 v[48:63], a[184:187], a[28:31], v[48:63]
ds_read_b64_tr_b16 a[200:201], v232 offset:128
ds_read_b64_tr_b16 a[202:203], v232 offset:896
s_add_u32 m0, s75, 61440
s_nop 0
buffer_load_dwordx4 v11, s[36:39], s77 offen lds
v_mfma_f32_32x32x16_bf16 v[64:79], a[188:191], a[28:31], v[64:79]
ds_read_b64_tr_b16 a[204:205], v234 offset:0
ds_read_b64_tr_b16 a[206:207], v234 offset:768
s_waitcnt lgkmcnt(6)
v_mfma_f32_32x32x16_bf16 v[32:47], a[192:195], a[32:35], v[32:47]
ds_read_b64_tr_b16 a[160:161], v234 offset:64
ds_read_b64_tr_b16 a[162:163], v234 offset:832
v_mfma_f32_16x16x32_bf16 v[208:211], a[192:195], v[246:249], v[208:211]
s_add_u32 m0, s75, 62464
s_nop 0
buffer_load_dwordx4 v12, s[36:39], s77 offen lds
buffer_load_dwordx4 a[16:19], v241, s[44:47], s90 offen sc1
s_add_u32 s90, s90, 5120
s_waitcnt lgkmcnt(6)
v_mfma_f32_32x32x16_bf16 v[48:63], a[196:199], a[32:35], v[48:63]
ds_read_b64_tr_b16 a[164:165], v234 offset:128
ds_read_b64_tr_b16 a[166:167], v234 offset:896
v_mfma_f32_16x16x32_bf16 v[212:215], a[196:199], v[246:249], v[212:215]
s_waitcnt lgkmcnt(6)
v_mfma_f32_32x32x16_bf16 v[64:79], a[200:203], a[32:35], v[64:79]
ds_read_b64_tr_b16 a[168:169], v236 offset:0
ds_read_b64_tr_b16 a[170:171], v236 offset:768
v_mfma_f32_16x16x32_bf16 v[216:219], a[200:203], v[246:249], v[216:219]
s_add_u32 m0, s75, 63488
s_nop 0
buffer_load_dwordx4 v13, s[36:39], s77 offen lds
s_add_u32 s77, s77, 221184
s_sub_u32 s87, s77, 2211840
s_cmp_ge_u32 s77, 2211840
s_cselect_b32 s77, s87, s77
s_waitcnt lgkmcnt(6)
v_mfma_f32_32x32x16_bf16 v[32:47], a[204:207], a[36:39], v[32:47]
ds_read_b64_tr_b16 a[172:173], v236 offset:64
ds_read_b64_tr_b16 a[174:175], v236 offset:832
buffer_load_dwordx4 a[20:23], v240, s[44:47], s90 offen offset:0 sc1
s_waitcnt lgkmcnt(6)
v_mfma_f32_32x32x16_bf16 v[48:63], a[160:163], a[36:39], v[48:63]
ds_read_b64_tr_b16 a[176:177], v236 offset:128
ds_read_b64_tr_b16 a[178:179], v236 offset:896
s_waitcnt lgkmcnt(6)
v_mfma_f32_32x32x16_bf16 v[64:79], a[164:167], a[36:39], v[64:79]
ds_read_b64_tr_b16 a[180:181], v238 offset:0
ds_read_b64_tr_b16 a[182:183], v238 offset:768
s_waitcnt lgkmcnt(6)
v_mfma_f32_32x32x16_bf16 v[32:47], a[168:171], a[40:43], v[32:47]
ds_read_b64_tr_b16 a[184:185], v238 offset:64
ds_read_b64_tr_b16 a[186:187], v238 offset:832
buffer_load_dwordx4 a[24:27], v240, s[44:47], s90 offen offset:1024 sc1
s_waitcnt lgkmcnt(6)
v_mfma_f32_32x32x16_bf16 v[48:63], a[172:175], a[40:43], v[48:63]
ds_read_b64_tr_b16 a[188:189], v238 offset:128
ds_read_b64_tr_b16 a[190:191], v238 offset:896
s_waitcnt lgkmcnt(6)
v_mfma_f32_32x32x16_bf16 v[64:79], a[176:179], a[40:43], v[64:79]
s_waitcnt lgkmcnt(4)
v_mfma_f32_32x32x16_bf16 v[32:47], a[180:183], a[44:47], v[32:47]
s_waitcnt lgkmcnt(0)
s_waitcnt vmcnt(13)
s_barrier
ds_read_b64_tr_b16 a[192:193], v232 offset:20480
ds_read_b64_tr_b16 a[194:195], v232 offset:21248
ds_read_b64_tr_b16 a[196:197], v232 offset:20544
ds_read_b64_tr_b16 a[198:199], v232 offset:21312
buffer_load_dwordx4 a[28:31], v240, s[44:47], s90 offen offset:2048 sc1
v_mfma_f32_32x32x16_bf16 v[48:63], a[184:187], a[44:47], v[48:63]
ds_read_b64_tr_b16 a[200:201], v232 offset:20608
ds_read_b64_tr_b16 a[202:203], v232 offset:21376
s_add_u32 m0, s75, 0
s_nop 0
buffer_load_dwordx4 v11, s[36:39], s77 offen lds
v_mfma_f32_32x32x16_bf16 v[64:79], a[188:191], a[44:47], v[64:79]
ds_read_b64_tr_b16 a[204:205], v234 offset:20480
ds_read_b64_tr_b16 a[206:207], v234 offset:21248
s_waitcnt lgkmcnt(6)
v_mfma_f32_32x32x16_bf16 v[32:47], a[192:195], a[48:51], v[32:47]
ds_read_b64_tr_b16 a[160:161], v234 offset:20544
ds_read_b64_tr_b16 a[162:163], v234 offset:21312
v_mfma_f32_16x16x32_bf16 v[208:211], a[192:195], v[246:249], v[208:211]
s_add_u32 m0, s75, 1024
s_nop 0
buffer_load_dwordx4 v12, s[36:39], s77 offen lds
buffer_load_dwordx4 a[32:35], v240, s[44:47], s90 offen offset:3072 sc1
s_waitcnt lgkmcnt(6)
v_mfma_f32_32x32x16_bf16 v[48:63], a[196:199], a[48:51], v[48:63]
ds_read_b64_tr_b16 a[164:165], v234 offset:20608
ds_read_b64_tr_b16 a[166:167], v234 offset:21376
v_mfma_f32_16x16x32_bf16 v[212:215], a[196:199], v[246:249], v[212:215]
s_waitcnt lgkmcnt(6)
v_mfma_f32_32x32x16_bf16 v[64:79], a[200:203], a[48:51], v[64:79]
ds_read_b64_tr_b16 a[168:169], v236 offset:20480
ds_read_b64_tr_b16 a[170:171], v236 offset:21248
v_mfma_f32_16x16x32_bf16 v[216:219], a[200:203], v[246:249], v[216:219]
s_add_u32 m0, s75, 2048
s_nop 0
buffer_load_dwordx4 v13, s[36:39], s77 offen lds
s_add_u32 s77, s77, 221184
s_sub_u32 s87, s77, 2211840
s_cmp_ge_u32 s77, 2211840
s_cselect_b32 s77, s87, s77
s_waitcnt lgkmcnt(6)
v_mfma_f32_32x32x16_bf16 v[32:47], a[204:207], a[52:55], v[32:47]
ds_read_b64_tr_b16 a[172:173], v236 offset:20544
ds_read_b64_tr_b16 a[174:175], v236 offset:21312
buffer_load_dwordx4 a[36:39], v241, s[44:47], s90 offen sc1
s_add_u32 s90, s90, 5120
s_waitcnt lgkmcnt(6)
v_mfma_f32_32x32x16_bf16 v[48:63], a[160:163], a[52:55], v[48:63]
ds_read_b64_tr_b16 a[176:177], v236 offset:20608
ds_read_b64_tr_b16 a[178:179], v236 offset:21376
s_waitcnt lgkmcnt(6)
v_mfma_f32_32x32x16_bf16 v[64:79], a[164:167], a[52:55], v[64:79]
ds_read_b64_tr_b16 a[180:181], v238 offset:20480
ds_read_b64_tr_b16 a[182:183], v238 offset:21248
s_waitcnt lgkmcnt(6)
v_mfma_f32_32x32x16_bf16 v[32:47], a[168:171], a[56:59], v[32:47]
ds_read_b64_tr_b16 a[184:185], v238 offset:20544
ds_read_b64_tr_b16 a[186:187], v238 offset:21312
buffer_load_dwordx4 a[40:43], v240, s[44:47], s90 offen offset:0 sc1
s_waitcnt lgkmcnt(6)
v_mfma_f32_32x32x16_bf16 v[48:63], a[172:175], a[56:59], v[48:63]
ds_read_b64_tr_b16 a[188:189], v238 offset:20608
ds_read_b64_tr_b16 a[190:191], v238 offset:21376
s_waitcnt lgkmcnt(6)
v_mfma_f32_32x32x16_bf16 v[64:79], a[176:179], a[56:59], v[64:79]
s_waitcnt lgkmcnt(4)
v_mfma_f32_32x32x16_bf16 v[32:47], a[180:183], a[60:63], v[32:47]
s_waitcnt lgkmcnt(0)
s_waitcnt vmcnt(16)
s_barrier
ds_read_b64_tr_b16 a[192:193], v232 offset:40960
ds_read_b64_tr_b16 a[194:195], v232 offset:41728
ds_read_b64_tr_b16 a[196:197], v232 offset:41024
ds_read_b64_tr_b16 a[198:199], v232 offset:41792
buffer_load_dwordx4 a[44:47], v240, s[44:47], s90 offen offset:1024 sc1
v_mfma_f32_32x32x16_bf16 v[48:63], a[184:187], a[60:63], v[48:63]
ds_read_b64_tr_b16 a[200:201], v232 offset:41088
ds_read_b64_tr_b16 a[202:203], v232 offset:41856
s_add_u32 m0, s75, 20480
s_nop 0
buffer_load_dwordx4 v11, s[36:39], s77 offen lds
s_cmp_ge_u32 s79, 592
s_cbranch_scc1 L_tj2_skip_A
s_waitcnt vmcnt(17)
v_lshrrev_b32_e64 v28, 4, v1
v_bfe_u32 v29, v1, 2, 2
v_lshl_add_u32 v28, v28, 3, v29
v_mul_u32_u24 v28, 160, v28
v_and_b32 v29, 3, v1
v_mul_u32_u24 v29, 40, v29
v_add_u32_e64 v28, v28, v29
s_add_u32 s61, s74, 81920
v_add_u32_e64 v28, s61, v28
ds_read_b64_tr_b16 a[208:209], v28 offset:0
ds_read_b64_tr_b16 a[210:211], v28 offset:640
ds_read_b64_tr_b16 a[212:213], v28 offset:8
ds_read_b64_tr_b16 a[214:215], v28 offset:648
ds_read_b64_tr_b16 a[216:217], v28 offset:16
ds_read_b64_tr_b16 a[218:219], v28 offset:656
ds_read_b64_tr_b16 a[220:221], v28 offset:24
ds_read_b64_tr_b16 a[222:223], v28 offset:664
ds_read_b64_tr_b16 a[224:225], v28 offset:32
ds_read_b64_tr_b16 a[226:227], v28 offset:672
s_lshr_b32 s60, s79, 3
s_and_b32 s61, s79, 7
s_mul_i32 s61, s61, 74
s_add_u32 s60, s60, s61
s_mul_i32 s60, s60, 5120
s_add_u32 s60, s60, 12582912
v_lshlrev_b32 v29, 4, v1
v_add_u32 v30, 4096, v29
s_waitcnt lgkmcnt(0)
buffer_store_dwordx4 a[208:211], v29, s[44:47], s60 offen offset:0 sc1
buffer_store_dwordx4 a[212:215], v29, s[44:47], s60 offen offset:1024 sc1
buffer_store_dwordx4 a[216:219], v29, s[44:47], s60 offen offset:2048 sc1
buffer_store_dwordx4 a[220:223], v29, s[44:47], s60 offen offset:3072 sc1
buffer_store_dwordx4 a[224:227], v30, s[44:47], s60 offen sc1
L_tj2_skip_A:
v_mfma_f32_32x32x16_bf16 v[64:79], a[188:191], a[60:63], v[64:79]
ds_read_b64_tr_b16 a[204:205], v234 offset:40960
ds_read_b64_tr_b16 a[206:207], v234 offset:41728
s_waitcnt lgkmcnt(6)
v_mfma_f32_32x32x16_bf16 v[32:47], a[192:195], a[64:67], v[32:47]
ds_read_b64_tr_b16 a[160:161], v234 offset:41024
ds_read_b64_tr_b16 a[162:163], v234 offset:41792
v_mfma_f32_16x16x32_bf16 v[208:211], a[192:195], v[246:249], v[208:211]
s_add_u32 m0, s75, 21504
s_nop 0
buffer_load_dwordx4 v12, s[36:39], s77 offen lds
buffer_load_dwordx4 a[48:51], v240, s[44:47], s90 offen offset:2048 sc1
s_waitcnt lgkmcnt(6)
v_mfma_f32_32x32x16_bf16 v[48:63], a[196:199], a[64:67], v[48:63]
ds_read_b64_tr_b16 a[164:165], v234 offset:41088
ds_read_b64_tr_b16 a[166:167], v234 offset:41856
v_mfma_f32_16x16x32_bf16 v[212:215], a[196:199], v[246:249], v[212:215]
s_waitcnt lgkmcnt(6)
v_mfma_f32_32x32x16_bf16 v[64:79], a[200:203], a[64:67], v[64:79]
ds_read_b64_tr_b16 a[168:169], v236 offset:40960
ds_read_b64_tr_b16 a[170:171], v236 offset:41728
v_mfma_f32_16x16x32_bf16 v[216:219], a[200:203], v[246:249], v[216:219]
s_add_u32 m0, s75, 22528
s_nop 0
buffer_load_dwordx4 v13, s[36:39], s77 offen lds
s_add_u32 s77, s77, 221184
s_sub_u32 s87, s77, 2211840
s_cmp_ge_u32 s77, 2211840
s_cselect_b32 s77, s87, s77
s_waitcnt lgkmcnt(6)
v_mfma_f32_32x32x16_bf16 v[32:47], a[204:207], a[68:71], v[32:47]
ds_read_b64_tr_b16 a[172:173], v236 offset:41024
ds_read_b64_tr_b16 a[174:175], v236 offset:41792
buffer_load_dwordx4 a[52:55], v240, s[44:47], s90 offen offset:3072 sc1
s_waitcnt lgkmcnt(6)
v_mfma_f32_32x32x16_bf16 v[48:63], a[160:163], a[68:71], v[48:63]
ds_read_b64_tr_b16 a[176:177], v236 offset:41088
ds_read_b64_tr_b16 a[178:179], v236 offset:41856
s_waitcnt lgkmcnt(6)
v_mfma_f32_32x32x16_bf16 v[64:79], a[164:167], a[68:71], v[64:79]
ds_read_b64_tr_b16 a[180:181], v238 offset:40960
ds_read_b64_tr_b16 a[182:183], v238 offset:41728
s_waitcnt lgkmcnt(6)
v_mfma_f32_32x32x16_bf16 v[32:47], a[168:171], a[72:75], v[32:47]
ds_read_b64_tr_b16 a[184:185], v238 offset:41024
ds_read_b64_tr_b16 a[186:187], v238 offset:41792
buffer_load_dwordx4 a[56:59], v241, s[44:47], s90 offen sc1
s_add_u32 s90, s90, 5120
s_waitcnt lgkmcnt(6)
v_mfma_f32_32x32x16_bf16 v[48:63], a[172:175], a[72:75], v[48:63]
ds_read_b64_tr_b16 a[188:189], v238 offset:41088
ds_read_b64_tr_b16 a[190:191], v238 offset:41856
s_waitcnt lgkmcnt(6)
v_mfma_f32_32x32x16_bf16 v[64:79], a[176:179], a[72:75], v[64:79]
s_waitcnt lgkmcnt(4)
v_mfma_f32_32x32x16_bf16 v[32:47], a[180:183], a[76:79], v[32:47]
s_waitcnt lgkmcnt(0)
s_waitcnt vmcnt(16)
s_barrier
ds_read_b64_tr_b16 a[192:193], v233 offset:12288
ds_read_b64_tr_b16 a[194:195], v233 offset:13056
ds_read_b64_tr_b16 a[196:197], v233 offset:12352
ds_read_b64_tr_b16 a[198:199], v233 offset:13120
buffer_load_dwordx4 a[60:63], v240, s[44:47], s90 offen offset:0 sc1
v_mfma_f32_32x32x16_bf16 v[48:63], a[184:187], a[76:79], v[48:63]
ds_read_b64_tr_b16 a[200:201], v233 offset:12416
ds_read_b64_tr_b16 a[202:203], v233 offset:13184
s_add_u32 m0, s75, 40960
s_nop 0
buffer_load_dwordx4 v11, s[36:39], s77 offen lds
v_mfma_f32_32x32x16_bf16 v[64:79], a[188:191], a[76:79], v[64:79]
ds_read_b64_tr_b16 a[204:205], v235 offset:12288
ds_read_b64_tr_b16 a[206:207], v235 offset:13056
s_waitcnt lgkmcnt(6)
v_mfma_f32_32x32x16_bf16 v[32:47], a[192:195], a[80:83], v[32:47]
ds_read_b64_tr_b16 a[160:161], v235 offset:12352
ds_read_b64_tr_b16 a[162:163], v235 offset:13120
v_mfma_f32_16x16x32_bf16 v[208:211], a[192:195], v[246:249], v[208:211]
s_add_u32 m0, s75, 41984
s_nop 0
buffer_load_dwordx4 v12, s[36:39], s77 offen lds
buffer_load_dwordx4 a[64:67], v240, s[44:47], s90 offen offset:1024 sc1
s_waitcnt lgkmcnt(6)
v_mfma_f32_32x32x16_bf16 v[48:63], a[196:199], a[80:83], v[48:63]
ds_read_b64_tr_b16 a[164:165], v235 offset:12416
ds_read_b64_tr_b16 a[166:167], v235 offset:13184
v_mfma_f32_16x16x32_bf16 v[212:215], a[196:199], v[246:249], v[212:215]
s_waitcnt lgkmcnt(6)
v_mfma_f32_32x32x16_bf16 v[64:79], a[200:203], a[80:83], v[64:79]
ds_read_b64_tr_b16 a[168:169], v237 offset:12288
ds_read_b64_tr_b16 a[170:171], v237 offset:13056
v_mfma_f32_16x16x32_bf16 v[216:219], a[200:203], v[246:249], v[216:219]
s_add_u32 m0, s75, 43008
s_nop 0
buffer_load_dwordx4 v13, s[36:39], s77 offen lds
s_add_u32 s77, s77, 221184
s_sub_u32 s87, s77, 2211840
s_cmp_ge_u32 s77, 2211840
s_cselect_b32 s77, s87, s77
s_waitcnt lgkmcnt(6)
v_mfma_f32_32x32x16_bf16 v[32:47], a[204:207], a[84:87], v[32:47]
ds_read_b64_tr_b16 a[172:173], v237 offset:12352
ds_read_b64_tr_b16 a[174:175], v237 offset:13120
buffer_load_dwordx4 a[68:71], v240, s[44:47], s90 offen offset:2048 sc1
s_waitcnt lgkmcnt(6)
v_mfma_f32_32x32x16_bf16 v[48:63], a[160:163], a[84:87], v[48:63]
ds_read_b64_tr_b16 a[176:177], v237 offset:12416
ds_read_b64_tr_b16 a[178:179], v237 offset:13184
s_waitcnt lgkmcnt(6)
v_mfma_f32_32x32x16_bf16 v[64:79], a[164:167], a[84:87], v[64:79]
ds_read_b64_tr_b16 a[180:181], v239 offset:12288
ds_read_b64_tr_b16 a[182:183], v239 offset:13056
s_waitcnt lgkmcnt(6)
v_mfma_f32_32x32x16_bf16 v[32:47], a[168:171], a[88:91], v[32:47]
ds_read_b64_tr_b16 a[184:185], v239 offset:12352
ds_read_b64_tr_b16 a[186:187], v239 offset:13120
buffer_load_dwordx4 a[72:75], v240, s[44:47], s90 offen offset:3072 sc1
s_waitcnt lgkmcnt(6)
v_mfma_f32_32x32x16_bf16 v[48:63], a[172:175], a[88:91], v[48:63]
ds_read_b64_tr_b16 a[188:189], v239 offset:12416
ds_read_b64_tr_b16 a[190:191], v239 offset:13184
s_waitcnt lgkmcnt(6)
v_mfma_f32_32x32x16_bf16 v[64:79], a[176:179], a[88:91], v[64:79]
s_waitcnt lgkmcnt(4)
v_mfma_f32_32x32x16_bf16 v[32:47], a[180:183], a[92:95], v[32:47]
s_waitcnt lgkmcnt(0)
s_waitcnt vmcnt(16)
s_barrier
ds_read_b64_tr_b16 a[192:193], v232 offset:0
ds_read_b64_tr_b16 a[194:195], v232 offset:768
ds_read_b64_tr_b16 a[196:197], v232 offset:64
ds_read_b64_tr_b16 a[198:199], v232 offset:832
buffer_load_dwordx4 a[76:79], v241, s[44:47], s90 offen sc1
s_add_u32 s90, s90, 5120
v_mfma_f32_32x32x16_bf16 v[48:63], a[184:187], a[92:95], v[48:63]
ds_read_b64_tr_b16 a[200:201], v232 offset:128
ds_read_b64_tr_b16 a[202:203], v232 offset:896
s_add_u32 m0, s75, 61440
s_nop 0
buffer_load_dwordx4 v11, s[36:39], s77 offen lds
v_mfma_f32_32x32x16_bf16 v[64:79], a[188:191], a[92:95], v[64:79]
ds_read_b64_tr_b16 a[204:205], v234 offset:0
ds_read_b64_tr_b16 a[206:207], v234 offset:768
s_waitcnt lgkmcnt(6)
v_mfma_f32_32x32x16_bf16 v[32:47], a[192:195], a[96:99], v[32:47]
ds_read_b64_tr_b16 a[160:161], v234 offset:64
ds_read_b64_tr_b16 a[162:163], v234 offset:832
v_mfma_f32_16x16x32_bf16 v[208:211], a[192:195], v[246:249], v[208:211]
s_add_u32 m0, s75, 62464
s_nop 0
buffer_load_dwordx4 v12, s[36:39], s77 offen lds
buffer_load_dwordx4 a[80:83], v240, s[44:47], s90 offen offset:0 sc1
s_waitcnt lgkmcnt(6)
v_mfma_f32_32x32x16_bf16 v[48:63], a[196:199], a[96:99], v[48:63]
ds_read_b64_tr_b16 a[164:165], v234 offset:128
ds_read_b64_tr_b16 a[166:167], v234 offset:896
v_mfma_f32_16x16x32_bf16 v[212:215], a[196:199], v[246:249], v[212:215]
s_waitcnt lgkmcnt(6)
v_mfma_f32_32x32x16_bf16 v[64:79], a[200:203], a[96:99], v[64:79]
ds_read_b64_tr_b16 a[168:169], v236 offset:0
ds_read_b64_tr_b16 a[170:171], v236 offset:768
v_mfma_f32_16x16x32_bf16 v[216:219], a[200:203], v[246:249], v[216:219]
s_add_u32 m0, s75, 63488
s_nop 0
buffer_load_dwordx4 v13, s[36:39], s77 offen lds
s_add_u32 s77, s77, 221184
s_sub_u32 s87, s77, 2211840
s_cmp_ge_u32 s77, 2211840
s_cselect_b32 s77, s87, s77
s_waitcnt lgkmcnt(6)
v_mfma_f32_32x32x16_bf16 v[32:47], a[204:207], a[100:103], v[32:47]
ds_read_b64_tr_b16 a[172:173], v236 offset:64
ds_read_b64_tr_b16 a[174:175], v236 offset:832
buffer_load_dwordx4 a[84:87], v240, s[44:47], s90 offen offset:1024 sc1
s_waitcnt lgkmcnt(6)
v_mfma_f32_32x32x16_bf16 v[48:63], a[160:163], a[100:103], v[48:63]
ds_read_b64_tr_b16 a[176:177], v236 offset:128
ds_read_b64_tr_b16 a[178:179], v236 offset:896
s_waitcnt lgkmcnt(6)
v_mfma_f32_32x32x16_bf16 v[64:79], a[164:167], a[100:103], v[64:79]
ds_read_b64_tr_b16 a[180:181], v238 offset:0
ds_read_b64_tr_b16 a[182:183], v238 offset:768
s_waitcnt lgkmcnt(6)
v_mfma_f32_32x32x16_bf16 v[32:47], a[168:171], a[104:107], v[32:47]
ds_read_b64_tr_b16 a[184:185], v238 offset:64
ds_read_b64_tr_b16 a[186:187], v238 offset:832
buffer_load_dwordx4 a[88:91], v240, s[44:47], s90 offen offset:2048 sc1
s_waitcnt lgkmcnt(6)
v_mfma_f32_32x32x16_bf16 v[48:63], a[172:175], a[104:107], v[48:63]
ds_read_b64_tr_b16 a[188:189], v238 offset:128
ds_read_b64_tr_b16 a[190:191], v238 offset:896
s_waitcnt lgkmcnt(6)
v_mfma_f32_32x32x16_bf16 v[64:79], a[176:179], a[104:107], v[64:79]
s_waitcnt lgkmcnt(4)
v_mfma_f32_32x32x16_bf16 v[32:47], a[180:183], a[108:111], v[32:47]
s_waitcnt lgkmcnt(0)
s_waitcnt vmcnt(16)
s_barrier
ds_read_b64_tr_b16 a[192:193], v232 offset:20480
ds_read_b64_tr_b16 a[194:195], v232 offset:21248
ds_read_b64_tr_b16 a[196:197], v232 offset:20544
ds_read_b64_tr_b16 a[198:199], v232 offset:21312
buffer_load_dwordx4 a[92:95], v240, s[44:47], s90 offen offset:3072 sc1
v_mfma_f32_32x32x16_bf16 v[48:63], a[184:187], a[108:111], v[48:63]
ds_read_b64_tr_b16 a[200:201], v232 offset:20608
ds_read_b64_tr_b16 a[202:203], v232 offset:21376
v_mfma_f32_32x32x16_bf16 v[64:79], a[188:191], a[108:111], v[64:79]
ds_read_b64_tr_b16 a[204:205], v234 offset:20480
ds_read_b64_tr_b16 a[206:207], v234 offset:21248
s_waitcnt lgkmcnt(6)
v_mfma_f32_32x32x16_bf16 v[32:47], a[192:195], a[112:115], v[32:47]
ds_read_b64_tr_b16 a[160:161], v234 offset:20544
ds_read_b64_tr_b16 a[162:163], v234 offset:21312
v_mfma_f32_16x16x32_bf16 v[208:211], a[192:195], v[246:249], v[208:211]
buffer_load_dwordx4 a[96:99], v241, s[44:47], s90 offen sc1
s_add_u32 s90, s90, 5120
s_waitcnt lgkmcnt(6)
v_mfma_f32_32x32x16_bf16 v[48:63], a[196:199], a[112:115], v[48:63]
ds_read_b64_tr_b16 a[164:165], v234 offset:20608
ds_read_b64_tr_b16 a[166:167], v234 offset:21376
v_mfma_f32_16x16x32_bf16 v[212:215], a[196:199], v[246:249], v[212:215]
s_waitcnt lgkmcnt(6)
v_mfma_f32_32x32x16_bf16 v[64:79], a[200:203], a[112:115], v[64:79]
ds_read_b64_tr_b16 a[168:169], v236 offset:20480
ds_read_b64_tr_b16 a[170:171], v236 offset:21248
v_mfma_f32_16x16x32_bf16 v[216:219], a[200:203], v[246:249], v[216:219]
s_waitcnt lgkmcnt(6)
v_mfma_f32_32x32x16_bf16 v[32:47], a[204:207], a[116:119], v[32:47]
ds_read_b64_tr_b16 a[172:173], v236 offset:20544
ds_read_b64_tr_b16 a[174:175], v236 offset:21312
buffer_load_dwordx4 a[100:103], v240, s[44:47], s90 offen offset:0 sc1
s_waitcnt lgkmcnt(6)
v_mfma_f32_32x32x16_bf16 v[48:63], a[160:163], a[116:119], v[48:63]
ds_read_b64_tr_b16 a[176:177], v236 offset:20608
ds_read_b64_tr_b16 a[178:179], v236 offset:21376
s_waitcnt lgkmcnt(6)
v_mfma_f32_32x32x16_bf16 v[64:79], a[164:167], a[116:119], v[64:79]
ds_read_b64_tr_b16 a[180:181], v238 offset:20480
ds_read_b64_tr_b16 a[182:183], v238 offset:21248
s_waitcnt lgkmcnt(6)
v_mfma_f32_32x32x16_bf16 v[32:47], a[168:171], a[120:123], v[32:47]
ds_read_b64_tr_b16 a[184:185], v238 offset:20544
ds_read_b64_tr_b16 a[186:187], v238 offset:21312
s_cmp_ge_u32 s79, 592
s_cbranch_scc1 L_tjf_A
v_mov_b32 v250, s84
s_lshl_b32 s60, s79, 7
s_add_u32 s60, s60, 16252928
s_mov_b64 exec, 1
buffer_store_dword v250, off, s[44:47], s60 sc1
s_mov_b64 exec, -1
L_tjf_A:
buffer_load_dwordx4 a[104:107], v240, s[44:47], s90 offen offset:1024 sc1
s_waitcnt lgkmcnt(6)
v_mfma_f32_32x32x16_bf16 v[48:63], a[172:175], a[120:123], v[48:63]
ds_read_b64_tr_b16 a[188:189], v238 offset:20608
ds_read_b64_tr_b16 a[190:191], v238 offset:21376
s_waitcnt lgkmcnt(6)
v_mfma_f32_32x32x16_bf16 v[64:79], a[176:179], a[120:123], v[64:79]
s_waitcnt lgkmcnt(4)
v_mfma_f32_32x32x16_bf16 v[32:47], a[180:183], a[124:127], v[32:47]
s_waitcnt lgkmcnt(0)
s_waitcnt vmcnt(13)
s_barrier
ds_read_b64_tr_b16 a[192:193], v232 offset:40960
ds_read_b64_tr_b16 a[194:195], v232 offset:41728
ds_read_b64_tr_b16 a[196:197], v232 offset:41024
ds_read_b64_tr_b16 a[198:199], v232 offset:41792
buffer_load_dwordx4 a[108:111], v240, s[44:47], s90 offen offset:2048 sc1
v_mfma_f32_32x32x16_bf16 v[48:63], a[184:187], a[124:127], v[48:63]
ds_read_b64_tr_b16 a[200:201], v232 offset:41088
ds_read_b64_tr_b16 a[202:203], v232 offset:41856
v_mfma_f32_32x32x16_bf16 v[64:79], a[188:191], a[124:127], v[64:79]
ds_read_b64_tr_b16 a[204:205], v234 offset:40960
ds_read_b64_tr_b16 a[206:207], v234 offset:41728
s_waitcnt lgkmcnt(6)
v_mfma_f32_32x32x16_bf16 v[32:47], a[192:195], a[128:131], v[32:47]
ds_read_b64_tr_b16 a[160:161], v234 offset:41024
ds_read_b64_tr_b16 a[162:163], v234 offset:41792
v_mfma_f32_16x16x32_bf16 v[208:211], a[192:195], v[246:249], v[208:211]
buffer_load_dwordx4 a[112:115], v240, s[44:47], s90 offen offset:3072 sc1
s_waitcnt lgkmcnt(6)
v_mfma_f32_32x32x16_bf16 v[48:63], a[196:199], a[128:131], v[48:63]
ds_read_b64_tr_b16 a[164:165], v234 offset:41088
ds_read_b64_tr_b16 a[166:167], v234 offset:41856
v_mfma_f32_16x16x32_bf16 v[212:215], a[196:199], v[246:249], v[212:215]
s_waitcnt lgkmcnt(6)
v_mfma_f32_32x32x16_bf16 v[64:79], a[200:203], a[128:131], v[64:79]
ds_read_b64_tr_b16 a[168:169], v236 offset:40960
ds_read_b64_tr_b16 a[170:171], v236 offset:41728
v_mfma_f32_16x16x32_bf16 v[216:219], a[200:203], v[246:249], v[216:219]
s_waitcnt lgkmcnt(6)
v_mfma_f32_32x32x16_bf16 v[32:47], a[204:207], a[132:135], v[32:47]
ds_read_b64_tr_b16 a[172:173], v236 offset:41024
ds_read_b64_tr_b16 a[174:175], v236 offset:41792
buffer_load_dwordx4 a[116:119], v241, s[44:47], s90 offen sc1
s_add_u32 s90, s90, 5120
s_waitcnt lgkmcnt(6)
v_mfma_f32_32x32x16_bf16 v[48:63], a[160:163], a[132:135], v[48:63]
ds_read_b64_tr_b16 a[176:177], v236 offset:41088
ds_read_b64_tr_b16 a[178:179], v236 offset:41856
s_waitcnt lgkmcnt(6)
v_mfma_f32_32x32x16_bf16 v[64:79], a[164:167], a[132:135], v[64:79]
ds_read_b64_tr_b16 a[180:181], v238 offset:40960
ds_read_b64_tr_b16 a[182:183], v238 offset:41728
s_waitcnt lgkmcnt(6)
v_mfma_f32_32x32x16_bf16 v[32:47], a[168:171], a[136:139], v[32:47]
ds_read_b64_tr_b16 a[184:185], v238 offset:41024
ds_read_b64_tr_b16 a[186:187], v238 offset:41792
buffer_load_dwordx4 a[120:123], v240, s[44:47], s90 offen offset:0 sc1
s_waitcnt lgkmcnt(6)
v_mfma_f32_32x32x16_bf16 v[48:63], a[172:175], a[136:139], v[48:63]
ds_read_b64_tr_b16 a[188:189], v238 offset:41088
ds_read_b64_tr_b16 a[190:191], v238 offset:41856
s_waitcnt lgkmcnt(6)
v_mfma_f32_32x32x16_bf16 v[64:79], a[176:179], a[136:139], v[64:79]
s_waitcnt lgkmcnt(4)
v_mfma_f32_32x32x16_bf16 v[32:47], a[180:183], a[140:143], v[32:47]
s_waitcnt lgkmcnt(0)
s_waitcnt vmcnt(10)
s_barrier
ds_read_b64_tr_b16 a[192:193], v233 offset:12288
ds_read_b64_tr_b16 a[194:195], v233 offset:13056
ds_read_b64_tr_b16 a[196:197], v233 offset:12352
ds_read_b64_tr_b16 a[198:199], v233 offset:13120
buffer_load_dwordx4 a[124:127], v240, s[44:47], s90 offen offset:1024 sc1
v_mfma_f32_32x32x16_bf16 v[48:63], a[184:187], a[140:143], v[48:63]
ds_read_b64_tr_b16 a[200:201], v233 offset:12416
ds_read_b64_tr_b16 a[202:203], v233 offset:13184
v_mfma_f32_32x32x16_bf16 v[64:79], a[188:191], a[140:143], v[64:79]
ds_read_b64_tr_b16 a[204:205], v235 offset:12288
ds_read_b64_tr_b16 a[206:207], v235 offset:13056
s_waitcnt lgkmcnt(6)
v_mfma_f32_32x32x16_bf16 v[32:47], a[192:195], a[144:147], v[32:47]
ds_read_b64_tr_b16 a[160:161], v235 offset:12352
ds_read_b64_tr_b16 a[162:163], v235 offset:13120
v_mfma_f32_16x16x32_bf16 v[208:211], a[192:195], v[246:249], v[208:211]
buffer_load_dwordx4 a[128:131], v240, s[44:47], s90 offen offset:2048 sc1
s_waitcnt lgkmcnt(6)
v_mfma_f32_32x32x16_bf16 v[48:63], a[196:199], a[144:147], v[48:63]
ds_read_b64_tr_b16 a[164:165], v235 offset:12416
ds_read_b64_tr_b16 a[166:167], v235 offset:13184
v_mfma_f32_16x16x32_bf16 v[212:215], a[196:199], v[246:249], v[212:215]
s_waitcnt lgkmcnt(6)
v_mfma_f32_32x32x16_bf16 v[64:79], a[200:203], a[144:147], v[64:79]
ds_read_b64_tr_b16 a[168:169], v237 offset:12288
ds_read_b64_tr_b16 a[170:171], v237 offset:13056
v_mfma_f32_16x16x32_bf16 v[216:219], a[200:203], v[246:249], v[216:219]
s_waitcnt lgkmcnt(6)
v_mfma_f32_32x32x16_bf16 v[32:47], a[204:207], a[148:151], v[32:47]
ds_read_b64_tr_b16 a[172:173], v237 offset:12352
ds_read_b64_tr_b16 a[174:175], v237 offset:13120
buffer_load_dwordx4 a[132:135], v240, s[44:47], s90 offen offset:3072 sc1
s_waitcnt lgkmcnt(6)
v_mfma_f32_32x32x16_bf16 v[48:63], a[160:163], a[148:151], v[48:63]
ds_read_b64_tr_b16 a[176:177], v237 offset:12416
ds_read_b64_tr_b16 a[178:179], v237 offset:13184
s_waitcnt lgkmcnt(6)
v_mfma_f32_32x32x16_bf16 v[64:79], a[164:167], a[148:151], v[64:79]
ds_read_b64_tr_b16 a[180:181], v239 offset:12288
ds_read_b64_tr_b16 a[182:183], v239 offset:13056
s_waitcnt lgkmcnt(6)
v_mfma_f32_32x32x16_bf16 v[32:47], a[168:171], a[152:155], v[32:47]
ds_read_b64_tr_b16 a[184:185], v239 offset:12352
ds_read_b64_tr_b16 a[186:187], v239 offset:13120
buffer_load_dwordx4 a[136:139], v241, s[44:47], s90 offen sc1
s_add_u32 s90, s90, 5120
s_waitcnt lgkmcnt(6)
v_mfma_f32_32x32x16_bf16 v[48:63], a[172:175], a[152:155], v[48:63]
ds_read_b64_tr_b16 a[188:189], v239 offset:12416
ds_read_b64_tr_b16 a[190:191], v239 offset:13184
s_waitcnt lgkmcnt(6)
v_mfma_f32_32x32x16_bf16 v[64:79], a[176:179], a[152:155], v[64:79]
s_waitcnt lgkmcnt(4)
v_mfma_f32_32x32x16_bf16 v[32:47], a[180:183], a[156:159], v[32:47]
buffer_load_dwordx4 a[140:143], v240, s[44:47], s90 offen offset:0 sc1
s_waitcnt lgkmcnt(2)
v_mfma_f32_32x32x16_bf16 v[48:63], a[184:187], a[156:159], v[48:63]
s_waitcnt lgkmcnt(0)
v_mfma_f32_32x32x16_bf16 v[64:79], a[188:191], a[156:159], v[64:79]
buffer_load_dwordx4 a[144:147], v240, s[44:47], s90 offen offset:1024 sc1
buffer_load_dwordx4 a[148:151], v240, s[44:47], s90 offen offset:2048 sc1
buffer_load_dwordx4 a[152:155], v240, s[44:47], s90 offen offset:3072 sc1
buffer_load_dwordx4 a[156:159], v241, s[44:47], s90 offen sc1
s_add_u32 s90, s90, 5120
v_and_b32 v164, 15, v1
v_lshlrev_b32 v164, 6, v164
v_lshrrev_b32_e64 v165, 4, v1
v_lshl_add_u32 v164, v165, 4, v164
s_lshl_b32 s60, s56, 10
s_add_u32 s60, s60, 159744
v_add_u32 v164, s60, v164
s_mov_b32 exec_lo, 0x00030003
s_mov_b32 exec_hi, 0x00030003
ds_write_b128 v164, v[208:211] offset:0
ds_write_b128 v164, v[212:215] offset:128
ds_write_b128 v164, v[216:219] offset:256
s_mov_b64 exec, -1
v_lshlrev_b32 v164, 4, v1
v_add_u32 v164, 159744, v164
s_waitcnt lgkmcnt(0)
s_barrier
s_cmp_lg_u32 s56, 0
s_cbranch_scc1 L_csr_A_3
ds_read_b128 v[166:169], v164 offset:0
ds_read_b128 v[170:173], v164 offset:1024
ds_read_b128 v[174:177], v164 offset:2048
ds_read_b128 v[178:181], v164 offset:3072
s_waitcnt lgkmcnt(0)
v_pk_add_f32 v[166:167], v[166:167], v[170:171]
v_pk_add_f32 v[168:169], v[168:169], v[172:173]
v_pk_add_f32 v[174:175], v[174:175], v[178:179]
v_pk_add_f32 v[176:177], v[176:177], v[180:181]
v_pk_add_f32 v[166:167], v[166:167], v[174:175]
v_pk_add_f32 v[168:169], v[168:169], v[176:177]
ds_write_b128 v164, v[166:169]
s_waitcnt lgkmcnt(0)
L_csr_A_3:
s_barrier
v_lshlrev_b32 v240, 4, v1
v_add_u32 v241, 4096, v240
v_add_u32 v252, 1024, v240
v_add_u32 v253, 2048, v240
v_add_u32 v254, 3072, v240
v_lshrrev_b32 v28, 5, v1
v_lshlrev_b32 v28, 4, v28
v_add_u32 v28, 159744, v28
ds_read_b128 v[164:167], v28 offset:0
ds_read_b128 v[168:171], v28 offset:32
ds_read_b128 v[172:175], v28 offset:64
ds_read_b128 v[176:179], v28 offset:96
ds_read_b128 v[180:183], v28 offset:128
ds_read_b128 v[184:187], v28 offset:160
ds_read_b128 v[188:191], v28 offset:192
ds_read_b128 v[192:195], v28 offset:224
s_waitcnt lgkmcnt(4)
v_pk_mul_f32 v[164:165], v[164:165], v[20:21] op_sel:[0,1] op_sel_hi:[1,1]
v_pk_mul_f32 v[166:167], v[166:167], v[20:21] op_sel:[0,1] op_sel_hi:[1,1]
v_pk_mul_f32 v[168:169], v[168:169], v[20:21] op_sel:[0,1] op_sel_hi:[1,1]
v_pk_mul_f32 v[170:171], v[170:171], v[20:21] op_sel:[0,1] op_sel_hi:[1,1]
v_pk_mul_f32 v[172:173], v[172:173], v[20:21] op_sel:[0,1] op_sel_hi:[1,1]
s_add_u32 m0, s94, 0
s_nop 0
buffer_load_dwordx4 v240, s[44:47], s90 offen sc1 lds
v_pk_mul_f32 v[174:175], v[174:175], v[20:21] op_sel:[0,1] op_sel_hi:[1,1]
v_pk_mul_f32 v[176:177], v[176:177], v[20:21] op_sel:[0,1] op_sel_hi:[1,1]
v_pk_mul_f32 v[178:179], v[178:179], v[20:21] op_sel:[0,1] op_sel_hi:[1,1]
v_pk_fma_f32 v[32:33], v[32:33], v[20:21], v[164:165] op_sel_hi:[1,0,1]
v_pk_fma_f32 v[34:35], v[34:35], v[20:21], v[166:167] op_sel_hi:[1,0,1]
v_pk_fma_f32 v[36:37], v[36:37], v[20:21], v[168:169] op_sel_hi:[1,0,1]
v_pk_fma_f32 v[38:39], v[38:39], v[20:21], v[170:171] op_sel_hi:[1,0,1]
v_pk_fma_f32 v[40:41], v[40:41], v[20:21], v[172:173] op_sel_hi:[1,0,1]
s_add_u32 m0, s94, 1024
s_nop 0
buffer_load_dwordx4 v252, s[44:47], s90 offen sc1 lds
v_pk_fma_f32 v[42:43], v[42:43], v[20:21], v[174:175] op_sel_hi:[1,0,1]
v_pk_fma_f32 v[44:45], v[44:45], v[20:21], v[176:177] op_sel_hi:[1,0,1]
v_pk_fma_f32 v[46:47], v[46:47], v[20:21], v[178:179] op_sel_hi:[1,0,1]
ds_read_b128 v[164:167], v28 offset:256
ds_read_b128 v[168:171], v28 offset:288
ds_read_b128 v[172:175], v28 offset:320
ds_read_b128 v[176:179], v28 offset:352
s_waitcnt lgkmcnt(4)
v_pk_mul_f32 v[180:181], v[180:181], v[20:21] op_sel:[0,1] op_sel_hi:[1,1]
v_pk_mul_f32 v[182:183], v[182:183], v[20:21] op_sel:[0,1] op_sel_hi:[1,1]
v_pk_mul_f32 v[184:185], v[184:185], v[20:21] op_sel:[0,1] op_sel_hi:[1,1]
v_pk_mul_f32 v[186:187], v[186:187], v[20:21] op_sel:[0,1] op_sel_hi:[1,1]
v_pk_mul_f32 v[188:189], v[188:189], v[20:21] op_sel:[0,1] op_sel_hi:[1,1]
s_add_u32 m0, s94, 2048
s_nop 0
buffer_load_dwordx4 v253, s[44:47], s90 offen sc1 lds
v_pk_mul_f32 v[190:191], v[190:191], v[20:21] op_sel:[0,1] op_sel_hi:[1,1]
v_pk_mul_f32 v[192:193], v[192:193], v[20:21] op_sel:[0,1] op_sel_hi:[1,1]
v_pk_mul_f32 v[194:195], v[194:195], v[20:21] op_sel:[0,1] op_sel_hi:[1,1]
v_pk_fma_f32 v[48:49], v[48:49], v[20:21], v[180:181] op_sel_hi:[1,0,1]
v_pk_fma_f32 v[50:51], v[50:51], v[20:21], v[182:183] op_sel_hi:[1,0,1]
v_pk_fma_f32 v[52:53], v[52:53], v[20:21], v[184:185] op_sel_hi:[1,0,1]
v_pk_fma_f32 v[54:55], v[54:55], v[20:21], v[186:187] op_sel_hi:[1,0,1]
v_pk_fma_f32 v[56:57], v[56:57], v[20:21], v[188:189] op_sel_hi:[1,0,1]
s_add_u32 m0, s94, 3072
s_nop 0
buffer_load_dwordx4 v254, s[44:47], s90 offen sc1 lds
v_pk_fma_f32 v[58:59], v[58:59], v[20:21], v[190:191] op_sel_hi:[1,0,1]
v_pk_fma_f32 v[60:61], v[60:61], v[20:21], v[192:193] op_sel_hi:[1,0,1]
v_pk_fma_f32 v[62:63], v[62:63], v[20:21], v[194:195] op_sel_hi:[1,0,1]
s_waitcnt lgkmcnt(0)
v_pk_mul_f32 v[164:165], v[164:165], v[20:21] op_sel:[0,1] op_sel_hi:[1,1]
v_pk_mul_f32 v[166:167], v[166:167], v[20:21] op_sel:[0,1] op_sel_hi:[1,1]
v_pk_mul_f32 v[168:169], v[168:169], v[20:21] op_sel:[0,1] op_sel_hi:[1,1]
v_pk_mul_f32 v[170:171], v[170:171], v[20:21] op_sel:[0,1] op_sel_hi:[1,1]
v_pk_mul_f32 v[172:173], v[172:173], v[20:21] op_sel:[0,1] op_sel_hi:[1,1]
s_add_u32 m0, s94, 4096
s_nop 0
buffer_load_dwordx4 v241, s[44:47], s90 offen sc1 lds
s_add_u32 s90, s90, 5120
v_pk_mul_f32 v[174:175], v[174:175], v[20:21] op_sel:[0,1] op_sel_hi:[1,1]
v_pk_mul_f32 v[176:177], v[176:177], v[20:21] op_sel:[0,1] op_sel_hi:[1,1]
v_pk_mul_f32 v[178:179], v[178:179], v[20:21] op_sel:[0,1] op_sel_hi:[1,1]
v_pk_fma_f32 v[64:65], v[64:65], v[20:21], v[164:165] op_sel_hi:[1,0,1]
v_pk_fma_f32 v[66:67], v[66:67], v[20:21], v[166:167] op_sel_hi:[1,0,1]
v_pk_fma_f32 v[68:69], v[68:69], v[20:21], v[168:169] op_sel_hi:[1,0,1]
v_pk_fma_f32 v[70:71], v[70:71], v[20:21], v[170:171] op_sel_hi:[1,0,1]
v_pk_fma_f32 v[72:73], v[72:73], v[20:21], v[172:173] op_sel_hi:[1,0,1]
s_add_u32 m0, s94, 5120
s_nop 0
buffer_load_dwordx4 v240, s[44:47], s90 offen sc1 lds
v_pk_fma_f32 v[74:75], v[74:75], v[20:21], v[174:175] op_sel_hi:[1,0,1]
v_pk_fma_f32 v[76:77], v[76:77], v[20:21], v[176:177] op_sel_hi:[1,0,1]
v_pk_fma_f32 v[78:79], v[78:79], v[20:21], v[178:179] op_sel_hi:[1,0,1]
v_and_b32_e64 v28, 15, v1
v_bfe_u32 v29, v1, 4, 1
v_lshrrev_b32 v30, 5, v1
v_lshlrev_b32 v96, 4, v28
v_lshl_add_u32 v96, v29, 10, v96
v_lshl_add_u32 v96, v30, 9, v96
s_add_u32 m0, s94, 6144
s_nop 0
buffer_load_dwordx4 v252, s[44:47], s90 offen sc1 lds
s_and_b32 s60, s56, 1
s_lshl_b32 s60, s60, 11
v_add_u32 v96, s60, v96
s_add_u32 s62, s82, 0
s_lshl_b32 s62, s62, 12
s_add_u32 s62, s62, s78
s_cmp_eq_u32 s58, 7
s_cselect_b32 s62, 0x7f000000, s62
s_add_u32 m0, s94, 7168
s_nop 0
buffer_load_dwordx4 v253, s[44:47], s90 offen sc1 lds
v_pk_mul_f32 v[112:113], v[32:33], s[68:69]
v_pk_mul_f32 v[114:115], v[34:35], s[68:69]
v_pk_mul_f32 v[116:117], v[36:37], s[68:69]
v_pk_mul_f32 v[118:119], v[38:39], s[68:69]
v_pk_mul_f32 v[120:121], v[40:41], s[68:69]
v_pk_mul_f32 v[122:123], v[42:43], s[68:69]
v_pk_mul_f32 v[124:125], v[44:45], s[68:69]
v_pk_mul_f32 v[126:127], v[46:47], s[68:69]
s_add_u32 m0, s94, 8192
s_nop 0
buffer_load_dwordx4 v254, s[44:47], s90 offen sc1 lds
v_exp_f32 v112, v112
v_exp_f32 v113, v113
v_exp_f32 v114, v114
v_exp_f32 v115, v115
v_exp_f32 v116, v116
v_exp_f32 v117, v117
v_exp_f32 v118, v118
v_exp_f32 v119, v119
s_add_u32 m0, s94, 9216
s_nop 0
buffer_load_dwordx4 v241, s[44:47], s90 offen sc1 lds
s_add_u32 s90, s90, 5120
v_exp_f32 v120, v120
v_exp_f32 v121, v121
v_exp_f32 v122, v122
v_exp_f32 v123, v123
v_exp_f32 v124, v124
v_exp_f32 v125, v125
v_exp_f32 v126, v126
v_exp_f32_e64 v127, v127
s_add_u32 m0, s94, 10240
s_nop 0
buffer_load_dwordx4 v240, s[44:47], s90 offen sc1 lds
v_pk_add_f32 v[112:113], v[112:113], s[80:81]
v_pk_add_f32 v[114:115], v[114:115], s[80:81]
v_pk_add_f32 v[116:117], v[116:117], s[80:81]
v_pk_add_f32 v[118:119], v[118:119], s[80:81]
v_pk_add_f32 v[120:121], v[120:121], s[80:81]
v_pk_add_f32 v[122:123], v[122:123], s[80:81]
v_pk_add_f32 v[124:125], v[124:125], s[80:81]
v_pk_add_f32 v[126:127], v[126:127], s[80:81]
s_add_u32 m0, s94, 11264
s_nop 0
buffer_load_dwordx4 v252, s[44:47], s90 offen sc1 lds
v_rcp_f32 v112, v112
v_rcp_f32 v113, v113
v_rcp_f32 v114, v114
v_rcp_f32 v115, v115
v_rcp_f32 v116, v116
v_rcp_f32 v117, v117
v_rcp_f32 v118, v118
v_rcp_f32 v119, v119
s_add_u32 m0, s94, 12288
s_nop 0
buffer_load_dwordx4 v253, s[44:47], s90 offen sc1 lds
v_rcp_f32 v120, v120
v_rcp_f32 v121, v121
v_rcp_f32 v122, v122
v_rcp_f32 v123, v123
v_rcp_f32 v124, v124
v_rcp_f32 v125, v125
v_rcp_f32 v126, v126
v_rcp_f32_e64 v127, v127
s_add_u32 m0, s94, 13312
s_nop 0
buffer_load_dwordx4 v254, s[44:47], s90 offen sc1 lds
v_pk_mul_f32 v[112:113], v[112:113], v[32:33]
v_pk_mul_f32 v[114:115], v[114:115], v[34:35]
v_pk_mul_f32 v[116:117], v[116:117], v[36:37]
v_pk_mul_f32 v[118:119], v[118:119], v[38:39]
v_pk_mul_f32 v[120:121], v[120:121], v[40:41]
v_pk_mul_f32 v[122:123], v[122:123], v[42:43]
v_pk_mul_f32 v[124:125], v[124:125], v[44:45]
v_pk_mul_f32 v[126:127], v[126:127], v[46:47]
s_add_u32 m0, s94, 14336
s_nop 0
buffer_load_dwordx4 v241, s[44:47], s90 offen sc1 lds
s_add_u32 s90, s90, 5120
v_cvt_pk_bf16_f32 v128, v112, v113
v_cvt_pk_bf16_f32 v129, v114, v115
v_cvt_pk_bf16_f32 v130, v116, v117
v_cvt_pk_bf16_f32 v131, v118, v119
v_cvt_pk_bf16_f32 v132, v120, v121
v_cvt_pk_bf16_f32 v133, v122, v123
v_cvt_pk_bf16_f32 v134, v124, v125
v_cvt_pk_bf16_f32 v135, v126, v127
s_add_u32 m0, s94, 15360
s_nop 0
buffer_load_dwordx4 v240, s[44:47], s90 offen sc1 lds
buffer_store_dwordx4 v[128:131], v96, s[44:47], s62 offen sc1
buffer_store_dwordx4 v[132:135], v96, s[44:47], s62 offen offset:256 sc1
s_add_u32 s62, s82, 1
s_lshl_b32 s62, s62, 12
s_add_u32 s62, s62, s78
s_cmp_eq_u32 s58, 7
s_cselect_b32 s62, 0x7f000000, s62
v_pk_mul_f32 v[112:113], v[48:49], s[68:69]
v_pk_mul_f32 v[114:115], v[50:51], s[68:69]
v_pk_mul_f32 v[116:117], v[52:53], s[68:69]
s_add_u32 m0, s94, 16384
s_nop 0
buffer_load_dwordx4 v252, s[44:47], s90 offen sc1 lds
v_pk_mul_f32 v[118:119], v[54:55], s[68:69]
v_pk_mul_f32 v[120:121], v[56:57], s[68:69]
v_pk_mul_f32 v[122:123], v[58:59], s[68:69]
v_pk_mul_f32 v[124:125], v[60:61], s[68:69]
v_pk_mul_f32 v[126:127], v[62:63], s[68:69]
v_exp_f32 v112, v112
v_exp_f32 v113, v113
v_exp_f32_e64 v114, v114
s_add_u32 m0, s94, 17408
s_nop 0
buffer_load_dwordx4 v253, s[44:47], s90 offen sc1 lds
v_exp_f32 v115, v115
v_exp_f32 v116, v116
v_exp_f32 v117, v117
v_exp_f32 v118, v118
v_exp_f32 v119, v119
v_exp_f32 v120, v120
v_exp_f32 v121, v121
v_exp_f32_e64 v122, v122
s_add_u32 m0, s94, 18432
s_nop 0
buffer_load_dwordx4 v254, s[44:47], s90 offen sc1 lds
v_exp_f32 v123, v123
v_exp_f32 v124, v124
v_exp_f32 v125, v125
v_exp_f32 v126, v126
v_exp_f32 v127, v127
v_pk_add_f32 v[112:113], v[112:113], s[80:81]
v_pk_add_f32 v[114:115], v[114:115], s[80:81]
v_pk_add_f32 v[116:117], v[116:117], s[80:81]
s_add_u32 m0, s94, 19456
s_nop 0
buffer_load_dwordx4 v241, s[44:47], s90 offen sc1 lds
s_add_u32 s90, s90, 5120
v_pk_add_f32 v[118:119], v[118:119], s[80:81]
v_pk_add_f32 v[120:121], v[120:121], s[80:81]
v_pk_add_f32 v[122:123], v[122:123], s[80:81]
v_pk_add_f32 v[124:125], v[124:125], s[80:81]
v_pk_add_f32 v[126:127], v[126:127], s[80:81]
v_rcp_f32 v112, v112
v_rcp_f32 v113, v113
v_rcp_f32 v114, v114
s_add_u32 m0, s94, 20480
s_nop 0
buffer_load_dwordx4 v240, s[44:47], s90 offen sc1 lds
v_rcp_f32 v115, v115
v_rcp_f32 v116, v116
v_rcp_f32 v117, v117
v_rcp_f32 v118, v118
v_rcp_f32 v119, v119
v_rcp_f32 v120, v120
v_rcp_f32 v121, v121
v_rcp_f32_e64 v122, v122
s_add_u32 m0, s94, 21504
s_nop 0
buffer_load_dwordx4 v252, s[44:47], s90 offen sc1 lds
v_rcp_f32 v123, v123
v_rcp_f32 v124, v124
v_rcp_f32 v125, v125
v_rcp_f32 v126, v126
v_rcp_f32 v127, v127
v_pk_mul_f32 v[112:113], v[112:113], v[48:49]
v_pk_mul_f32 v[114:115], v[114:115], v[50:51]
v_pk_mul_f32 v[116:117], v[116:117], v[52:53]
s_add_u32 m0, s94, 22528
s_nop 0
buffer_load_dwordx4 v253, s[44:47], s90 offen sc1 lds
v_pk_mul_f32 v[118:119], v[118:119], v[54:55]
v_pk_mul_f32 v[120:121], v[120:121], v[56:57]
v_pk_mul_f32 v[122:123], v[122:123], v[58:59]
v_pk_mul_f32 v[124:125], v[124:125], v[60:61]
v_pk_mul_f32 v[126:127], v[126:127], v[62:63]
v_cvt_pk_bf16_f32 v136, v112, v113
v_cvt_pk_bf16_f32 v137, v114, v115
v_cvt_pk_bf16_f32 v138, v116, v117
s_add_u32 m0, s94, 23552
s_nop 0
buffer_load_dwordx4 v254, s[44:47], s90 offen sc1 lds
v_cvt_pk_bf16_f32 v139, v118, v119
v_cvt_pk_bf16_f32 v140, v120, v121
v_cvt_pk_bf16_f32 v141, v122, v123
v_cvt_pk_bf16_f32 v142, v124, v125
v_cvt_pk_bf16_f32 v143, v126, v127
buffer_store_dwordx4 v[136:139], v96, s[44:47], s62 offen sc1
buffer_store_dwordx4 v[140:143], v96, s[44:47], s62 offen offset:256 sc1
s_add_u32 s62, s82, 2
s_lshl_b32 s62, s62, 12
s_add_u32 s62, s62, s78
s_add_u32 m0, s94, 24576
s_nop 0
buffer_load_dwordx4 v241, s[44:47], s90 offen sc1 lds
s_add_u32 s90, s90, 5120
v_pk_mul_f32 v[112:113], v[64:65], s[68:69]
v_pk_mul_f32 v[114:115], v[66:67], s[68:69]
v_pk_mul_f32 v[116:117], v[68:69], s[68:69]
v_pk_mul_f32 v[118:119], v[70:71], s[68:69]
v_pk_mul_f32 v[120:121], v[72:73], s[68:69]
v_pk_mul_f32 v[122:123], v[74:75], s[68:69]
v_pk_mul_f32 v[124:125], v[76:77], s[68:69]
v_pk_mul_f32 v[126:127], v[78:79], s[68:69]
s_add_u32 m0, s94, 25600
s_nop 0
buffer_load_dwordx4 v240, s[44:47], s90 offen sc1 lds
v_exp_f32 v112, v112
v_exp_f32 v113, v113
v_exp_f32 v114, v114
v_exp_f32 v115, v115
v_exp_f32 v116, v116
v_exp_f32 v117, v117
v_exp_f32 v118, v118
v_exp_f32_e64 v119, v119
s_add_u32 m0, s94, 26624
s_nop 0
buffer_load_dwordx4 v252, s[44:47], s90 offen sc1 lds
v_exp_f32 v120, v120
v_exp_f32 v121, v121
v_exp_f32 v122, v122
v_exp_f32 v123, v123
v_exp_f32 v124, v124
v_exp_f32 v125, v125
v_exp_f32 v126, v126
v_exp_f32_e64 v127, v127
s_add_u32 m0, s94, 27648
s_nop 0
buffer_load_dwordx4 v253, s[44:47], s90 offen sc1 lds
v_pk_add_f32 v[112:113], v[112:113], s[80:81]
v_pk_add_f32 v[114:115], v[114:115], s[80:81]
v_pk_add_f32 v[116:117], v[116:117], s[80:81]
v_pk_add_f32 v[118:119], v[118:119], s[80:81]
v_pk_add_f32 v[120:121], v[120:121], s[80:81]
v_pk_add_f32 v[122:123], v[122:123], s[80:81]
v_pk_add_f32 v[124:125], v[124:125], s[80:81]
v_pk_add_f32 v[126:127], v[126:127], s[80:81]
s_add_u32 m0, s94, 28672
s_nop 0
buffer_load_dwordx4 v254, s[44:47], s90 offen sc1 lds
v_rcp_f32 v112, v112
v_rcp_f32 v113, v113
v_rcp_f32 v114, v114
v_rcp_f32 v115, v115
v_rcp_f32 v116, v116
v_rcp_f32 v117, v117
v_rcp_f32 v118, v118
v_rcp_f32 v119, v119
s_add_u32 m0, s94, 29696
s_nop 0
buffer_load_dwordx4 v241, s[44:47], s90 offen sc1 lds
s_add_u32 s90, s90, 5120
v_rcp_f32 v120, v120
v_rcp_f32 v121, v121
v_rcp_f32 v122, v122
v_rcp_f32 v123, v123
v_rcp_f32 v124, v124
v_rcp_f32 v125, v125
v_rcp_f32 v126, v126
v_rcp_f32_e64 v127, v127
v_pk_mul_f32 v[112:113], v[112:113], v[64:65]
v_pk_mul_f32 v[114:115], v[114:115], v[66:67]
v_pk_mul_f32 v[116:117], v[116:117], v[68:69]
v_pk_mul_f32 v[118:119], v[118:119], v[70:71]
v_pk_mul_f32 v[120:121], v[120:121], v[72:73]
v_pk_mul_f32 v[122:123], v[122:123], v[74:75]
v_pk_mul_f32 v[124:125], v[124:125], v[76:77]
v_pk_mul_f32 v[126:127], v[126:127], v[78:79]
v_cvt_pk_bf16_f32 v144, v112, v113
v_cvt_pk_bf16_f32 v145, v114, v115
v_cvt_pk_bf16_f32 v146, v116, v117
v_cvt_pk_bf16_f32 v147, v118, v119
v_cvt_pk_bf16_f32 v148, v120, v121
v_cvt_pk_bf16_f32 v149, v122, v123
v_cvt_pk_bf16_f32 v150, v124, v125
v_cvt_pk_bf16_f32 v151, v126, v127
buffer_store_dwordx4 v[144:147], v96, s[44:47], s62 offen sc1
buffer_store_dwordx4 v[148:151], v96, s[44:47], s62 offen offset:256 sc1
s_branch L_k2
L1_typeB:
s_lshl_b32 s82, s58, 2
v_add_u32_e64 v28, 0, v1
v_mul_u32_u24 v29, 5462, v28
v_lshrrev_b32 v29, 16, v29
v_mul_u32_u24 v30, 12, v29
v_sub_u32_e64 v30, v28, v30
v_mul_u32_u24 v11, 3840, v29
v_lshrrev_b32 v28, 2, v30
v_and_b32 v31, 1, v30
v_lshl_add_u32 v28, v28, 1, v31
v_bfe_u32 v31, v30, 1, 1
v_min_u32_e64 v28, 4, v28
v_lshl_add_u32 v11, v28, 4, v11
v_mul_u32_u24 v31, 80, v31
v_add_u32_e64 v11, v11, v31
s_mul_i32 s60, s58, 160
v_add_u32 v11, s60, v11
v_add_u32 v28, 64, v1
v_mul_u32_u24 v29, 5462, v28
v_lshrrev_b32 v29, 16, v29
v_mul_u32_u24 v30, 12, v29
v_sub_u32_e64 v30, v28, v30
v_mul_u32_u24 v12, 3840, v29
v_lshrrev_b32 v28, 2, v30
v_and_b32 v31, 1, v30
v_lshl_add_u32 v28, v28, 1, v31
v_bfe_u32 v31, v30, 1, 1
v_min_u32_e64 v28, 4, v28
v_lshl_add_u32 v12, v28, 4, v12
v_mul_u32_u24 v31, 80, v31
v_add_u32_e64 v12, v12, v31
s_mul_i32 s60, s58, 160
v_add_u32_e64 v12, s60, v12
v_add_u32 v28, 128, v1
v_mul_u32_u24 v29, 5462, v28
v_lshrrev_b32 v29, 16, v29
v_mul_u32_u24 v30, 12, v29
v_sub_u32_e64 v30, v28, v30
v_mul_u32_u24 v13, 3840, v29
v_lshrrev_b32 v28, 2, v30
v_and_b32 v31, 1, v30
v_lshl_add_u32 v28, v28, 1, v31
v_bfe_u32 v31, v30, 1, 1
v_min_u32_e64 v28, 4, v28
v_lshl_add_u32 v13, v28, 4, v13
v_mul_u32_u24 v31, 80, v31
v_add_u32_e64 v13, v13, v31
s_mul_i32 s60, s58, 160
v_add_u32 v13, s60, v13
v_add_u32 v28, 0, v1
v_mul_u32_u24 v29, 3277, v28
v_lshrrev_b32 v29, 16, v29
v_mul_u32_u24 v30, 20, v29
v_sub_u32_e64 v30, v28, v30
v_mul_u32_u24 v6, 3456, v29
v_min_u32_e64 v30, 15, v30
v_lshl_add_u32 v6, v30, 4, v6
s_lshl_b32 s60, s82, 6
v_add_u32 v6, s60, v6
v_add_u32_e64 v28, 64, v1
v_mul_u32_u24 v29, 3277, v28
v_lshrrev_b32 v29, 16, v29
v_mul_u32_u24 v30, 20, v29
v_sub_u32_e64 v30, v28, v30
v_mul_u32_u24 v7, 3456, v29
v_min_u32_e64 v30, 15, v30
v_lshl_add_u32 v7, v30, 4, v7
s_lshl_b32 s60, s82, 6
v_add_u32 v7, s60, v7
v_add_u32 v28, 128, v1
v_mul_u32_u24 v29, 3277, v28
v_lshrrev_b32 v29, 16, v29
v_mul_u32_u24 v30, 20, v29
v_sub_u32_e64 v30, v28, v30
v_mul_u32_u24 v8, 3456, v29
v_min_u32_e64 v30, 15, v30
v_lshl_add_u32 v8, v30, 4, v8
s_lshl_b32 s60, s82, 6
v_add_u32 v8, s60, v8
v_add_u32 v28, 192, v1
v_mul_u32_u24 v29, 3277, v28
v_lshrrev_b32 v29, 16, v29
v_mul_u32_u24 v30, 20, v29
v_sub_u32_e64 v30, v28, v30
v_mul_u32_u24 v9, 3456, v29
v_min_u32_e64 v30, 15, v30
v_lshl_add_u32 v9, v30, 4, v9
s_lshl_b32 s60, s82, 6
v_add_u32 v9, s60, v9
v_add_u32 v28, 256, v1
v_mul_u32_u24 v29, 3277, v28
v_lshrrev_b32 v29, 16, v29
v_mul_u32_u24 v30, 20, v29
v_sub_u32_e64 v30, v28, v30
v_mul_u32_u24 v10, 3456, v29
v_min_u32_e64 v30, 15, v30
v_lshl_add_u32 v10, v30, 4, v10
s_lshl_b32 s60, s82, 6
v_add_u32 v10, s60, v10
s_lshl_b32 s60, s85, 2
s_add_u32 s60, s60, s56
s_mul_i32 s76, s60, 61440
s_mul_i32 s77, s60, 55296
s_add_u32 s60, s56, 0
s_and_b32 s60, s60, 3
s_mul_i32 s60, s60, 5120
v_add_u32_e64 v144, s60, v2
v_add_u32 v145, 49152, v144
s_add_u32 s60, s56, 1
s_and_b32 s60, s60, 3
s_mul_i32 s60, s60, 5120
v_add_u32_e64 v146, s60, v2
v_add_u32 v147, 49152, v146
s_add_u32 s60, s56, 2
s_and_b32 s60, s60, 3
s_mul_i32 s60, s60, 5120
v_add_u32_e64 v148, s60, v2
v_add_u32 v149, 49152, v148
s_add_u32 s60, s56, 3
s_and_b32 s60, s60, 3
s_mul_i32 s60, s60, 5120
v_add_u32_e64 v150, s60, v2
v_add_u32 v151, 49152, v150
s_add_u32 s60, s56, 0
s_and_b32 s60, s60, 3
s_mul_i32 s60, s60, 3072
v_add_u32_e64 v152, s60, v4
v_add_u32 v153, 49152, v152
s_add_u32 s60, s56, 1
s_and_b32 s60, s60, 3
s_mul_i32 s60, s60, 3072
v_add_u32_e64 v154, s60, v4
v_add_u32 v155, 49152, v154
s_add_u32 s60, s56, 2
s_and_b32 s60, s60, 3
s_mul_i32 s60, s60, 3072
v_add_u32_e64 v156, s60, v4
v_add_u32 v157, 49152, v156
s_add_u32 s60, s56, 3
s_and_b32 s60, s60, 3
s_mul_i32 s60, s60, 3072
v_add_u32_e64 v158, s60, v4
v_add_u32 v159, 49152, v158
s_lshl_b32 s60, s57, 3
s_add_u32 s60, s60, s58
s_lshl_b32 s60, s60, 2
s_add_u32 s60, s60, s56
s_and_b32 s61, s60, 7
s_lshr_b32 s62, s60, 3
s_mul_i32 s63, s62, 147
s_lshr_b32 s63, s63, 11
s_lshl_b32 s63, s63, 2
s_add_u32 s63, s63, s62
s_lshl_b32 s63, s63, 3
s_add_u32 s63, s63, s61
s_cmp_lt_u32 s60, 448
s_cselect_b32 s79, s63, 592
s_mul_i32 s94, s56, 30720
s_add_u32 s94, s94, 24576
v_mov_b32 v20, 0
v_mov_b32 v21, 0
v_mov_b32 v14, 0
v_mov_b32 v15, 0
v_mov_b32 v24, 0
v_mov_b32 v25, 0
v_mov_b32 v192, 0
v_mov_b32 v193, 0
s_add_u32 m0, s75, 0
s_nop 0
buffer_load_dwordx4 v11, s[28:31], s76 offen lds
s_add_u32 m0, s75, 1024
s_nop 0
buffer_load_dwordx4 v12, s[28:31], s76 offen lds
s_add_u32 m0, s75, 2048
s_nop 0
buffer_load_dwordx4 v13, s[28:31], s76 offen lds
s_add_u32 s76, s76, 245760
s_sub_u32 s87, s76, 2457600
s_cmp_ge_u32 s76, 2457600
s_cselect_b32 s76, s87, s76
s_add_u32 m0, s74, 12288
s_nop 0
buffer_load_dwordx4 v6, s[36:39], s77 offen lds
s_add_u32 m0, s74, 13312
s_nop 0
buffer_load_dwordx4 v7, s[36:39], s77 offen lds
s_add_u32 m0, s74, 14336
s_nop 0
buffer_load_dwordx4 v8, s[36:39], s77 offen lds
s_add_u32 m0, s74, 15360
s_nop 0
buffer_load_dwordx4 v9, s[36:39], s77 offen lds
s_add_u32 m0, s74, 16384
s_nop 0
buffer_load_dwordx4 v10, s[36:39], s77 offen lds
s_add_u32 s77, s77, 221184
s_sub_u32 s87, s77, 2211840
s_cmp_ge_u32 s77, 2211840
s_cselect_b32 s77, s87, s77
s_add_u32 m0, s75, 32768
s_nop 0
buffer_load_dwordx4 v11, s[28:31], s76 offen lds
s_add_u32 m0, s75, 33792
s_nop 0
buffer_load_dwordx4 v12, s[28:31], s76 offen lds
s_add_u32 m0, s75, 34816
s_nop 0
buffer_load_dwordx4 v13, s[28:31], s76 offen lds
s_add_u32 s76, s76, 245760
s_sub_u32 s87, s76, 2457600
s_cmp_ge_u32 s76, 2457600
s_cselect_b32 s76, s87, s76
s_add_u32 m0, s74, 45056
s_nop 0
buffer_load_dwordx4 v6, s[36:39], s77 offen lds
s_add_u32 m0, s74, 46080
s_nop 0
buffer_load_dwordx4 v7, s[36:39], s77 offen lds
s_add_u32 m0, s74, 47104
s_nop 0
buffer_load_dwordx4 v8, s[36:39], s77 offen lds
s_add_u32 m0, s74, 48128
s_nop 0
buffer_load_dwordx4 v9, s[36:39], s77 offen lds
s_add_u32 m0, s74, 49152
s_nop 0
buffer_load_dwordx4 v10, s[36:39], s77 offen lds
s_add_u32 s77, s77, 221184
s_sub_u32 s87, s77, 2211840
s_cmp_ge_u32 s77, 2211840
s_cselect_b32 s77, s87, s77
s_lshl_b32 s60, s58, 2
s_add_u32 s60, s60, s56
s_mul_i32 s60, s60, 800
v_lshlrev_b32_e64 v28, 3, v1
buffer_load_dwordx2 v[194:195], v28, s[32:35], s60 offen
buffer_load_dwordx2 v[196:197], v28, s[32:35], s60 offen offset:512
s_cmp_ge_u32 s79, 592
s_cbranch_scc1 L_tj1_skip_B
s_lshr_b32 s60, s79, 3
s_and_b32 s61, s79, 7
s_mov_b32 s63, 819200
s_cmp_lt_u32 s60, 54
s_cselect_b32 s40, s14, s10
s_cselect_b32 s41, s15, s11
s_cselect_b32 s42, 2211840, s63
s_cselect_b32 s62, 0, 54
s_and_b32 s41, s41, 0xffff
s_mov_b32 s43, 0x20000
s_sub_u32 s60, s60, s62
s_mul_i32 s60, s60, 40960
s_mul_i32 s61, s61, 160
s_add_u32 s60, s60, s61
v_add_u32 v28, 0, v1
v_mul_u32_u24 v29, 6554, v28
v_lshrrev_b32 v29, 16, v29
v_mul_u32_u24 v30, 10, v29
v_sub_u32_e64 v30, v28, v30
v_mul_u32_u24 v29, 1280, v29
v_lshl_add_u32 v29, v30, 4, v29
s_add_u32 m0, s74, 65536
s_nop 0
buffer_load_dwordx4 v29, s[40:43], s60 offen lds
v_add_u32 v28, 64, v1
v_mul_u32_u24 v29, 6554, v28
v_lshrrev_b32 v29, 16, v29
v_mul_u32_u24 v30, 10, v29
v_sub_u32_e64 v30, v28, v30
v_mul_u32_u24 v29, 1280, v29
v_lshl_add_u32 v29, v30, 4, v29
s_add_u32 m0, s74, 66560
s_nop 0
buffer_load_dwordx4 v29, s[40:43], s60 offen lds
v_add_u32 v28, 128, v1
v_mul_u32_u24 v29, 6554, v28
v_lshrrev_b32 v29, 16, v29
v_mul_u32_u24 v30, 10, v29
v_sub_u32 v30, v28, v30
v_mul_u32_u24 v29, 1280, v29
v_lshl_add_u32 v29, v30, 4, v29
s_add_u32 m0, s74, 67584
s_nop 0
buffer_load_dwordx4 v29, s[40:43], s60 offen lds
v_add_u32 v28, 192, v1
v_mul_u32_u24 v29, 6554, v28
v_lshrrev_b32 v29, 16, v29
v_mul_u32_u24 v30, 10, v29
v_sub_u32 v30, v28, v30
v_mul_u32_u24 v29, 1280, v29
v_lshl_add_u32 v29, v30, 4, v29
s_add_u32 m0, s74, 68608
s_nop 0
buffer_load_dwordx4 v29, s[40:43], s60 offen lds
v_add_u32 v28, 256, v1
v_mul_u32_u24 v29, 6554, v28
v_lshrrev_b32 v29, 16, v29
v_mul_u32_u24 v30, 10, v29
v_sub_u32 v30, v28, v30
v_mul_u32_u24 v29, 1280, v29
v_lshl_add_u32 v29, v30, 4, v29
s_add_u32 m0, s74, 69632
s_nop 0
buffer_load_dwordx4 v29, s[40:43], s60 offen lds
L_tj1_skip_B:
v_mov_b32 v44, 0
v_mov_b32 v45, 0
v_mov_b32 v46, 0
v_mov_b32 v47, 0
v_lshlrev_b32 v48, 4, v0
v_add_u32 v48, 147456, v48
ds_write_b128 v48, v[44:47] offset:0
ds_write_b128 v48, v[44:47] offset:4096
ds_write_b128 v48, v[44:47] offset:8192
ds_write_b128 v48, v[44:47] offset:12288
v_bfe_u32 v28, v1, 4, 1
v_and_b32 v29, 15, v1
v_mov_b32 v246, s65
v_cmp_eq_u32 vcc, v28, v29
s_nop 1
v_cndmask_b32 v246, 0, v246, vcc
v_mov_b32 v247, v246
v_mov_b32 v248, v246
v_mov_b32 v249, v246
s_waitcnt vmcnt(26)
ds_read_b128 a[0:3], v16 offset:0
ds_read_b128 a[4:7], v17 offset:0
ds_read_b128 a[8:11], v18 offset:0
ds_read_b128 a[12:15], v19 offset:0
ds_read_b128 v[160:163], v16 offset:0
ds_read_b128 v[164:167], v17 offset:0
ds_read_b128 v[168:171], v18 offset:0
ds_read_b128 v[172:175], v19 offset:0
s_waitcnt lgkmcnt(0)
s_add_u32 s60, s70, s86
s_add_u32 m0, s88, 0
s_nop 0
buffer_load_dwordx4 v22, s[24:27], s60 offen lds
s_add_u32 s60, s70, s86
s_add_u32 m0, s88, 1024
s_nop 0
buffer_load_dwordx4 v23, s[24:27], s60 offen lds
s_add_u32 s60, s70, s86
s_add_u32 m0, s88, 2048
s_nop 0
buffer_load_dwordx4 v26, s[24:27], s60 offen lds
s_add_u32 s60, s70, s86
s_add_u32 m0, s88, 3072
s_nop 0
buffer_load_dwordx4 v27, s[24:27], s60 offen lds
s_add_u32 s86, s86, 128
s_cmp_ge_u32 s86, 1280
s_cselect_b32 s86, 0, s86
v_dot2c_f32_bf16 v20, s65, v160
v_dot2c_f32_bf16 v24, v160, v160
v_dot2c_f32_bf16 v21, s65, v161
v_dot2c_f32_bf16 v25, v161, v161
v_dot2c_f32_bf16 v14, s65, v162
v_dot2c_f32_bf16 v192, v162, v162
v_dot2c_f32_bf16 v15, s65, v163
v_dot2c_f32_bf16 v193, v163, v163
v_dot2c_f32_bf16 v20, s65, v164
v_dot2c_f32_bf16 v24, v164, v164
v_dot2c_f32_bf16 v21, s65, v165
v_dot2c_f32_bf16 v25, v165, v165
v_dot2c_f32_bf16 v14, s65, v166
v_dot2c_f32_bf16 v192, v166, v166
v_dot2c_f32_bf16 v15, s65, v167
v_dot2c_f32_bf16 v193, v167, v167
v_dot2c_f32_bf16 v20, s65, v168
v_dot2c_f32_bf16 v24, v168, v168
v_dot2c_f32_bf16 v21, s65, v169
v_dot2c_f32_bf16 v25, v169, v169
v_dot2c_f32_bf16 v14, s65, v170
v_dot2c_f32_bf16 v192, v170, v170
v_dot2c_f32_bf16 v15, s65, v171
v_dot2c_f32_bf16 v193, v171, v171
v_dot2c_f32_bf16 v20, s65, v172
v_dot2c_f32_bf16 v24, v172, v172
v_dot2c_f32_bf16 v21, s65, v173
v_dot2c_f32_bf16 v25, v173, v173
v_dot2c_f32_bf16 v14, s65, v174
v_dot2c_f32_bf16 v192, v174, v174
v_dot2c_f32_bf16 v15, s65, v175
v_dot2c_f32_bf16 v193, v175, v175
s_waitcnt vmcnt(14)
s_barrier
ds_read_b64_tr_b16 a[160:161], v152 offset:0
ds_read_b64_tr_b16 a[162:163], v152 offset:768
ds_read_b64_tr_b16 a[164:165], v152 offset:64
ds_read_b64_tr_b16 a[166:167], v152 offset:832
ds_read_b64_tr_b16 a[168:169], v152 offset:128
ds_read_b64_tr_b16 a[170:171], v152 offset:896
ds_read_b64_tr_b16 a[172:173], v144 offset:12288
ds_read_b64_tr_b16 a[174:175], v144 offset:13568
s_waitcnt lgkmcnt(6)
v_mfma_f32_32x32x16_bf16 v[32:47], a[160:163], a[0:3], 0
ds_read_b64_tr_b16 a[176:177], v144 offset:12352
ds_read_b64_tr_b16 a[178:179], v144 offset:13632
v_mfma_f32_16x16x32_bf16 v[208:211], a[160:163], v[246:249], 0
s_waitcnt lgkmcnt(6)
v_mfma_f32_32x32x16_bf16 v[48:63], a[164:167], a[0:3], 0
ds_read_b64_tr_b16 a[180:181], v144 offset:12416
ds_read_b64_tr_b16 a[182:183], v144 offset:13696
v_mfma_f32_16x16x32_bf16 v[212:215], a[164:167], v[246:249], 0
s_waitcnt lgkmcnt(6)
v_mfma_f32_32x32x16_bf16 v[64:79], a[168:171], a[0:3], 0
ds_read_b64_tr_b16 a[184:185], v144 offset:12480
ds_read_b64_tr_b16 a[186:187], v144 offset:13760
v_mfma_f32_16x16x32_bf16 v[216:219], a[168:171], v[246:249], 0
s_waitcnt lgkmcnt(6)
v_mfma_f32_32x32x16_bf16 v[80:95], a[172:175], a[0:3], 0
ds_read_b64_tr_b16 a[188:189], v154 offset:0
ds_read_b64_tr_b16 a[190:191], v154 offset:768
v_mfma_f32_16x16x32_bf16 v[220:223], a[172:175], v[246:249], 0
s_waitcnt lgkmcnt(6)
v_mfma_f32_32x32x16_bf16 v[96:111], a[176:179], a[0:3], 0
ds_read_b64_tr_b16 a[192:193], v154 offset:64
ds_read_b64_tr_b16 a[194:195], v154 offset:832
v_mfma_f32_16x16x32_bf16 v[224:227], a[176:179], v[246:249], 0
s_waitcnt lgkmcnt(6)
v_mfma_f32_32x32x16_bf16 v[112:127], a[180:183], a[0:3], 0
ds_read_b64_tr_b16 a[196:197], v154 offset:128
ds_read_b64_tr_b16 a[198:199], v154 offset:896
v_mfma_f32_16x16x32_bf16 v[228:231], a[180:183], v[246:249], 0
s_waitcnt lgkmcnt(6)
v_mfma_f32_32x32x16_bf16 v[128:143], a[184:187], a[0:3], 0
ds_read_b64_tr_b16 a[200:201], v146 offset:12288
ds_read_b64_tr_b16 a[202:203], v146 offset:13568
v_mfma_f32_16x16x32_bf16 v[232:235], a[184:187], v[246:249], 0
s_waitcnt lgkmcnt(6)
v_mfma_f32_32x32x16_bf16 v[32:47], a[188:191], a[4:7], v[32:47]
ds_read_b64_tr_b16 a[204:205], v146 offset:12352
ds_read_b64_tr_b16 a[206:207], v146 offset:13632
ds_read_b128 a[16:19], v16 offset:4096
ds_read_b128 a[20:23], v17 offset:4096
ds_read_b128 a[24:27], v18 offset:4096
ds_read_b128 a[28:31], v19 offset:4096
ds_read_b128 v[176:179], v16 offset:4096
ds_read_b128 v[180:183], v17 offset:4096
ds_read_b128 v[184:187], v18 offset:4096
ds_read_b128 v[188:191], v19 offset:4096
s_waitcnt lgkmcnt(14)
v_mfma_f32_32x32x16_bf16 v[48:63], a[192:195], a[4:7], v[48:63]
ds_read_b64_tr_b16 a[160:161], v146 offset:12416
ds_read_b64_tr_b16 a[162:163], v146 offset:13696
s_waitcnt lgkmcnt(14)
v_mfma_f32_32x32x16_bf16 v[64:79], a[196:199], a[4:7], v[64:79]
ds_read_b64_tr_b16 a[164:165], v146 offset:12480
ds_read_b64_tr_b16 a[166:167], v146 offset:13760
s_waitcnt lgkmcnt(14)
v_mfma_f32_32x32x16_bf16 v[80:95], a[200:203], a[4:7], v[80:95]
ds_read_b64_tr_b16 a[168:169], v156 offset:0
ds_read_b64_tr_b16 a[170:171], v156 offset:768
s_waitcnt lgkmcnt(14)
v_mfma_f32_32x32x16_bf16 v[96:111], a[204:207], a[4:7], v[96:111]
ds_read_b64_tr_b16 a[172:173], v156 offset:64
ds_read_b64_tr_b16 a[174:175], v156 offset:832
s_waitcnt lgkmcnt(8)
v_dot2c_f32_bf16 v20, s65, v176
v_dot2c_f32_bf16 v24, v176, v176
v_dot2c_f32_bf16 v21, s65, v177
v_dot2c_f32_bf16 v25, v177, v177
v_dot2c_f32_bf16 v14, s65, v178
v_dot2c_f32_bf16 v192, v178, v178
v_dot2c_f32_bf16 v15, s65, v179
v_dot2c_f32_bf16 v193, v179, v179
v_dot2c_f32_bf16 v20, s65, v180
v_dot2c_f32_bf16 v24, v180, v180
v_dot2c_f32_bf16 v21, s65, v181
v_dot2c_f32_bf16 v25, v181, v181
v_dot2c_f32_bf16 v14, s65, v182
v_dot2c_f32_bf16 v192, v182, v182
v_dot2c_f32_bf16 v15, s65, v183
v_dot2c_f32_bf16 v193, v183, v183
v_dot2c_f32_bf16 v20, s65, v184
v_dot2c_f32_bf16 v24, v184, v184
v_dot2c_f32_bf16 v21, s65, v185
v_dot2c_f32_bf16 v25, v185, v185
v_dot2c_f32_bf16 v14, s65, v186
v_dot2c_f32_bf16 v192, v186, v186
v_dot2c_f32_bf16 v15, s65, v187
v_dot2c_f32_bf16 v193, v187, v187
v_dot2c_f32_bf16 v20, s65, v188
v_dot2c_f32_bf16 v24, v188, v188
v_dot2c_f32_bf16 v21, s65, v189
v_dot2c_f32_bf16 v25, v189, v189
v_dot2c_f32_bf16 v14, s65, v190
v_dot2c_f32_bf16 v192, v190, v190
v_dot2c_f32_bf16 v15, s65, v191
v_dot2c_f32_bf16 v193, v191, v191
s_waitcnt lgkmcnt(6)
v_mfma_f32_32x32x16_bf16 v[112:127], a[160:163], a[4:7], v[112:127]
ds_read_b64_tr_b16 a[176:177], v156 offset:128
ds_read_b64_tr_b16 a[178:179], v156 offset:896
s_waitcnt lgkmcnt(6)
v_mfma_f32_32x32x16_bf16 v[128:143], a[164:167], a[4:7], v[128:143]
ds_read_b64_tr_b16 a[180:181], v148 offset:12288
ds_read_b64_tr_b16 a[182:183], v148 offset:13568
s_add_u32 s60, s70, s86
s_add_u32 m0, s88, 4096
s_nop 0
buffer_load_dwordx4 v22, s[24:27], s60 offen lds
s_waitcnt lgkmcnt(6)
v_mfma_f32_32x32x16_bf16 v[32:47], a[168:171], a[8:11], v[32:47]
ds_read_b64_tr_b16 a[184:185], v148 offset:12352
ds_read_b64_tr_b16 a[186:187], v148 offset:13632
s_cmp_ge_u32 s79, 592
s_cbranch_scc1 L_tj2_skip_B
s_waitcnt vmcnt(5)
v_lshrrev_b32_e64 v28, 4, v1
v_bfe_u32 v29, v1, 2, 2
v_lshl_add_u32 v28, v28, 3, v29
v_mul_u32_u24 v28, 160, v28
v_and_b32 v29, 3, v1
v_mul_u32_u24 v29, 40, v29
v_add_u32_e64 v28, v28, v29
s_add_u32 s61, s74, 65536
v_add_u32_e64 v28, s61, v28
ds_read_b64_tr_b16 a[208:209], v28 offset:0
ds_read_b64_tr_b16 a[210:211], v28 offset:640
ds_read_b64_tr_b16 a[212:213], v28 offset:8
ds_read_b64_tr_b16 a[214:215], v28 offset:648
ds_read_b64_tr_b16 a[216:217], v28 offset:16
ds_read_b64_tr_b16 a[218:219], v28 offset:656
ds_read_b64_tr_b16 a[220:221], v28 offset:24
ds_read_b64_tr_b16 a[222:223], v28 offset:664
ds_read_b64_tr_b16 a[224:225], v28 offset:32
ds_read_b64_tr_b16 a[226:227], v28 offset:672
s_lshr_b32 s60, s79, 3
s_and_b32 s61, s79, 7
s_mul_i32 s61, s61, 74
s_add_u32 s60, s60, s61
s_mul_i32 s60, s60, 5120
s_add_u32 s60, s60, 12582912
v_lshlrev_b32 v29, 4, v1
v_add_u32 v30, 4096, v29
s_waitcnt lgkmcnt(0)
buffer_store_dwordx4 a[208:211], v29, s[44:47], s60 offen offset:0 sc1
buffer_store_dwordx4 a[212:215], v29, s[44:47], s60 offen offset:1024 sc1
buffer_store_dwordx4 a[216:219], v29, s[44:47], s60 offen offset:2048 sc1
buffer_store_dwordx4 a[220:223], v29, s[44:47], s60 offen offset:3072 sc1
buffer_store_dwordx4 a[224:227], v30, s[44:47], s60 offen sc1
L_tj2_skip_B:
s_waitcnt lgkmcnt(6)
v_mfma_f32_32x32x16_bf16 v[48:63], a[172:175], a[8:11], v[48:63]
ds_read_b64_tr_b16 a[188:189], v148 offset:12416
ds_read_b64_tr_b16 a[190:191], v148 offset:13696
s_add_u32 s60, s70, s86
s_add_u32 m0, s88, 5120
s_nop 0
buffer_load_dwordx4 v23, s[24:27], s60 offen lds
s_waitcnt lgkmcnt(6)
v_mfma_f32_32x32x16_bf16 v[64:79], a[176:179], a[8:11], v[64:79]
ds_read_b64_tr_b16 a[192:193], v148 offset:12480
ds_read_b64_tr_b16 a[194:195], v148 offset:13760
s_waitcnt lgkmcnt(6)
v_mfma_f32_32x32x16_bf16 v[80:95], a[180:183], a[8:11], v[80:95]
ds_read_b64_tr_b16 a[196:197], v158 offset:0
ds_read_b64_tr_b16 a[198:199], v158 offset:768
s_add_u32 s60, s70, s86
s_add_u32 m0, s88, 6144
s_nop 0
buffer_load_dwordx4 v26, s[24:27], s60 offen lds
s_waitcnt lgkmcnt(6)
v_mfma_f32_32x32x16_bf16 v[96:111], a[184:187], a[8:11], v[96:111]
ds_read_b64_tr_b16 a[200:201], v158 offset:64
ds_read_b64_tr_b16 a[202:203], v158 offset:832
s_waitcnt lgkmcnt(6)
v_mfma_f32_32x32x16_bf16 v[112:127], a[188:191], a[8:11], v[112:127]
ds_read_b64_tr_b16 a[204:205], v158 offset:128
ds_read_b64_tr_b16 a[206:207], v158 offset:896
s_add_u32 s60, s70, s86
s_add_u32 m0, s88, 7168
s_nop 0
buffer_load_dwordx4 v27, s[24:27], s60 offen lds
s_add_u32 s86, s86, 128
s_cmp_ge_u32 s86, 1280
s_cselect_b32 s86, 0, s86
s_waitcnt lgkmcnt(6)
v_mfma_f32_32x32x16_bf16 v[128:143], a[192:195], a[8:11], v[128:143]
ds_read_b64_tr_b16 a[160:161], v150 offset:12288
ds_read_b64_tr_b16 a[162:163], v150 offset:13568
s_waitcnt lgkmcnt(6)
v_mfma_f32_32x32x16_bf16 v[32:47], a[196:199], a[12:15], v[32:47]
ds_read_b64_tr_b16 a[164:165], v150 offset:12352
ds_read_b64_tr_b16 a[166:167], v150 offset:13632
s_waitcnt lgkmcnt(6)
v_mfma_f32_32x32x16_bf16 v[48:63], a[200:203], a[12:15], v[48:63]
ds_read_b64_tr_b16 a[168:169], v150 offset:12416
ds_read_b64_tr_b16 a[170:171], v150 offset:13696
s_waitcnt lgkmcnt(6)
v_mfma_f32_32x32x16_bf16 v[64:79], a[204:207], a[12:15], v[64:79]
ds_read_b64_tr_b16 a[172:173], v150 offset:12480
ds_read_b64_tr_b16 a[174:175], v150 offset:13760
s_waitcnt lgkmcnt(6)
v_mfma_f32_32x32x16_bf16 v[80:95], a[160:163], a[12:15], v[80:95]
s_waitcnt lgkmcnt(4)
v_mfma_f32_32x32x16_bf16 v[96:111], a[164:167], a[12:15], v[96:111]
s_waitcnt lgkmcnt(0)
s_waitcnt vmcnt(10)
s_barrier
ds_read_b64_tr_b16 a[176:177], v152 offset:32768
ds_read_b64_tr_b16 a[178:179], v152 offset:33536
ds_read_b64_tr_b16 a[180:181], v152 offset:32832
ds_read_b64_tr_b16 a[182:183], v152 offset:33600
v_mfma_f32_32x32x16_bf16 v[112:127], a[168:171], a[12:15], v[112:127]
ds_read_b64_tr_b16 a[184:185], v152 offset:32896
ds_read_b64_tr_b16 a[186:187], v152 offset:33664
s_add_u32 m0, s75, 65536
s_nop 0
buffer_load_dwordx4 v11, s[28:31], s76 offen lds
v_mfma_f32_32x32x16_bf16 v[128:143], a[172:175], a[12:15], v[128:143]
ds_read_b64_tr_b16 a[188:189], v144 offset:45056
ds_read_b64_tr_b16 a[190:191], v144 offset:46336
s_add_u32 m0, s75, 66560
s_nop 0
buffer_load_dwordx4 v12, s[28:31], s76 offen lds
s_waitcnt lgkmcnt(6)
v_mfma_f32_32x32x16_bf16 v[32:47], a[176:179], a[16:19], v[32:47]
ds_read_b64_tr_b16 a[192:193], v144 offset:45120
ds_read_b64_tr_b16 a[194:195], v144 offset:46400
v_mfma_f32_16x16x32_bf16 v[208:211], a[176:179], v[246:249], v[208:211]
s_add_u32 m0, s75, 67584
s_nop 0
buffer_load_dwordx4 v13, s[28:31], s76 offen lds
s_add_u32 s76, s76, 245760
s_sub_u32 s87, s76, 2457600
s_cmp_ge_u32 s76, 2457600
s_cselect_b32 s76, s87, s76
s_waitcnt lgkmcnt(6)
v_mfma_f32_32x32x16_bf16 v[48:63], a[180:183], a[16:19], v[48:63]
ds_read_b64_tr_b16 a[196:197], v144 offset:45184
ds_read_b64_tr_b16 a[198:199], v144 offset:46464
v_mfma_f32_16x16x32_bf16 v[212:215], a[180:183], v[246:249], v[212:215]
s_add_u32 m0, s74, 77824
s_nop 0
buffer_load_dwordx4 v6, s[36:39], s77 offen lds
s_waitcnt lgkmcnt(6)
v_mfma_f32_32x32x16_bf16 v[64:79], a[184:187], a[16:19], v[64:79]
ds_read_b64_tr_b16 a[200:201], v144 offset:45248
ds_read_b64_tr_b16 a[202:203], v144 offset:46528
v_mfma_f32_16x16x32_bf16 v[216:219], a[184:187], v[246:249], v[216:219]
s_add_u32 m0, s74, 78848
s_nop 0
buffer_load_dwordx4 v7, s[36:39], s77 offen lds
buffer_load_dword v250, off, s[48:51], 0 sc1
s_waitcnt lgkmcnt(6)
v_mfma_f32_32x32x16_bf16 v[80:95], a[188:191], a[16:19], v[80:95]
ds_read_b64_tr_b16 a[204:205], v154 offset:32768
ds_read_b64_tr_b16 a[206:207], v154 offset:33536
v_mfma_f32_16x16x32_bf16 v[220:223], a[188:191], v[246:249], v[220:223]
s_add_u32 m0, s74, 79872
s_nop 0
buffer_load_dwordx4 v8, s[36:39], s77 offen lds
s_waitcnt lgkmcnt(6)
v_mfma_f32_32x32x16_bf16 v[96:111], a[192:195], a[16:19], v[96:111]
ds_read_b64_tr_b16 a[160:161], v154 offset:32832
ds_read_b64_tr_b16 a[162:163], v154 offset:33600
v_mfma_f32_16x16x32_bf16 v[224:227], a[192:195], v[246:249], v[224:227]
s_add_u32 m0, s74, 80896
s_nop 0
buffer_load_dwordx4 v9, s[36:39], s77 offen lds
s_waitcnt lgkmcnt(6)
v_mfma_f32_32x32x16_bf16 v[112:127], a[196:199], a[16:19], v[112:127]
ds_read_b64_tr_b16 a[164:165], v154 offset:32896
ds_read_b64_tr_b16 a[166:167], v154 offset:33664
v_mfma_f32_16x16x32_bf16 v[228:231], a[196:199], v[246:249], v[228:231]
s_add_u32 m0, s74, 81920
s_nop 0
buffer_load_dwordx4 v10, s[36:39], s77 offen lds
s_add_u32 s77, s77, 221184
s_sub_u32 s87, s77, 2211840
s_cmp_ge_u32 s77, 2211840
s_cselect_b32 s77, s87, s77
s_waitcnt lgkmcnt(6)
v_mfma_f32_32x32x16_bf16 v[128:143], a[200:203], a[16:19], v[128:143]
ds_read_b64_tr_b16 a[168:169], v146 offset:45056
ds_read_b64_tr_b16 a[170:171], v146 offset:46336
v_mfma_f32_16x16x32_bf16 v[232:235], a[200:203], v[246:249], v[232:235]
s_add_u32 m0, s75, 0
s_nop 0
buffer_load_dwordx4 v11, s[28:31], s76 offen lds
s_waitcnt lgkmcnt(6)
v_mfma_f32_32x32x16_bf16 v[32:47], a[204:207], a[20:23], v[32:47]
ds_read_b64_tr_b16 a[172:173], v146 offset:45120
ds_read_b64_tr_b16 a[174:175], v146 offset:46400
s_add_u32 m0, s75, 1024
s_nop 0
buffer_load_dwordx4 v12, s[28:31], s76 offen lds
ds_read_b128 a[32:35], v16 offset:8192
ds_read_b128 a[36:39], v17 offset:8192
ds_read_b128 a[40:43], v18 offset:8192
ds_read_b128 a[44:47], v19 offset:8192
ds_read_b128 v[160:163], v16 offset:8192
ds_read_b128 v[164:167], v17 offset:8192
ds_read_b128 v[168:171], v18 offset:8192
ds_read_b128 v[172:175], v19 offset:8192
s_waitcnt lgkmcnt(14)
v_mfma_f32_32x32x16_bf16 v[48:63], a[160:163], a[20:23], v[48:63]
ds_read_b64_tr_b16 a[176:177], v146 offset:45184
ds_read_b64_tr_b16 a[178:179], v146 offset:46464
s_add_u32 m0, s75, 2048
s_nop 0
buffer_load_dwordx4 v13, s[28:31], s76 offen lds
s_add_u32 s76, s76, 245760
s_sub_u32 s87, s76, 2457600
s_cmp_ge_u32 s76, 2457600
s_cselect_b32 s76, s87, s76
s_waitcnt lgkmcnt(14)
v_mfma_f32_32x32x16_bf16 v[64:79], a[164:167], a[20:23], v[64:79]
ds_read_b64_tr_b16 a[180:181], v146 offset:45248
ds_read_b64_tr_b16 a[182:183], v146 offset:46528
s_add_u32 m0, s74, 12288
s_nop 0
buffer_load_dwordx4 v6, s[36:39], s77 offen lds
s_waitcnt lgkmcnt(14)
v_mfma_f32_32x32x16_bf16 v[80:95], a[168:171], a[20:23], v[80:95]
ds_read_b64_tr_b16 a[184:185], v156 offset:32768
ds_read_b64_tr_b16 a[186:187], v156 offset:33536
s_add_u32 m0, s74, 13312
s_nop 0
buffer_load_dwordx4 v7, s[36:39], s77 offen lds
s_waitcnt lgkmcnt(14)
v_mfma_f32_32x32x16_bf16 v[96:111], a[172:175], a[20:23], v[96:111]
ds_read_b64_tr_b16 a[188:189], v156 offset:32832
ds_read_b64_tr_b16 a[190:191], v156 offset:33600
s_add_u32 m0, s74, 14336
s_nop 0
buffer_load_dwordx4 v8, s[36:39], s77 offen lds
s_waitcnt lgkmcnt(8)
v_dot2c_f32_bf16 v20, s65, v160
v_dot2c_f32_bf16 v24, v160, v160
v_dot2c_f32_bf16 v21, s65, v161
v_dot2c_f32_bf16 v25, v161, v161
v_dot2c_f32_bf16 v14, s65, v162
v_dot2c_f32_bf16 v192, v162, v162
v_dot2c_f32_bf16 v15, s65, v163
v_dot2c_f32_bf16 v193, v163, v163
v_dot2c_f32_bf16 v20, s65, v164
v_dot2c_f32_bf16 v24, v164, v164
v_dot2c_f32_bf16 v21, s65, v165
v_dot2c_f32_bf16 v25, v165, v165
v_dot2c_f32_bf16 v14, s65, v166
v_dot2c_f32_bf16 v192, v166, v166
v_dot2c_f32_bf16 v15, s65, v167
v_dot2c_f32_bf16 v193, v167, v167
v_dot2c_f32_bf16 v20, s65, v168
v_dot2c_f32_bf16 v24, v168, v168
v_dot2c_f32_bf16 v21, s65, v169
v_dot2c_f32_bf16 v25, v169, v169
v_dot2c_f32_bf16 v14, s65, v170
v_dot2c_f32_bf16 v192, v170, v170
v_dot2c_f32_bf16 v15, s65, v171
v_dot2c_f32_bf16 v193, v171, v171
v_dot2c_f32_bf16 v20, s65, v172
v_dot2c_f32_bf16 v24, v172, v172
v_dot2c_f32_bf16 v21, s65, v173
v_dot2c_f32_bf16 v25, v173, v173
v_dot2c_f32_bf16 v14, s65, v174
v_dot2c_f32_bf16 v192, v174, v174
v_dot2c_f32_bf16 v15, s65, v175
v_dot2c_f32_bf16 v193, v175, v175
s_waitcnt lgkmcnt(6)
v_mfma_f32_32x32x16_bf16 v[112:127], a[176:179], a[20:23], v[112:127]
ds_read_b64_tr_b16 a[192:193], v156 offset:32896
ds_read_b64_tr_b16 a[194:195], v156 offset:33664
s_add_u32 m0, s74, 15360
s_nop 0
buffer_load_dwordx4 v9, s[36:39], s77 offen lds
s_waitcnt lgkmcnt(6)
v_mfma_f32_32x32x16_bf16 v[128:143], a[180:183], a[20:23], v[128:143]
ds_read_b64_tr_b16 a[196:197], v148 offset:45056
ds_read_b64_tr_b16 a[198:199], v148 offset:46336
s_add_u32 m0, s74, 16384
s_nop 0
buffer_load_dwordx4 v10, s[36:39], s77 offen lds
s_add_u32 s77, s77, 221184
s_sub_u32 s87, s77, 2211840
s_cmp_ge_u32 s77, 2211840
s_cselect_b32 s77, s87, s77
s_add_u32 s60, s70, s86
s_add_u32 m0, s88, 8192
s_nop 0
buffer_load_dwordx4 v22, s[24:27], s60 offen lds
s_waitcnt lgkmcnt(6)
v_mfma_f32_32x32x16_bf16 v[32:47], a[184:187], a[24:27], v[32:47]
ds_read_b64_tr_b16 a[200:201], v148 offset:45120
ds_read_b64_tr_b16 a[202:203], v148 offset:46400
s_waitcnt lgkmcnt(6)
v_mfma_f32_32x32x16_bf16 v[48:63], a[188:191], a[24:27], v[48:63]
ds_read_b64_tr_b16 a[204:205], v148 offset:45184
ds_read_b64_tr_b16 a[206:207], v148 offset:46464
s_add_u32 s60, s70, s86
s_add_u32 m0, s88, 9216
s_nop 0
buffer_load_dwordx4 v23, s[24:27], s60 offen lds
s_waitcnt lgkmcnt(6)
v_mfma_f32_32x32x16_bf16 v[64:79], a[192:195], a[24:27], v[64:79]
ds_read_b64_tr_b16 a[160:161], v148 offset:45248
ds_read_b64_tr_b16 a[162:163], v148 offset:46528
s_waitcnt lgkmcnt(6)
v_mfma_f32_32x32x16_bf16 v[80:95], a[196:199], a[24:27], v[80:95]
ds_read_b64_tr_b16 a[164:165], v158 offset:32768
ds_read_b64_tr_b16 a[166:167], v158 offset:33536
s_add_u32 s60, s70, s86
s_add_u32 m0, s88, 10240
s_nop 0
buffer_load_dwordx4 v26, s[24:27], s60 offen lds
s_waitcnt lgkmcnt(6)
v_mfma_f32_32x32x16_bf16 v[96:111], a[200:203], a[24:27], v[96:111]
ds_read_b64_tr_b16 a[168:169], v158 offset:32832
ds_read_b64_tr_b16 a[170:171], v158 offset:33600
s_waitcnt lgkmcnt(6)
v_mfma_f32_32x32x16_bf16 v[112:127], a[204:207], a[24:27], v[112:127]
ds_read_b64_tr_b16 a[172:173], v158 offset:32896
ds_read_b64_tr_b16 a[174:175], v158 offset:33664
s_add_u32 s60, s70, s86
s_add_u32 m0, s88, 11264
s_nop 0
buffer_load_dwordx4 v27, s[24:27], s60 offen lds
s_add_u32 s86, s86, 128
s_cmp_ge_u32 s86, 1280
s_cselect_b32 s86, 0, s86
s_waitcnt lgkmcnt(6)
v_mfma_f32_32x32x16_bf16 v[128:143], a[160:163], a[24:27], v[128:143]
ds_read_b64_tr_b16 a[176:177], v150 offset:45056
ds_read_b64_tr_b16 a[178:179], v150 offset:46336
s_waitcnt lgkmcnt(6)
v_mfma_f32_32x32x16_bf16 v[32:47], a[164:167], a[28:31], v[32:47]
ds_read_b64_tr_b16 a[180:181], v150 offset:45120
ds_read_b64_tr_b16 a[182:183], v150 offset:46400
s_waitcnt lgkmcnt(6)
v_mfma_f32_32x32x16_bf16 v[48:63], a[168:171], a[28:31], v[48:63]
ds_read_b64_tr_b16 a[184:185], v150 offset:45184
ds_read_b64_tr_b16 a[186:187], v150 offset:46464
s_waitcnt lgkmcnt(6)
v_mfma_f32_32x32x16_bf16 v[64:79], a[172:175], a[28:31], v[64:79]
ds_read_b64_tr_b16 a[188:189], v150 offset:45248
ds_read_b64_tr_b16 a[190:191], v150 offset:46528
s_waitcnt lgkmcnt(6)
v_mfma_f32_32x32x16_bf16 v[80:95], a[176:179], a[28:31], v[80:95]
s_waitcnt lgkmcnt(4)
v_mfma_f32_32x32x16_bf16 v[96:111], a[180:183], a[28:31], v[96:111]
s_waitcnt lgkmcnt(0)
s_waitcnt vmcnt(12)
s_barrier
ds_read_b64_tr_b16 a[192:193], v153 offset:16384
ds_read_b64_tr_b16 a[194:195], v153 offset:17152
ds_read_b64_tr_b16 a[196:197], v153 offset:16448
ds_read_b64_tr_b16 a[198:199], v153 offset:17216
v_mfma_f32_32x32x16_bf16 v[112:127], a[184:187], a[28:31], v[112:127]
ds_read_b64_tr_b16 a[200:201], v153 offset:16512
ds_read_b64_tr_b16 a[202:203], v153 offset:17280
s_add_u32 m0, s75, 32768
s_nop 0
buffer_load_dwordx4 v11, s[28:31], s76 offen lds
v_mfma_f32_32x32x16_bf16 v[128:143], a[188:191], a[28:31], v[128:143]
ds_read_b64_tr_b16 a[204:205], v145 offset:28672
ds_read_b64_tr_b16 a[206:207], v145 offset:29952
s_waitcnt lgkmcnt(6)
v_mfma_f32_32x32x16_bf16 v[32:47], a[192:195], a[32:35], v[32:47]
ds_read_b64_tr_b16 a[160:161], v145 offset:28736
ds_read_b64_tr_b16 a[162:163], v145 offset:30016
v_mfma_f32_16x16x32_bf16 v[208:211], a[192:195], v[246:249], v[208:211]
s_add_u32 m0, s75, 33792
s_nop 0
buffer_load_dwordx4 v12, s[28:31], s76 offen lds
s_waitcnt lgkmcnt(6)
v_mfma_f32_32x32x16_bf16 v[48:63], a[196:199], a[32:35], v[48:63]
ds_read_b64_tr_b16 a[164:165], v145 offset:28800
ds_read_b64_tr_b16 a[166:167], v145 offset:30080
v_mfma_f32_16x16x32_bf16 v[212:215], a[196:199], v[246:249], v[212:215]
s_waitcnt lgkmcnt(6)
v_mfma_f32_32x32x16_bf16 v[64:79], a[200:203], a[32:35], v[64:79]
ds_read_b64_tr_b16 a[168:169], v145 offset:28864
ds_read_b64_tr_b16 a[170:171], v145 offset:30144
v_mfma_f32_16x16x32_bf16 v[216:219], a[200:203], v[246:249], v[216:219]
s_add_u32 m0, s75, 34816
s_nop 0
buffer_load_dwordx4 v13, s[28:31], s76 offen lds
s_add_u32 s76, s76, 245760
s_sub_u32 s87, s76, 2457600
s_cmp_ge_u32 s76, 2457600
s_cselect_b32 s76, s87, s76
L_ng_B:
v_readfirstlane_b32 s84, v250
s_cmp_lg_u32 s84, 0
s_cbranch_scc1 L_ngok_B
s_sub_u32 s7, s7, 1
s_cbranch_scc1 L_ngok_B
s_sleep 2
buffer_load_dword v250, off, s[48:51], 0 sc1
s_waitcnt vmcnt(0)
s_branch L_ng_B
L_ngok_B:
s_waitcnt lgkmcnt(6)
v_mfma_f32_32x32x16_bf16 v[80:95], a[204:207], a[32:35], v[80:95]
ds_read_b64_tr_b16 a[172:173], v155 offset:16384
ds_read_b64_tr_b16 a[174:175], v155 offset:17152
v_mfma_f32_16x16x32_bf16 v[220:223], a[204:207], v[246:249], v[220:223]
s_waitcnt lgkmcnt(6)
v_mfma_f32_32x32x16_bf16 v[96:111], a[160:163], a[32:35], v[96:111]
ds_read_b64_tr_b16 a[176:177], v155 offset:16448
ds_read_b64_tr_b16 a[178:179], v155 offset:17216
v_mfma_f32_16x16x32_bf16 v[224:227], a[160:163], v[246:249], v[224:227]
s_add_u32 m0, s74, 45056
s_nop 0
buffer_load_dwordx4 v6, s[36:39], s77 offen lds
s_cmp_ge_u32 s79, 592
s_cbranch_scc1 L_tjf_B
v_mov_b32 v250, s84
s_lshl_b32 s60, s79, 7
s_add_u32 s60, s60, 16252928
s_mov_b64 exec, 1
buffer_store_dword v250, off, s[44:47], s60 sc1
s_mov_b64 exec, -1
L_tjf_B:
s_waitcnt lgkmcnt(6)
v_mfma_f32_32x32x16_bf16 v[112:127], a[164:167], a[32:35], v[112:127]
ds_read_b64_tr_b16 a[180:181], v155 offset:16512
ds_read_b64_tr_b16 a[182:183], v155 offset:17280
v_mfma_f32_16x16x32_bf16 v[228:231], a[164:167], v[246:249], v[228:231]
s_waitcnt lgkmcnt(6)
v_mfma_f32_32x32x16_bf16 v[128:143], a[168:171], a[32:35], v[128:143]
ds_read_b64_tr_b16 a[184:185], v147 offset:28672
ds_read_b64_tr_b16 a[186:187], v147 offset:29952
v_mfma_f32_16x16x32_bf16 v[232:235], a[168:171], v[246:249], v[232:235]
s_add_u32 m0, s74, 46080
s_nop 0
buffer_load_dwordx4 v7, s[36:39], s77 offen lds
s_waitcnt lgkmcnt(6)
v_mfma_f32_32x32x16_bf16 v[32:47], a[172:175], a[36:39], v[32:47]
ds_read_b64_tr_b16 a[188:189], v147 offset:28736
ds_read_b64_tr_b16 a[190:191], v147 offset:30016
ds_read_b128 a[48:51], v16 offset:0
ds_read_b128 a[52:55], v17 offset:0
ds_read_b128 a[56:59], v18 offset:0
ds_read_b128 a[60:63], v19 offset:0
ds_read_b128 v[176:179], v16 offset:0
ds_read_b128 v[180:183], v17 offset:0
ds_read_b128 v[184:187], v18 offset:0
ds_read_b128 v[188:191], v19 offset:0
s_waitcnt lgkmcnt(14)
v_mfma_f32_32x32x16_bf16 v[48:63], a[176:179], a[36:39], v[48:63]
ds_read_b64_tr_b16 a[192:193], v147 offset:28800
ds_read_b64_tr_b16 a[194:195], v147 offset:30080
s_add_u32 m0, s74, 47104
s_nop 0
buffer_load_dwordx4 v8, s[36:39], s77 offen lds
s_waitcnt lgkmcnt(14)
v_mfma_f32_32x32x16_bf16 v[64:79], a[180:183], a[36:39], v[64:79]
ds_read_b64_tr_b16 a[196:197], v147 offset:28864
ds_read_b64_tr_b16 a[198:199], v147 offset:30144
s_waitcnt lgkmcnt(14)
v_mfma_f32_32x32x16_bf16 v[80:95], a[184:187], a[36:39], v[80:95]
ds_read_b64_tr_b16 a[200:201], v157 offset:16384
ds_read_b64_tr_b16 a[202:203], v157 offset:17152
s_add_u32 m0, s74, 48128
s_nop 0
buffer_load_dwordx4 v9, s[36:39], s77 offen lds
s_waitcnt lgkmcnt(14)
v_mfma_f32_32x32x16_bf16 v[96:111], a[188:191], a[36:39], v[96:111]
ds_read_b64_tr_b16 a[204:205], v157 offset:16448
ds_read_b64_tr_b16 a[206:207], v157 offset:17216
s_waitcnt lgkmcnt(8)
v_dot2c_f32_bf16 v20, s65, v176
v_dot2c_f32_bf16 v24, v176, v176
v_dot2c_f32_bf16 v21, s65, v177
v_dot2c_f32_bf16 v25, v177, v177
v_dot2c_f32_bf16 v14, s65, v178
v_dot2c_f32_bf16 v192, v178, v178
v_dot2c_f32_bf16 v15, s65, v179
v_dot2c_f32_bf16 v193, v179, v179
v_dot2c_f32_bf16 v20, s65, v180
v_dot2c_f32_bf16 v24, v180, v180
v_dot2c_f32_bf16 v21, s65, v181
v_dot2c_f32_bf16 v25, v181, v181
v_dot2c_f32_bf16 v14, s65, v182
v_dot2c_f32_bf16 v192, v182, v182
v_dot2c_f32_bf16 v15, s65, v183
v_dot2c_f32_bf16 v193, v183, v183
v_dot2c_f32_bf16 v20, s65, v184
v_dot2c_f32_bf16 v24, v184, v184
v_dot2c_f32_bf16 v21, s65, v185
v_dot2c_f32_bf16 v25, v185, v185
v_dot2c_f32_bf16 v14, s65, v186
v_dot2c_f32_bf16 v192, v186, v186
v_dot2c_f32_bf16 v15, s65, v187
v_dot2c_f32_bf16 v193, v187, v187
v_dot2c_f32_bf16 v20, s65, v188
v_dot2c_f32_bf16 v24, v188, v188
v_dot2c_f32_bf16 v21, s65, v189
v_dot2c_f32_bf16 v25, v189, v189
v_dot2c_f32_bf16 v14, s65, v190
v_dot2c_f32_bf16 v192, v190, v190
v_dot2c_f32_bf16 v15, s65, v191
v_dot2c_f32_bf16 v193, v191, v191
s_waitcnt lgkmcnt(6)
v_mfma_f32_32x32x16_bf16 v[112:127], a[192:195], a[36:39], v[112:127]
ds_read_b64_tr_b16 a[160:161], v157 offset:16512
ds_read_b64_tr_b16 a[162:163], v157 offset:17280
s_add_u32 m0, s74, 49152
s_nop 0
buffer_load_dwordx4 v10, s[36:39], s77 offen lds
s_add_u32 s77, s77, 221184
s_sub_u32 s87, s77, 2211840
s_cmp_ge_u32 s77, 2211840
s_cselect_b32 s77, s87, s77
s_waitcnt lgkmcnt(6)
v_mfma_f32_32x32x16_bf16 v[128:143], a[196:199], a[36:39], v[128:143]
ds_read_b64_tr_b16 a[164:165], v149 offset:28672
ds_read_b64_tr_b16 a[166:167], v149 offset:29952
s_add_u32 s60, s70, s86
s_add_u32 m0, s88, 0
s_nop 0
buffer_load_dwordx4 v22, s[24:27], s60 offen lds
s_waitcnt lgkmcnt(6)
v_mfma_f32_32x32x16_bf16 v[32:47], a[200:203], a[40:43], v[32:47]
ds_read_b64_tr_b16 a[168:169], v149 offset:28736
ds_read_b64_tr_b16 a[170:171], v149 offset:30016
s_waitcnt lgkmcnt(6)
v_mfma_f32_32x32x16_bf16 v[48:63], a[204:207], a[40:43], v[48:63]
ds_read_b64_tr_b16 a[172:173], v149 offset:28800
ds_read_b64_tr_b16 a[174:175], v149 offset:30080
s_add_u32 s60, s70, s86
s_add_u32 m0, s88, 1024
s_nop 0
buffer_load_dwordx4 v23, s[24:27], s60 offen lds
s_waitcnt lgkmcnt(6)
v_mfma_f32_32x32x16_bf16 v[64:79], a[160:163], a[40:43], v[64:79]
ds_read_b64_tr_b16 a[176:177], v149 offset:28864
ds_read_b64_tr_b16 a[178:179], v149 offset:30144
s_waitcnt lgkmcnt(6)
v_mfma_f32_32x32x16_bf16 v[80:95], a[164:167], a[40:43], v[80:95]
ds_read_b64_tr_b16 a[180:181], v159 offset:16384
ds_read_b64_tr_b16 a[182:183], v159 offset:17152
s_add_u32 s60, s70, s86
s_add_u32 m0, s88, 2048
s_nop 0
buffer_load_dwordx4 v26, s[24:27], s60 offen lds
s_waitcnt lgkmcnt(6)
v_mfma_f32_32x32x16_bf16 v[96:111], a[168:171], a[40:43], v[96:111]
ds_read_b64_tr_b16 a[184:185], v159 offset:16448
ds_read_b64_tr_b16 a[186:187], v159 offset:17216
s_waitcnt lgkmcnt(6)
v_mfma_f32_32x32x16_bf16 v[112:127], a[172:175], a[40:43], v[112:127]
ds_read_b64_tr_b16 a[188:189], v159 offset:16512
ds_read_b64_tr_b16 a[190:191], v159 offset:17280
s_add_u32 s60, s70, s86
s_add_u32 m0, s88, 3072
s_nop 0
buffer_load_dwordx4 v27, s[24:27], s60 offen lds
s_add_u32 s86, s86, 128
s_cmp_ge_u32 s86, 1280
s_cselect_b32 s86, 0, s86
s_waitcnt lgkmcnt(6)
v_mfma_f32_32x32x16_bf16 v[128:143], a[176:179], a[40:43], v[128:143]
ds_read_b64_tr_b16 a[192:193], v151 offset:28672
ds_read_b64_tr_b16 a[194:195], v151 offset:29952
s_waitcnt lgkmcnt(6)
v_mfma_f32_32x32x16_bf16 v[32:47], a[180:183], a[44:47], v[32:47]
ds_read_b64_tr_b16 a[196:197], v151 offset:28736
ds_read_b64_tr_b16 a[198:199], v151 offset:30016
s_waitcnt lgkmcnt(6)
v_mfma_f32_32x32x16_bf16 v[48:63], a[184:187], a[44:47], v[48:63]
ds_read_b64_tr_b16 a[200:201], v151 offset:28800
ds_read_b64_tr_b16 a[202:203], v151 offset:30080
s_waitcnt lgkmcnt(6)
v_mfma_f32_32x32x16_bf16 v[64:79], a[188:191], a[44:47], v[64:79]
ds_read_b64_tr_b16 a[204:205], v151 offset:28864
ds_read_b64_tr_b16 a[206:207], v151 offset:30144
s_waitcnt lgkmcnt(6)
v_mfma_f32_32x32x16_bf16 v[80:95], a[192:195], a[44:47], v[80:95]
s_waitcnt lgkmcnt(4)
v_mfma_f32_32x32x16_bf16 v[96:111], a[196:199], a[44:47], v[96:111]
s_waitcnt lgkmcnt(0)
s_waitcnt vmcnt(16)
s_barrier
ds_read_b64_tr_b16 a[160:161], v152 offset:0
ds_read_b64_tr_b16 a[162:163], v152 offset:768
ds_read_b64_tr_b16 a[164:165], v152 offset:64
ds_read_b64_tr_b16 a[166:167], v152 offset:832
v_mfma_f32_32x32x16_bf16 v[112:127], a[200:203], a[44:47], v[112:127]
ds_read_b64_tr_b16 a[168:169], v152 offset:128
ds_read_b64_tr_b16 a[170:171], v152 offset:896
s_add_u32 m0, s75, 65536
s_nop 0
buffer_load_dwordx4 v11, s[28:31], s76 offen lds
v_mfma_f32_32x32x16_bf16 v[128:143], a[204:207], a[44:47], v[128:143]
ds_read_b64_tr_b16 a[172:173], v144 offset:12288
ds_read_b64_tr_b16 a[174:175], v144 offset:13568
s_waitcnt lgkmcnt(6)
v_mfma_f32_32x32x16_bf16 v[32:47], a[160:163], a[48:51], v[32:47]
ds_read_b64_tr_b16 a[176:177], v144 offset:12352
ds_read_b64_tr_b16 a[178:179], v144 offset:13632
v_mfma_f32_16x16x32_bf16 v[208:211], a[160:163], v[246:249], v[208:211]
s_add_u32 m0, s75, 66560
s_nop 0
buffer_load_dwordx4 v12, s[28:31], s76 offen lds
s_waitcnt lgkmcnt(6)
v_mfma_f32_32x32x16_bf16 v[48:63], a[164:167], a[48:51], v[48:63]
ds_read_b64_tr_b16 a[180:181], v144 offset:12416
ds_read_b64_tr_b16 a[182:183], v144 offset:13696
v_mfma_f32_16x16x32_bf16 v[212:215], a[164:167], v[246:249], v[212:215]
s_waitcnt lgkmcnt(6)
v_mfma_f32_32x32x16_bf16 v[64:79], a[168:171], a[48:51], v[64:79]
ds_read_b64_tr_b16 a[184:185], v144 offset:12480
ds_read_b64_tr_b16 a[186:187], v144 offset:13760
v_mfma_f32_16x16x32_bf16 v[216:219], a[168:171], v[246:249], v[216:219]
s_add_u32 m0, s75, 67584
s_nop 0
buffer_load_dwordx4 v13, s[28:31], s76 offen lds
s_add_u32 s76, s76, 245760
s_sub_u32 s87, s76, 2457600
s_cmp_ge_u32 s76, 2457600
s_cselect_b32 s76, s87, s76
s_lshr_b32 s60, s56, 1
s_and_b32 s61, s56, 1
s_mul_i32 s62, s61, 5
v_add_u32 v198, 0, v1
v_mul_u32_u24 v199, 13108, v198
v_lshrrev_b32 v199, 16, v199
v_mul_u32_u24 v200, 5, v199
v_sub_u32 v200, v198, v200
v_lshrrev_b32 v201, 2, v199
v_add_u32 v201, s62, v201
v_and_b32 v202, 1, v201
v_lshlrev_b32 v202, 2, v202
v_and_b32 v199, 3, v199
v_add_u32 v202, v202, v199
v_lshrrev_b32 v201, 1, v201
v_cmp_gt_u32 vcc, 4, v200
v_mov_b32 v199, 6
v_mov_b32 v203, s61
v_cndmask_b32 v199, v199, v203, vcc
v_add_u32 v201, v201, v199
v_cndmask_b32 v200, v203, v200, vcc
v_lshlrev_b32_e64 v201, 10, v201
v_lshl_add_u32 v201, v200, 7, v201
v_lshl_add_u32 v201, v202, 1, v201
s_mul_i32 s63, s60, 576
s_add_u32 s63, s63, 147456
v_add_u32_e64 v201, s63, v201
ds_write_b16 v201, v194
ds_write_b16_d16_hi v201, v194 offset:16
ds_write_b16 v201, v195 offset:32
ds_write_b16_d16_hi v201, v195 offset:48
v_add_u32_e64 v198, 64, v1
v_mul_u32_u24 v199, 13108, v198
v_lshrrev_b32 v199, 16, v199
v_mul_u32_u24 v200, 5, v199
v_sub_u32 v200, v198, v200
v_lshrrev_b32 v201, 2, v199
v_add_u32 v201, s62, v201
v_and_b32 v202, 1, v201
v_lshlrev_b32 v202, 2, v202
v_and_b32 v199, 3, v199
v_add_u32 v202, v202, v199
v_lshrrev_b32 v201, 1, v201
v_cmp_gt_u32 vcc, 4, v200
v_mov_b32 v199, 6
v_mov_b32 v203, s61
v_cndmask_b32 v199, v199, v203, vcc
v_add_u32 v201, v201, v199
v_cndmask_b32 v200, v203, v200, vcc
v_lshlrev_b32_e64 v201, 10, v201
v_lshl_add_u32 v201, v200, 7, v201
v_lshl_add_u32 v201, v202, 1, v201
s_mul_i32 s63, s60, 576
s_add_u32 s63, s63, 147456
v_add_u32_e64 v201, s63, v201
v_cmp_gt_u32 vcc, 100, v198
v_mov_b32 v199, 158976
s_nop 0
v_cndmask_b32 v201, v199, v201, vcc
ds_write_b16 v201, v196
ds_write_b16_d16_hi v201, v196 offset:16
ds_write_b16 v201, v197 offset:32
ds_write_b16_d16_hi v201, v197 offset:48
s_waitcnt lgkmcnt(14)
v_mfma_f32_32x32x16_bf16 v[80:95], a[172:175], a[48:51], v[80:95]
ds_read_b64_tr_b16 a[188:189], v154 offset:0
ds_read_b64_tr_b16 a[190:191], v154 offset:768
v_mfma_f32_16x16x32_bf16 v[220:223], a[172:175], v[246:249], v[220:223]
s_waitcnt lgkmcnt(14)
v_mfma_f32_32x32x16_bf16 v[96:111], a[176:179], a[48:51], v[96:111]
ds_read_b64_tr_b16 a[192:193], v154 offset:64
ds_read_b64_tr_b16 a[194:195], v154 offset:832
v_mfma_f32_16x16x32_bf16 v[224:227], a[176:179], v[246:249], v[224:227]
s_add_u32 m0, s74, 77824
s_nop 0
buffer_load_dwordx4 v6, s[36:39], s77 offen lds
s_waitcnt lgkmcnt(14)
v_mfma_f32_32x32x16_bf16 v[112:127], a[180:183], a[48:51], v[112:127]
ds_read_b64_tr_b16 a[196:197], v154 offset:128
ds_read_b64_tr_b16 a[198:199], v154 offset:896
v_mfma_f32_16x16x32_bf16 v[228:231], a[180:183], v[246:249], v[228:231]
s_waitcnt lgkmcnt(14)
v_mfma_f32_32x32x16_bf16 v[128:143], a[184:187], a[48:51], v[128:143]
ds_read_b64_tr_b16 a[200:201], v146 offset:12288
ds_read_b64_tr_b16 a[202:203], v146 offset:13568
v_mfma_f32_16x16x32_bf16 v[232:235], a[184:187], v[246:249], v[232:235]
s_add_u32 m0, s74, 78848
s_nop 0
buffer_load_dwordx4 v7, s[36:39], s77 offen lds
s_waitcnt lgkmcnt(6)
v_mfma_f32_32x32x16_bf16 v[32:47], a[188:191], a[52:55], v[32:47]
ds_read_b64_tr_b16 a[204:205], v146 offset:12352
ds_read_b64_tr_b16 a[206:207], v146 offset:13632
ds_read_b128 a[64:67], v16 offset:4096
ds_read_b128 a[68:71], v17 offset:4096
ds_read_b128 a[72:75], v18 offset:4096
ds_read_b128 a[76:79], v19 offset:4096
ds_read_b128 v[160:163], v16 offset:4096
ds_read_b128 v[164:167], v17 offset:4096
ds_read_b128 v[168:171], v18 offset:4096
ds_read_b128 v[172:175], v19 offset:4096
s_waitcnt lgkmcnt(14)
v_mfma_f32_32x32x16_bf16 v[48:63], a[192:195], a[52:55], v[48:63]
ds_read_b64_tr_b16 a[160:161], v146 offset:12416
ds_read_b64_tr_b16 a[162:163], v146 offset:13696
s_add_u32 m0, s74, 79872
s_nop 0
buffer_load_dwordx4 v8, s[36:39], s77 offen lds
s_waitcnt lgkmcnt(14)
v_mfma_f32_32x32x16_bf16 v[64:79], a[196:199], a[52:55], v[64:79]
ds_read_b64_tr_b16 a[164:165], v146 offset:12480
ds_read_b64_tr_b16 a[166:167], v146 offset:13760
s_waitcnt lgkmcnt(14)
v_mfma_f32_32x32x16_bf16 v[80:95], a[200:203], a[52:55], v[80:95]
ds_read_b64_tr_b16 a[168:169], v156 offset:0
ds_read_b64_tr_b16 a[170:171], v156 offset:768
s_add_u32 m0, s74, 80896
s_nop 0
buffer_load_dwordx4 v9, s[36:39], s77 offen lds
s_waitcnt lgkmcnt(14)
v_mfma_f32_32x32x16_bf16 v[96:111], a[204:207], a[52:55], v[96:111]
ds_read_b64_tr_b16 a[172:173], v156 offset:64
ds_read_b64_tr_b16 a[174:175], v156 offset:832
s_waitcnt lgkmcnt(8)
v_dot2c_f32_bf16 v20, s65, v160
v_dot2c_f32_bf16 v24, v160, v160
v_dot2c_f32_bf16 v21, s65, v161
v_dot2c_f32_bf16 v25, v161, v161
v_dot2c_f32_bf16 v14, s65, v162
v_dot2c_f32_bf16 v192, v162, v162
v_dot2c_f32_bf16 v15, s65, v163
v_dot2c_f32_bf16 v193, v163, v163
v_dot2c_f32_bf16 v20, s65, v164
v_dot2c_f32_bf16 v24, v164, v164
v_dot2c_f32_bf16 v21, s65, v165
v_dot2c_f32_bf16 v25, v165, v165
v_dot2c_f32_bf16 v14, s65, v166
v_dot2c_f32_bf16 v192, v166, v166
v_dot2c_f32_bf16 v15, s65, v167
v_dot2c_f32_bf16 v193, v167, v167
v_dot2c_f32_bf16 v20, s65, v168
v_dot2c_f32_bf16 v24, v168, v168
v_dot2c_f32_bf16 v21, s65, v169
v_dot2c_f32_bf16 v25, v169, v169
v_dot2c_f32_bf16 v14, s65, v170
v_dot2c_f32_bf16 v192, v170, v170
v_dot2c_f32_bf16 v15, s65, v171
v_dot2c_f32_bf16 v193, v171, v171
v_dot2c_f32_bf16 v20, s65, v172
v_dot2c_f32_bf16 v24, v172, v172
v_dot2c_f32_bf16 v21, s65, v173
v_dot2c_f32_bf16 v25, v173, v173
v_dot2c_f32_bf16 v14, s65, v174
v_dot2c_f32_bf16 v192, v174, v174
v_dot2c_f32_bf16 v15, s65, v175
v_dot2c_f32_bf16 v193, v175, v175
s_waitcnt lgkmcnt(6)
v_mfma_f32_32x32x16_bf16 v[112:127], a[160:163], a[52:55], v[112:127]
ds_read_b64_tr_b16 a[176:177], v156 offset:128
ds_read_b64_tr_b16 a[178:179], v156 offset:896
s_add_u32 m0, s74, 81920
s_nop 0
buffer_load_dwordx4 v10, s[36:39], s77 offen lds
s_add_u32 s77, s77, 221184
s_sub_u32 s87, s77, 2211840
s_cmp_ge_u32 s77, 2211840
s_cselect_b32 s77, s87, s77
s_waitcnt lgkmcnt(6)
v_mfma_f32_32x32x16_bf16 v[128:143], a[164:167], a[52:55], v[128:143]
ds_read_b64_tr_b16 a[180:181], v148 offset:12288
ds_read_b64_tr_b16 a[182:183], v148 offset:13568
s_add_u32 s60, s70, s86
s_add_u32 m0, s88, 4096
s_nop 0
buffer_load_dwordx4 v22, s[24:27], s60 offen lds
s_waitcnt lgkmcnt(6)
v_mfma_f32_32x32x16_bf16 v[32:47], a[168:171], a[56:59], v[32:47]
ds_read_b64_tr_b16 a[184:185], v148 offset:12352
ds_read_b64_tr_b16 a[186:187], v148 offset:13632
s_waitcnt lgkmcnt(6)
v_mfma_f32_32x32x16_bf16 v[48:63], a[172:175], a[56:59], v[48:63]
ds_read_b64_tr_b16 a[188:189], v148 offset:12416
ds_read_b64_tr_b16 a[190:191], v148 offset:13696
s_add_u32 s60, s70, s86
s_add_u32 m0, s88, 5120
s_nop 0
buffer_load_dwordx4 v23, s[24:27], s60 offen lds
s_waitcnt lgkmcnt(6)
v_mfma_f32_32x32x16_bf16 v[64:79], a[176:179], a[56:59], v[64:79]
ds_read_b64_tr_b16 a[192:193], v148 offset:12480
ds_read_b64_tr_b16 a[194:195], v148 offset:13760
s_waitcnt lgkmcnt(6)
v_mfma_f32_32x32x16_bf16 v[80:95], a[180:183], a[56:59], v[80:95]
ds_read_b64_tr_b16 a[196:197], v158 offset:0
ds_read_b64_tr_b16 a[198:199], v158 offset:768
s_add_u32 s60, s70, s86
s_add_u32 m0, s88, 6144
s_nop 0
buffer_load_dwordx4 v26, s[24:27], s60 offen lds
s_waitcnt lgkmcnt(6)
v_mfma_f32_32x32x16_bf16 v[96:111], a[184:187], a[56:59], v[96:111]
ds_read_b64_tr_b16 a[200:201], v158 offset:64
ds_read_b64_tr_b16 a[202:203], v158 offset:832
s_waitcnt lgkmcnt(6)
v_mfma_f32_32x32x16_bf16 v[112:127], a[188:191], a[56:59], v[112:127]
ds_read_b64_tr_b16 a[204:205], v158 offset:128
ds_read_b64_tr_b16 a[206:207], v158 offset:896
s_add_u32 s60, s70, s86
s_add_u32 m0, s88, 7168
s_nop 0
buffer_load_dwordx4 v27, s[24:27], s60 offen lds
s_add_u32 s86, s86, 128
s_cmp_ge_u32 s86, 1280
s_cselect_b32 s86, 0, s86
s_waitcnt lgkmcnt(6)
v_mfma_f32_32x32x16_bf16 v[128:143], a[192:195], a[56:59], v[128:143]
ds_read_b64_tr_b16 a[160:161], v150 offset:12288
ds_read_b64_tr_b16 a[162:163], v150 offset:13568
s_waitcnt lgkmcnt(6)
v_mfma_f32_32x32x16_bf16 v[32:47], a[196:199], a[60:63], v[32:47]
ds_read_b64_tr_b16 a[164:165], v150 offset:12352
ds_read_b64_tr_b16 a[166:167], v150 offset:13632
s_waitcnt lgkmcnt(6)
v_mfma_f32_32x32x16_bf16 v[48:63], a[200:203], a[60:63], v[48:63]
ds_read_b64_tr_b16 a[168:169], v150 offset:12416
ds_read_b64_tr_b16 a[170:171], v150 offset:13696
s_waitcnt lgkmcnt(6)
v_mfma_f32_32x32x16_bf16 v[64:79], a[204:207], a[60:63], v[64:79]
ds_read_b64_tr_b16 a[172:173], v150 offset:12480
ds_read_b64_tr_b16 a[174:175], v150 offset:13760
s_waitcnt lgkmcnt(6)
v_mfma_f32_32x32x16_bf16 v[80:95], a[160:163], a[60:63], v[80:95]
s_waitcnt lgkmcnt(4)
v_mfma_f32_32x32x16_bf16 v[96:111], a[164:167], a[60:63], v[96:111]
s_waitcnt lgkmcnt(0)
s_waitcnt vmcnt(16)
s_barrier
ds_read_b64_tr_b16 a[176:177], v152 offset:32768
ds_read_b64_tr_b16 a[178:179], v152 offset:33536
ds_read_b64_tr_b16 a[180:181], v152 offset:32832
ds_read_b64_tr_b16 a[182:183], v152 offset:33600
v_mfma_f32_32x32x16_bf16 v[112:127], a[168:171], a[60:63], v[112:127]
ds_read_b64_tr_b16 a[184:185], v152 offset:32896
ds_read_b64_tr_b16 a[186:187], v152 offset:33664
s_add_u32 m0, s75, 0
s_nop 0
buffer_load_dwordx4 v11, s[28:31], s76 offen lds
v_mfma_f32_32x32x16_bf16 v[128:143], a[172:175], a[60:63], v[128:143]
ds_read_b64_tr_b16 a[188:189], v144 offset:45056
ds_read_b64_tr_b16 a[190:191], v144 offset:46336
s_waitcnt lgkmcnt(6)
v_mfma_f32_32x32x16_bf16 v[32:47], a[176:179], a[64:67], v[32:47]
ds_read_b64_tr_b16 a[192:193], v144 offset:45120
ds_read_b64_tr_b16 a[194:195], v144 offset:46400
v_mfma_f32_16x16x32_bf16 v[208:211], a[176:179], v[246:249], v[208:211]
s_add_u32 m0, s75, 1024
s_nop 0
buffer_load_dwordx4 v12, s[28:31], s76 offen lds
s_waitcnt lgkmcnt(6)
v_mfma_f32_32x32x16_bf16 v[48:63], a[180:183], a[64:67], v[48:63]
ds_read_b64_tr_b16 a[196:197], v144 offset:45184
ds_read_b64_tr_b16 a[198:199], v144 offset:46464
v_mfma_f32_16x16x32_bf16 v[212:215], a[180:183], v[246:249], v[212:215]
s_waitcnt lgkmcnt(6)
v_mfma_f32_32x32x16_bf16 v[64:79], a[184:187], a[64:67], v[64:79]
ds_read_b64_tr_b16 a[200:201], v144 offset:45248
ds_read_b64_tr_b16 a[202:203], v144 offset:46528
v_mfma_f32_16x16x32_bf16 v[216:219], a[184:187], v[246:249], v[216:219]
s_add_u32 m0, s75, 2048
s_nop 0
buffer_load_dwordx4 v13, s[28:31], s76 offen lds
s_add_u32 s76, s76, 245760
s_sub_u32 s87, s76, 2457600
s_cmp_ge_u32 s76, 2457600
s_cselect_b32 s76, s87, s76
v_lshlrev_b32_e64 v245, 10, v1
v_mov_b32 v251, 0x7f000000
v_cmp_gt_u32 vcc, 14, v1
s_nop 1
v_cndmask_b32_e64 v245, v251, v245, vcc
buffer_load_dword v251, v245, s[44:47], s93 offen sc1
s_waitcnt lgkmcnt(6)
v_mfma_f32_32x32x16_bf16 v[80:95], a[188:191], a[64:67], v[80:95]
ds_read_b64_tr_b16 a[204:205], v154 offset:32768
ds_read_b64_tr_b16 a[206:207], v154 offset:33536
v_mfma_f32_16x16x32_bf16 v[220:223], a[188:191], v[246:249], v[220:223]
s_waitcnt lgkmcnt(6)
v_mfma_f32_32x32x16_bf16 v[96:111], a[192:195], a[64:67], v[96:111]
ds_read_b64_tr_b16 a[160:161], v154 offset:32832
ds_read_b64_tr_b16 a[162:163], v154 offset:33600
v_mfma_f32_16x16x32_bf16 v[224:227], a[192:195], v[246:249], v[224:227]
s_add_u32 m0, s74, 12288
s_nop 0
buffer_load_dwordx4 v6, s[36:39], s77 offen lds
s_waitcnt lgkmcnt(6)
v_mfma_f32_32x32x16_bf16 v[112:127], a[196:199], a[64:67], v[112:127]
ds_read_b64_tr_b16 a[164:165], v154 offset:32896
ds_read_b64_tr_b16 a[166:167], v154 offset:33664
v_mfma_f32_16x16x32_bf16 v[228:231], a[196:199], v[246:249], v[228:231]
s_waitcnt lgkmcnt(6)
v_mfma_f32_32x32x16_bf16 v[128:143], a[200:203], a[64:67], v[128:143]
ds_read_b64_tr_b16 a[168:169], v146 offset:45056
ds_read_b64_tr_b16 a[170:171], v146 offset:46336
v_mfma_f32_16x16x32_bf16 v[232:235], a[200:203], v[246:249], v[232:235]
s_add_u32 m0, s74, 13312
s_nop 0
buffer_load_dwordx4 v7, s[36:39], s77 offen lds
s_waitcnt lgkmcnt(6)
v_mfma_f32_32x32x16_bf16 v[32:47], a[204:207], a[68:71], v[32:47]
ds_read_b64_tr_b16 a[172:173], v146 offset:45120
ds_read_b64_tr_b16 a[174:175], v146 offset:46400
ds_read_b128 a[80:83], v16 offset:8192
ds_read_b128 a[84:87], v17 offset:8192
ds_read_b128 a[88:91], v18 offset:8192
ds_read_b128 a[92:95], v19 offset:8192
ds_read_b128 v[176:179], v16 offset:8192
ds_read_b128 v[180:183], v17 offset:8192
ds_read_b128 v[184:187], v18 offset:8192
ds_read_b128 v[188:191], v19 offset:8192
s_waitcnt lgkmcnt(14)
v_mfma_f32_32x32x16_bf16 v[48:63], a[160:163], a[68:71], v[48:63]
ds_read_b64_tr_b16 a[176:177], v146 offset:45184
ds_read_b64_tr_b16 a[178:179], v146 offset:46464
s_add_u32 m0, s74, 14336
s_nop 0
buffer_load_dwordx4 v8, s[36:39], s77 offen lds
s_waitcnt lgkmcnt(14)
v_mfma_f32_32x32x16_bf16 v[64:79], a[164:167], a[68:71], v[64:79]
ds_read_b64_tr_b16 a[180:181], v146 offset:45248
ds_read_b64_tr_b16 a[182:183], v146 offset:46528
s_waitcnt lgkmcnt(14)
v_mfma_f32_32x32x16_bf16 v[80:95], a[168:171], a[68:71], v[80:95]
ds_read_b64_tr_b16 a[184:185], v156 offset:32768
ds_read_b64_tr_b16 a[186:187], v156 offset:33536
s_add_u32 m0, s74, 15360
s_nop 0
buffer_load_dwordx4 v9, s[36:39], s77 offen lds
s_waitcnt lgkmcnt(14)
v_mfma_f32_32x32x16_bf16 v[96:111], a[172:175], a[68:71], v[96:111]
ds_read_b64_tr_b16 a[188:189], v156 offset:32832
ds_read_b64_tr_b16 a[190:191], v156 offset:33600
s_waitcnt lgkmcnt(8)
v_dot2c_f32_bf16 v20, s65, v176
v_dot2c_f32_bf16 v24, v176, v176
v_dot2c_f32_bf16 v21, s65, v177
v_dot2c_f32_bf16 v25, v177, v177
v_dot2c_f32_bf16 v14, s65, v178
v_dot2c_f32_bf16 v192, v178, v178
v_dot2c_f32_bf16 v15, s65, v179
v_dot2c_f32_bf16 v193, v179, v179
v_dot2c_f32_bf16 v20, s65, v180
v_dot2c_f32_bf16 v24, v180, v180
v_dot2c_f32_bf16 v21, s65, v181
v_dot2c_f32_bf16 v25, v181, v181
v_dot2c_f32_bf16 v14, s65, v182
v_dot2c_f32_bf16 v192, v182, v182
v_dot2c_f32_bf16 v15, s65, v183
v_dot2c_f32_bf16 v193, v183, v183
v_dot2c_f32_bf16 v20, s65, v184
v_dot2c_f32_bf16 v24, v184, v184
v_dot2c_f32_bf16 v21, s65, v185
v_dot2c_f32_bf16 v25, v185, v185
v_dot2c_f32_bf16 v14, s65, v186
v_dot2c_f32_bf16 v192, v186, v186
v_dot2c_f32_bf16 v15, s65, v187
v_dot2c_f32_bf16 v193, v187, v187
v_dot2c_f32_bf16 v20, s65, v188
v_dot2c_f32_bf16 v24, v188, v188
v_dot2c_f32_bf16 v21, s65, v189
v_dot2c_f32_bf16 v25, v189, v189
v_dot2c_f32_bf16 v14, s65, v190
v_dot2c_f32_bf16 v192, v190, v190
v_dot2c_f32_bf16 v15, s65, v191
v_dot2c_f32_bf16 v193, v191, v191
s_waitcnt lgkmcnt(6)
v_mfma_f32_32x32x16_bf16 v[112:127], a[176:179], a[68:71], v[112:127]
ds_read_b64_tr_b16 a[192:193], v156 offset:32896
ds_read_b64_tr_b16 a[194:195], v156 offset:33664
s_add_u32 m0, s74, 16384
s_nop 0
buffer_load_dwordx4 v10, s[36:39], s77 offen lds
s_add_u32 s77, s77, 221184
s_sub_u32 s87, s77, 2211840
s_cmp_ge_u32 s77, 2211840
s_cselect_b32 s77, s87, s77
s_waitcnt lgkmcnt(6)
v_mfma_f32_32x32x16_bf16 v[128:143], a[180:183], a[68:71], v[128:143]
ds_read_b64_tr_b16 a[196:197], v148 offset:45056
ds_read_b64_tr_b16 a[198:199], v148 offset:46336
s_add_u32 s60, s70, s86
s_add_u32 m0, s88, 8192
s_nop 0
buffer_load_dwordx4 v22, s[24:27], s60 offen lds
s_waitcnt lgkmcnt(6)
v_mfma_f32_32x32x16_bf16 v[32:47], a[184:187], a[72:75], v[32:47]
ds_read_b64_tr_b16 a[200:201], v148 offset:45120
ds_read_b64_tr_b16 a[202:203], v148 offset:46400
s_waitcnt lgkmcnt(6)
v_mfma_f32_32x32x16_bf16 v[48:63], a[188:191], a[72:75], v[48:63]
ds_read_b64_tr_b16 a[204:205], v148 offset:45184
ds_read_b64_tr_b16 a[206:207], v148 offset:46464
s_add_u32 s60, s70, s86
s_add_u32 m0, s88, 9216
s_nop 0
buffer_load_dwordx4 v23, s[24:27], s60 offen lds
s_waitcnt lgkmcnt(6)
v_mfma_f32_32x32x16_bf16 v[64:79], a[192:195], a[72:75], v[64:79]
ds_read_b64_tr_b16 a[160:161], v148 offset:45248
ds_read_b64_tr_b16 a[162:163], v148 offset:46528
s_waitcnt lgkmcnt(6)
v_mfma_f32_32x32x16_bf16 v[80:95], a[196:199], a[72:75], v[80:95]
ds_read_b64_tr_b16 a[164:165], v158 offset:32768
ds_read_b64_tr_b16 a[166:167], v158 offset:33536
s_add_u32 s60, s70, s86
s_add_u32 m0, s88, 10240
s_nop 0
buffer_load_dwordx4 v26, s[24:27], s60 offen lds
s_waitcnt lgkmcnt(6)
v_mfma_f32_32x32x16_bf16 v[96:111], a[200:203], a[72:75], v[96:111]
ds_read_b64_tr_b16 a[168:169], v158 offset:32832
ds_read_b64_tr_b16 a[170:171], v158 offset:33600
s_waitcnt lgkmcnt(6)
v_mfma_f32_32x32x16_bf16 v[112:127], a[204:207], a[72:75], v[112:127]
ds_read_b64_tr_b16 a[172:173], v158 offset:32896
ds_read_b64_tr_b16 a[174:175], v158 offset:33664
s_add_u32 s60, s70, s86
s_add_u32 m0, s88, 11264
s_nop 0
buffer_load_dwordx4 v27, s[24:27], s60 offen lds
s_add_u32 s86, s86, 128
s_cmp_ge_u32 s86, 1280
s_cselect_b32 s86, 0, s86
s_waitcnt lgkmcnt(6)
v_mfma_f32_32x32x16_bf16 v[128:143], a[160:163], a[72:75], v[128:143]
ds_read_b64_tr_b16 a[176:177], v150 offset:45056
ds_read_b64_tr_b16 a[178:179], v150 offset:46336
s_waitcnt lgkmcnt(6)
v_mfma_f32_32x32x16_bf16 v[32:47], a[164:167], a[76:79], v[32:47]
ds_read_b64_tr_b16 a[180:181], v150 offset:45120
ds_read_b64_tr_b16 a[182:183], v150 offset:46400
s_waitcnt lgkmcnt(6)
v_mfma_f32_32x32x16_bf16 v[48:63], a[168:171], a[76:79], v[48:63]
ds_read_b64_tr_b16 a[184:185], v150 offset:45184
ds_read_b64_tr_b16 a[186:187], v150 offset:46464
s_waitcnt lgkmcnt(6)
v_mfma_f32_32x32x16_bf16 v[64:79], a[172:175], a[76:79], v[64:79]
ds_read_b64_tr_b16 a[188:189], v150 offset:45248
ds_read_b64_tr_b16 a[190:191], v150 offset:46528
s_waitcnt lgkmcnt(6)
v_mfma_f32_32x32x16_bf16 v[80:95], a[176:179], a[76:79], v[80:95]
s_waitcnt lgkmcnt(4)
v_mfma_f32_32x32x16_bf16 v[96:111], a[180:183], a[76:79], v[96:111]
s_waitcnt lgkmcnt(0)
s_waitcnt vmcnt(17)
s_barrier
ds_read_b64_tr_b16 a[192:193], v153 offset:16384
ds_read_b64_tr_b16 a[194:195], v153 offset:17152
ds_read_b64_tr_b16 a[196:197], v153 offset:16448
ds_read_b64_tr_b16 a[198:199], v153 offset:17216
v_mfma_f32_32x32x16_bf16 v[112:127], a[184:187], a[76:79], v[112:127]
ds_read_b64_tr_b16 a[200:201], v153 offset:16512
ds_read_b64_tr_b16 a[202:203], v153 offset:17280
s_add_u32 m0, s75, 32768
s_nop 0
buffer_load_dwordx4 v11, s[28:31], s76 offen lds
v_mfma_f32_32x32x16_bf16 v[128:143], a[188:191], a[76:79], v[128:143]
ds_read_b64_tr_b16 a[204:205], v145 offset:28672
ds_read_b64_tr_b16 a[206:207], v145 offset:29952
s_waitcnt lgkmcnt(6)
v_mfma_f32_32x32x16_bf16 v[32:47], a[192:195], a[80:83], v[32:47]
ds_read_b64_tr_b16 a[160:161], v145 offset:28736
ds_read_b64_tr_b16 a[162:163], v145 offset:30016
v_mfma_f32_16x16x32_bf16 v[208:211], a[192:195], v[246:249], v[208:211]
s_add_u32 m0, s75, 33792
s_nop 0
buffer_load_dwordx4 v12, s[28:31], s76 offen lds
s_waitcnt lgkmcnt(6)
v_mfma_f32_32x32x16_bf16 v[48:63], a[196:199], a[80:83], v[48:63]
ds_read_b64_tr_b16 a[164:165], v145 offset:28800
ds_read_b64_tr_b16 a[166:167], v145 offset:30080
v_mfma_f32_16x16x32_bf16 v[212:215], a[196:199], v[246:249], v[212:215]
s_waitcnt lgkmcnt(6)
v_mfma_f32_32x32x16_bf16 v[64:79], a[200:203], a[80:83], v[64:79]
ds_read_b64_tr_b16 a[168:169], v145 offset:28864
ds_read_b64_tr_b16 a[170:171], v145 offset:30144
v_mfma_f32_16x16x32_bf16 v[216:219], a[200:203], v[246:249], v[216:219]
s_add_u32 m0, s75, 34816
s_nop 0
buffer_load_dwordx4 v13, s[28:31], s76 offen lds
s_add_u32 s76, s76, 245760
s_sub_u32 s87, s76, 2457600
s_cmp_ge_u32 s76, 2457600
s_cselect_b32 s76, s87, s76
s_mov_b32 s62, 16383
s_waitcnt vmcnt(12)
L_wp_B:
v_cmp_eq_u32 vcc, s84, v251
s_and_b32 s60, vcc_lo, s62
s_cmp_eq_u32 s60, s62
s_cbranch_scc1 L_wpok_B
s_sub_u32 s7, s7, 1
s_cbranch_scc1 L_wpok_B
s_sleep 2
buffer_load_dword v251, v245, s[44:47], s93 offen sc1
s_waitcnt vmcnt(0)
s_branch L_wp_B
L_wpok_B:
v_lshlrev_b32 v240, 4, v1
v_add_u32 v241, 4096, v240
s_waitcnt lgkmcnt(6)
v_mfma_f32_32x32x16_bf16 v[80:95], a[204:207], a[80:83], v[80:95]
ds_read_b64_tr_b16 a[172:173], v155 offset:16384
ds_read_b64_tr_b16 a[174:175], v155 offset:17152
v_mfma_f32_16x16x32_bf16 v[220:223], a[204:207], v[246:249], v[220:223]
s_waitcnt lgkmcnt(6)
v_mfma_f32_32x32x16_bf16 v[96:111], a[160:163], a[80:83], v[96:111]
ds_read_b64_tr_b16 a[176:177], v155 offset:16448
ds_read_b64_tr_b16 a[178:179], v155 offset:17216
v_mfma_f32_16x16x32_bf16 v[224:227], a[160:163], v[246:249], v[224:227]
s_add_u32 m0, s74, 45056
s_nop 0
buffer_load_dwordx4 v6, s[36:39], s77 offen lds
s_waitcnt lgkmcnt(6)
v_mfma_f32_32x32x16_bf16 v[112:127], a[164:167], a[80:83], v[112:127]
ds_read_b64_tr_b16 a[180:181], v155 offset:16512
ds_read_b64_tr_b16 a[182:183], v155 offset:17280
v_mfma_f32_16x16x32_bf16 v[228:231], a[164:167], v[246:249], v[228:231]
s_waitcnt lgkmcnt(6)
v_mfma_f32_32x32x16_bf16 v[128:143], a[168:171], a[80:83], v[128:143]
ds_read_b64_tr_b16 a[184:185], v147 offset:28672
ds_read_b64_tr_b16 a[186:187], v147 offset:29952
v_mfma_f32_16x16x32_bf16 v[232:235], a[168:171], v[246:249], v[232:235]
s_add_u32 m0, s74, 46080
s_nop 0
buffer_load_dwordx4 v7, s[36:39], s77 offen lds
s_waitcnt lgkmcnt(6)
v_mfma_f32_32x32x16_bf16 v[32:47], a[172:175], a[84:87], v[32:47]
ds_read_b64_tr_b16 a[188:189], v147 offset:28736
ds_read_b64_tr_b16 a[190:191], v147 offset:30016
ds_read_b128 a[96:99], v16 offset:0
ds_read_b128 a[100:103], v17 offset:0
ds_read_b128 a[104:107], v18 offset:0
ds_read_b128 a[108:111], v19 offset:0
ds_read_b128 v[160:163], v16 offset:0
ds_read_b128 v[164:167], v17 offset:0
ds_read_b128 v[168:171], v18 offset:0
ds_read_b128 v[172:175], v19 offset:0
s_waitcnt lgkmcnt(14)
v_mfma_f32_32x32x16_bf16 v[48:63], a[176:179], a[84:87], v[48:63]
ds_read_b64_tr_b16 a[192:193], v147 offset:28800
ds_read_b64_tr_b16 a[194:195], v147 offset:30080
s_add_u32 m0, s74, 47104
s_nop 0
buffer_load_dwordx4 v8, s[36:39], s77 offen lds
s_waitcnt lgkmcnt(14)
v_mfma_f32_32x32x16_bf16 v[64:79], a[180:183], a[84:87], v[64:79]
ds_read_b64_tr_b16 a[196:197], v147 offset:28864
ds_read_b64_tr_b16 a[198:199], v147 offset:30144
s_waitcnt lgkmcnt(14)
v_mfma_f32_32x32x16_bf16 v[80:95], a[184:187], a[84:87], v[80:95]
ds_read_b64_tr_b16 a[200:201], v157 offset:16384
ds_read_b64_tr_b16 a[202:203], v157 offset:17152
s_add_u32 m0, s74, 48128
s_nop 0
buffer_load_dwordx4 v9, s[36:39], s77 offen lds
s_waitcnt lgkmcnt(14)
v_mfma_f32_32x32x16_bf16 v[96:111], a[188:191], a[84:87], v[96:111]
ds_read_b64_tr_b16 a[204:205], v157 offset:16448
ds_read_b64_tr_b16 a[206:207], v157 offset:17216
s_waitcnt lgkmcnt(8)
v_dot2c_f32_bf16 v20, s65, v160
v_dot2c_f32_bf16 v24, v160, v160
v_dot2c_f32_bf16 v21, s65, v161
v_dot2c_f32_bf16 v25, v161, v161
v_dot2c_f32_bf16 v14, s65, v162
v_dot2c_f32_bf16 v192, v162, v162
v_dot2c_f32_bf16 v15, s65, v163
v_dot2c_f32_bf16 v193, v163, v163
v_dot2c_f32_bf16 v20, s65, v164
v_dot2c_f32_bf16 v24, v164, v164
v_dot2c_f32_bf16 v21, s65, v165
v_dot2c_f32_bf16 v25, v165, v165
v_dot2c_f32_bf16 v14, s65, v166
v_dot2c_f32_bf16 v192, v166, v166
v_dot2c_f32_bf16 v15, s65, v167
v_dot2c_f32_bf16 v193, v167, v167
v_dot2c_f32_bf16 v20, s65, v168
v_dot2c_f32_bf16 v24, v168, v168
v_dot2c_f32_bf16 v21, s65, v169
v_dot2c_f32_bf16 v25, v169, v169
v_dot2c_f32_bf16 v14, s65, v170
v_dot2c_f32_bf16 v192, v170, v170
v_dot2c_f32_bf16 v15, s65, v171
v_dot2c_f32_bf16 v193, v171, v171
v_dot2c_f32_bf16 v20, s65, v172
v_dot2c_f32_bf16 v24, v172, v172
v_dot2c_f32_bf16 v21, s65, v173
v_dot2c_f32_bf16 v25, v173, v173
v_dot2c_f32_bf16 v14, s65, v174
v_dot2c_f32_bf16 v192, v174, v174
v_dot2c_f32_bf16 v15, s65, v175
v_dot2c_f32_bf16 v193, v175, v175
s_waitcnt lgkmcnt(6)
v_mfma_f32_32x32x16_bf16 v[112:127], a[192:195], a[84:87], v[112:127]
ds_read_b64_tr_b16 a[160:161], v157 offset:16512
ds_read_b64_tr_b16 a[162:163], v157 offset:17280
s_add_u32 m0, s74, 49152
s_nop 0
buffer_load_dwordx4 v10, s[36:39], s77 offen lds
s_add_u32 s77, s77, 221184
s_sub_u32 s87, s77, 2211840
s_cmp_ge_u32 s77, 2211840
s_cselect_b32 s77, s87, s77
s_waitcnt lgkmcnt(6)
v_mfma_f32_32x32x16_bf16 v[128:143], a[196:199], a[84:87], v[128:143]
ds_read_b64_tr_b16 a[164:165], v149 offset:28672
ds_read_b64_tr_b16 a[166:167], v149 offset:29952
s_add_u32 s60, s70, s86
s_add_u32 m0, s88, 0
s_nop 0
buffer_load_dwordx4 v22, s[24:27], s60 offen lds
s_waitcnt lgkmcnt(6)
v_mfma_f32_32x32x16_bf16 v[32:47], a[200:203], a[88:91], v[32:47]
ds_read_b64_tr_b16 a[168:169], v149 offset:28736
ds_read_b64_tr_b16 a[170:171], v149 offset:30016
s_waitcnt lgkmcnt(6)
v_mfma_f32_32x32x16_bf16 v[48:63], a[204:207], a[88:91], v[48:63]
ds_read_b64_tr_b16 a[172:173], v149 offset:28800
ds_read_b64_tr_b16 a[174:175], v149 offset:30080
s_add_u32 s60, s70, s86
s_add_u32 m0, s88, 1024
s_nop 0
buffer_load_dwordx4 v23, s[24:27], s60 offen lds
s_waitcnt lgkmcnt(6)
v_mfma_f32_32x32x16_bf16 v[64:79], a[160:163], a[88:91], v[64:79]
ds_read_b64_tr_b16 a[176:177], v149 offset:28864
ds_read_b64_tr_b16 a[178:179], v149 offset:30144
s_waitcnt lgkmcnt(6)
v_mfma_f32_32x32x16_bf16 v[80:95], a[164:167], a[88:91], v[80:95]
ds_read_b64_tr_b16 a[180:181], v159 offset:16384
ds_read_b64_tr_b16 a[182:183], v159 offset:17152
s_add_u32 s60, s70, s86
s_add_u32 m0, s88, 2048
s_nop 0
buffer_load_dwordx4 v26, s[24:27], s60 offen lds
s_waitcnt lgkmcnt(6)
v_mfma_f32_32x32x16_bf16 v[96:111], a[168:171], a[88:91], v[96:111]
ds_read_b64_tr_b16 a[184:185], v159 offset:16448
ds_read_b64_tr_b16 a[186:187], v159 offset:17216
s_waitcnt lgkmcnt(6)
v_mfma_f32_32x32x16_bf16 v[112:127], a[172:175], a[88:91], v[112:127]
ds_read_b64_tr_b16 a[188:189], v159 offset:16512
ds_read_b64_tr_b16 a[190:191], v159 offset:17280
s_add_u32 s60, s70, s86
s_add_u32 m0, s88, 3072
s_nop 0
buffer_load_dwordx4 v27, s[24:27], s60 offen lds
s_waitcnt lgkmcnt(6)
v_mfma_f32_32x32x16_bf16 v[128:143], a[176:179], a[88:91], v[128:143]
ds_read_b64_tr_b16 a[192:193], v151 offset:28672
ds_read_b64_tr_b16 a[194:195], v151 offset:29952
s_waitcnt lgkmcnt(6)
v_mfma_f32_32x32x16_bf16 v[32:47], a[180:183], a[92:95], v[32:47]
ds_read_b64_tr_b16 a[196:197], v151 offset:28736
ds_read_b64_tr_b16 a[198:199], v151 offset:30016
s_waitcnt lgkmcnt(6)
v_mfma_f32_32x32x16_bf16 v[48:63], a[184:187], a[92:95], v[48:63]
ds_read_b64_tr_b16 a[200:201], v151 offset:28800
ds_read_b64_tr_b16 a[202:203], v151 offset:30080
s_waitcnt lgkmcnt(6)
v_mfma_f32_32x32x16_bf16 v[64:79], a[188:191], a[92:95], v[64:79]
ds_read_b64_tr_b16 a[204:205], v151 offset:28864
ds_read_b64_tr_b16 a[206:207], v151 offset:30144
s_waitcnt lgkmcnt(6)
v_mfma_f32_32x32x16_bf16 v[80:95], a[192:195], a[92:95], v[80:95]
s_waitcnt lgkmcnt(4)
v_mfma_f32_32x32x16_bf16 v[96:111], a[196:199], a[92:95], v[96:111]
s_waitcnt lgkmcnt(0)
s_waitcnt vmcnt(16)
s_barrier
ds_read_b64_tr_b16 a[160:161], v152 offset:0
ds_read_b64_tr_b16 a[162:163], v152 offset:768
ds_read_b64_tr_b16 a[164:165], v152 offset:64
ds_read_b64_tr_b16 a[166:167], v152 offset:832
v_mfma_f32_32x32x16_bf16 v[112:127], a[200:203], a[92:95], v[112:127]
ds_read_b64_tr_b16 a[168:169], v152 offset:128
ds_read_b64_tr_b16 a[170:171], v152 offset:896
s_add_u32 m0, s75, 65536
s_nop 0
buffer_load_dwordx4 v11, s[28:31], s76 offen lds
v_mfma_f32_32x32x16_bf16 v[128:143], a[204:207], a[92:95], v[128:143]
ds_read_b64_tr_b16 a[172:173], v144 offset:12288
ds_read_b64_tr_b16 a[174:175], v144 offset:13568
s_waitcnt lgkmcnt(6)
v_mfma_f32_32x32x16_bf16 v[32:47], a[160:163], a[96:99], v[32:47]
ds_read_b64_tr_b16 a[176:177], v144 offset:12352
ds_read_b64_tr_b16 a[178:179], v144 offset:13632
v_mfma_f32_16x16x32_bf16 v[208:211], a[160:163], v[246:249], v[208:211]
s_add_u32 m0, s75, 66560
s_nop 0
buffer_load_dwordx4 v12, s[28:31], s76 offen lds
buffer_load_dwordx4 a[0:3], v240, s[44:47], s90 offen offset:0 sc1
s_waitcnt lgkmcnt(6)
v_mfma_f32_32x32x16_bf16 v[48:63], a[164:167], a[96:99], v[48:63]
ds_read_b64_tr_b16 a[180:181], v144 offset:12416
ds_read_b64_tr_b16 a[182:183], v144 offset:13696
v_mfma_f32_16x16x32_bf16 v[212:215], a[164:167], v[246:249], v[212:215]
s_waitcnt lgkmcnt(6)
v_mfma_f32_32x32x16_bf16 v[64:79], a[168:171], a[96:99], v[64:79]
ds_read_b64_tr_b16 a[184:185], v144 offset:12480
ds_read_b64_tr_b16 a[186:187], v144 offset:13760
v_mfma_f32_16x16x32_bf16 v[216:219], a[168:171], v[246:249], v[216:219]
s_add_u32 m0, s75, 67584
s_nop 0
buffer_load_dwordx4 v13, s[28:31], s76 offen lds
s_add_u32 s76, s76, 245760
s_sub_u32 s87, s76, 2457600
s_cmp_ge_u32 s76, 2457600
s_cselect_b32 s76, s87, s76
buffer_load_dwordx4 a[4:7], v240, s[44:47], s90 offen offset:1024 sc1
s_waitcnt lgkmcnt(6)
v_mfma_f32_32x32x16_bf16 v[80:95], a[172:175], a[96:99], v[80:95]
ds_read_b64_tr_b16 a[188:189], v154 offset:0
ds_read_b64_tr_b16 a[190:191], v154 offset:768
v_mfma_f32_16x16x32_bf16 v[220:223], a[172:175], v[246:249], v[220:223]
s_waitcnt lgkmcnt(6)
v_mfma_f32_32x32x16_bf16 v[96:111], a[176:179], a[96:99], v[96:111]
ds_read_b64_tr_b16 a[192:193], v154 offset:64
ds_read_b64_tr_b16 a[194:195], v154 offset:832
v_mfma_f32_16x16x32_bf16 v[224:227], a[176:179], v[246:249], v[224:227]
s_add_u32 m0, s74, 77824
s_nop 0
buffer_load_dwordx4 v6, s[36:39], s77 offen lds
buffer_load_dwordx4 a[8:11], v240, s[44:47], s90 offen offset:2048 sc1
s_waitcnt lgkmcnt(6)
v_mfma_f32_32x32x16_bf16 v[112:127], a[180:183], a[96:99], v[112:127]
ds_read_b64_tr_b16 a[196:197], v154 offset:128
ds_read_b64_tr_b16 a[198:199], v154 offset:896
v_mfma_f32_16x16x32_bf16 v[228:231], a[180:183], v[246:249], v[228:231]
s_waitcnt lgkmcnt(6)
v_mfma_f32_32x32x16_bf16 v[128:143], a[184:187], a[96:99], v[128:143]
ds_read_b64_tr_b16 a[200:201], v146 offset:12288
ds_read_b64_tr_b16 a[202:203], v146 offset:13568
v_mfma_f32_16x16x32_bf16 v[232:235], a[184:187], v[246:249], v[232:235]
s_add_u32 m0, s74, 78848
s_nop 0
buffer_load_dwordx4 v7, s[36:39], s77 offen lds
buffer_load_dwordx4 a[12:15], v240, s[44:47], s90 offen offset:3072 sc1
s_waitcnt lgkmcnt(6)
v_mfma_f32_32x32x16_bf16 v[32:47], a[188:191], a[100:103], v[32:47]
ds_read_b64_tr_b16 a[204:205], v146 offset:12352
ds_read_b64_tr_b16 a[206:207], v146 offset:13632
ds_read_b128 a[112:115], v16 offset:4096
ds_read_b128 a[116:119], v17 offset:4096
ds_read_b128 a[120:123], v18 offset:4096
ds_read_b128 a[124:127], v19 offset:4096
ds_read_b128 v[176:179], v16 offset:4096
ds_read_b128 v[180:183], v17 offset:4096
ds_read_b128 v[184:187], v18 offset:4096
ds_read_b128 v[188:191], v19 offset:4096
s_waitcnt lgkmcnt(14)
v_mfma_f32_32x32x16_bf16 v[48:63], a[192:195], a[100:103], v[48:63]
ds_read_b64_tr_b16 a[160:161], v146 offset:12416
ds_read_b64_tr_b16 a[162:163], v146 offset:13696
s_add_u32 m0, s74, 79872
s_nop 0
buffer_load_dwordx4 v8, s[36:39], s77 offen lds
buffer_load_dwordx4 a[16:19], v241, s[44:47], s90 offen sc1
s_add_u32 s90, s90, 5120
s_waitcnt lgkmcnt(14)
v_mfma_f32_32x32x16_bf16 v[64:79], a[196:199], a[100:103], v[64:79]
ds_read_b64_tr_b16 a[164:165], v146 offset:12480
ds_read_b64_tr_b16 a[166:167], v146 offset:13760
s_waitcnt lgkmcnt(14)
v_mfma_f32_32x32x16_bf16 v[80:95], a[200:203], a[100:103], v[80:95]
ds_read_b64_tr_b16 a[168:169], v156 offset:0
ds_read_b64_tr_b16 a[170:171], v156 offset:768
s_add_u32 m0, s74, 80896
s_nop 0
buffer_load_dwordx4 v9, s[36:39], s77 offen lds
buffer_load_dwordx4 a[20:23], v240, s[44:47], s90 offen offset:0 sc1
s_waitcnt lgkmcnt(14)
v_mfma_f32_32x32x16_bf16 v[96:111], a[204:207], a[100:103], v[96:111]
ds_read_b64_tr_b16 a[172:173], v156 offset:64
ds_read_b64_tr_b16 a[174:175], v156 offset:832
s_waitcnt lgkmcnt(8)
v_dot2c_f32_bf16 v20, s65, v176
v_dot2c_f32_bf16 v24, v176, v176
v_dot2c_f32_bf16 v21, s65, v177
v_dot2c_f32_bf16 v25, v177, v177
v_dot2c_f32_bf16 v14, s65, v178
v_dot2c_f32_bf16 v192, v178, v178
v_dot2c_f32_bf16 v15, s65, v179
v_dot2c_f32_bf16 v193, v179, v179
v_dot2c_f32_bf16 v20, s65, v180
v_dot2c_f32_bf16 v24, v180, v180
v_dot2c_f32_bf16 v21, s65, v181
v_dot2c_f32_bf16 v25, v181, v181
v_dot2c_f32_bf16 v14, s65, v182
v_dot2c_f32_bf16 v192, v182, v182
v_dot2c_f32_bf16 v15, s65, v183
v_dot2c_f32_bf16 v193, v183, v183
v_dot2c_f32_bf16 v20, s65, v184
v_dot2c_f32_bf16 v24, v184, v184
v_dot2c_f32_bf16 v21, s65, v185
v_dot2c_f32_bf16 v25, v185, v185
v_dot2c_f32_bf16 v14, s65, v186
v_dot2c_f32_bf16 v192, v186, v186
v_dot2c_f32_bf16 v15, s65, v187
v_dot2c_f32_bf16 v193, v187, v187
v_dot2c_f32_bf16 v20, s65, v188
v_dot2c_f32_bf16 v24, v188, v188
v_dot2c_f32_bf16 v21, s65, v189
v_dot2c_f32_bf16 v25, v189, v189
v_dot2c_f32_bf16 v14, s65, v190
v_dot2c_f32_bf16 v192, v190, v190
v_dot2c_f32_bf16 v15, s65, v191
v_dot2c_f32_bf16 v193, v191, v191
s_waitcnt lgkmcnt(6)
v_mfma_f32_32x32x16_bf16 v[112:127], a[160:163], a[100:103], v[112:127]
ds_read_b64_tr_b16 a[176:177], v156 offset:128
ds_read_b64_tr_b16 a[178:179], v156 offset:896
s_add_u32 m0, s74, 81920
s_nop 0
buffer_load_dwordx4 v10, s[36:39], s77 offen lds
s_add_u32 s77, s77, 221184
s_sub_u32 s87, s77, 2211840
s_cmp_ge_u32 s77, 2211840
s_cselect_b32 s77, s87, s77
buffer_load_dwordx4 a[24:27], v240, s[44:47], s90 offen offset:1024 sc1
s_waitcnt lgkmcnt(6)
v_mfma_f32_32x32x16_bf16 v[128:143], a[164:167], a[100:103], v[128:143]
ds_read_b64_tr_b16 a[180:181], v148 offset:12288
ds_read_b64_tr_b16 a[182:183], v148 offset:13568
s_waitcnt lgkmcnt(6)
v_mfma_f32_32x32x16_bf16 v[32:47], a[168:171], a[104:107], v[32:47]
ds_read_b64_tr_b16 a[184:185], v148 offset:12352
ds_read_b64_tr_b16 a[186:187], v148 offset:13632
buffer_load_dwordx4 a[28:31], v240, s[44:47], s90 offen offset:2048 sc1
s_waitcnt lgkmcnt(6)
v_mfma_f32_32x32x16_bf16 v[48:63], a[172:175], a[104:107], v[48:63]
ds_read_b64_tr_b16 a[188:189], v148 offset:12416
ds_read_b64_tr_b16 a[190:191], v148 offset:13696
s_waitcnt lgkmcnt(6)
v_mfma_f32_32x32x16_bf16 v[64:79], a[176:179], a[104:107], v[64:79]
ds_read_b64_tr_b16 a[192:193], v148 offset:12480
ds_read_b64_tr_b16 a[194:195], v148 offset:13760
buffer_load_dwordx4 a[32:35], v240, s[44:47], s90 offen offset:3072 sc1
s_waitcnt lgkmcnt(6)
v_mfma_f32_32x32x16_bf16 v[80:95], a[180:183], a[104:107], v[80:95]
ds_read_b64_tr_b16 a[196:197], v158 offset:0
ds_read_b64_tr_b16 a[198:199], v158 offset:768
s_waitcnt lgkmcnt(6)
v_mfma_f32_32x32x16_bf16 v[96:111], a[184:187], a[104:107], v[96:111]
ds_read_b64_tr_b16 a[200:201], v158 offset:64
ds_read_b64_tr_b16 a[202:203], v158 offset:832
buffer_load_dwordx4 a[36:39], v241, s[44:47], s90 offen sc1
s_add_u32 s90, s90, 5120
s_waitcnt lgkmcnt(6)
v_mfma_f32_32x32x16_bf16 v[112:127], a[188:191], a[104:107], v[112:127]
ds_read_b64_tr_b16 a[204:205], v158 offset:128
ds_read_b64_tr_b16 a[206:207], v158 offset:896
s_waitcnt lgkmcnt(6)
v_mfma_f32_32x32x16_bf16 v[128:143], a[192:195], a[104:107], v[128:143]
ds_read_b64_tr_b16 a[160:161], v150 offset:12288
ds_read_b64_tr_b16 a[162:163], v150 offset:13568
buffer_load_dwordx4 a[40:43], v240, s[44:47], s90 offen offset:0 sc1
s_waitcnt lgkmcnt(6)
v_mfma_f32_32x32x16_bf16 v[32:47], a[196:199], a[108:111], v[32:47]
ds_read_b64_tr_b16 a[164:165], v150 offset:12352
ds_read_b64_tr_b16 a[166:167], v150 offset:13632
s_waitcnt lgkmcnt(6)
v_mfma_f32_32x32x16_bf16 v[48:63], a[200:203], a[108:111], v[48:63]
ds_read_b64_tr_b16 a[168:169], v150 offset:12416
ds_read_b64_tr_b16 a[170:171], v150 offset:13696
buffer_load_dwordx4 a[44:47], v240, s[44:47], s90 offen offset:1024 sc1
s_waitcnt lgkmcnt(6)
v_mfma_f32_32x32x16_bf16 v[64:79], a[204:207], a[108:111], v[64:79]
ds_read_b64_tr_b16 a[172:173], v150 offset:12480
ds_read_b64_tr_b16 a[174:175], v150 offset:13760
s_waitcnt lgkmcnt(6)
v_mfma_f32_32x32x16_bf16 v[80:95], a[160:163], a[108:111], v[80:95]
buffer_load_dwordx4 a[48:51], v240, s[44:47], s90 offen offset:2048 sc1
s_waitcnt lgkmcnt(4)
v_mfma_f32_32x32x16_bf16 v[96:111], a[164:167], a[108:111], v[96:111]
s_waitcnt lgkmcnt(0)
s_waitcnt vmcnt(25)
s_barrier
ds_read_b64_tr_b16 a[176:177], v152 offset:32768
ds_read_b64_tr_b16 a[178:179], v152 offset:33536
ds_read_b64_tr_b16 a[180:181], v152 offset:32832
ds_read_b64_tr_b16 a[182:183], v152 offset:33600
v_mfma_f32_32x32x16_bf16 v[112:127], a[168:171], a[108:111], v[112:127]
ds_read_b64_tr_b16 a[184:185], v152 offset:32896
ds_read_b64_tr_b16 a[186:187], v152 offset:33664
s_add_u32 m0, s75, 0
s_nop 0
buffer_load_dwordx4 v11, s[28:31], s76 offen lds
buffer_load_dwordx4 a[52:55], v240, s[44:47], s90 offen offset:3072 sc1
v_mfma_f32_32x32x16_bf16 v[128:143], a[172:175], a[108:111], v[128:143]
ds_read_b64_tr_b16 a[188:189], v144 offset:45056
ds_read_b64_tr_b16 a[190:191], v144 offset:46336
s_waitcnt lgkmcnt(6)
v_mfma_f32_32x32x16_bf16 v[32:47], a[176:179], a[112:115], v[32:47]
ds_read_b64_tr_b16 a[192:193], v144 offset:45120
ds_read_b64_tr_b16 a[194:195], v144 offset:46400
v_mfma_f32_16x16x32_bf16 v[208:211], a[176:179], v[246:249], v[208:211]
s_add_u32 m0, s75, 1024
s_nop 0
buffer_load_dwordx4 v12, s[28:31], s76 offen lds
buffer_load_dwordx4 a[56:59], v241, s[44:47], s90 offen sc1
s_add_u32 s90, s90, 5120
s_waitcnt lgkmcnt(6)
v_mfma_f32_32x32x16_bf16 v[48:63], a[180:183], a[112:115], v[48:63]
ds_read_b64_tr_b16 a[196:197], v144 offset:45184
ds_read_b64_tr_b16 a[198:199], v144 offset:46464
v_mfma_f32_16x16x32_bf16 v[212:215], a[180:183], v[246:249], v[212:215]
s_waitcnt lgkmcnt(6)
v_mfma_f32_32x32x16_bf16 v[64:79], a[184:187], a[112:115], v[64:79]
ds_read_b64_tr_b16 a[200:201], v144 offset:45248
ds_read_b64_tr_b16 a[202:203], v144 offset:46528
v_mfma_f32_16x16x32_bf16 v[216:219], a[184:187], v[246:249], v[216:219]
s_add_u32 m0, s75, 2048
s_nop 0
buffer_load_dwordx4 v13, s[28:31], s76 offen lds
s_add_u32 s76, s76, 245760
s_sub_u32 s87, s76, 2457600
s_cmp_ge_u32 s76, 2457600
s_cselect_b32 s76, s87, s76
buffer_load_dwordx4 a[60:63], v240, s[44:47], s90 offen offset:0 sc1
s_waitcnt lgkmcnt(6)
v_mfma_f32_32x32x16_bf16 v[80:95], a[188:191], a[112:115], v[80:95]
ds_read_b64_tr_b16 a[204:205], v154 offset:32768
ds_read_b64_tr_b16 a[206:207], v154 offset:33536
v_mfma_f32_16x16x32_bf16 v[220:223], a[188:191], v[246:249], v[220:223]
s_waitcnt lgkmcnt(6)
v_mfma_f32_32x32x16_bf16 v[96:111], a[192:195], a[112:115], v[96:111]
ds_read_b64_tr_b16 a[160:161], v154 offset:32832
ds_read_b64_tr_b16 a[162:163], v154 offset:33600
v_mfma_f32_16x16x32_bf16 v[224:227], a[192:195], v[246:249], v[224:227]
s_add_u32 m0, s74, 12288
s_nop 0
buffer_load_dwordx4 v6, s[36:39], s77 offen lds
buffer_load_dwordx4 a[64:67], v240, s[44:47], s90 offen offset:1024 sc1
s_waitcnt lgkmcnt(6)
v_mfma_f32_32x32x16_bf16 v[112:127], a[196:199], a[112:115], v[112:127]
ds_read_b64_tr_b16 a[164:165], v154 offset:32896
ds_read_b64_tr_b16 a[166:167], v154 offset:33664
v_mfma_f32_16x16x32_bf16 v[228:231], a[196:199], v[246:249], v[228:231]
s_waitcnt lgkmcnt(6)
v_mfma_f32_32x32x16_bf16 v[128:143], a[200:203], a[112:115], v[128:143]
ds_read_b64_tr_b16 a[168:169], v146 offset:45056
ds_read_b64_tr_b16 a[170:171], v146 offset:46336
v_mfma_f32_16x16x32_bf16 v[232:235], a[200:203], v[246:249], v[232:235]
s_add_u32 m0, s74, 13312
s_nop 0
buffer_load_dwordx4 v7, s[36:39], s77 offen lds
buffer_load_dwordx4 a[68:71], v240, s[44:47], s90 offen offset:2048 sc1
s_waitcnt lgkmcnt(6)
v_mfma_f32_32x32x16_bf16 v[32:47], a[204:207], a[116:119], v[32:47]
ds_read_b64_tr_b16 a[172:173], v146 offset:45120
ds_read_b64_tr_b16 a[174:175], v146 offset:46400
ds_read_b128 a[128:131], v16 offset:8192
ds_read_b128 a[132:135], v17 offset:8192
ds_read_b128 a[136:139], v18 offset:8192
ds_read_b128 a[140:143], v19 offset:8192
ds_read_b128 v[160:163], v16 offset:8192
ds_read_b128 v[164:167], v17 offset:8192
ds_read_b128 v[168:171], v18 offset:8192
ds_read_b128 v[172:175], v19 offset:8192
s_waitcnt lgkmcnt(14)
v_mfma_f32_32x32x16_bf16 v[48:63], a[160:163], a[116:119], v[48:63]
ds_read_b64_tr_b16 a[176:177], v146 offset:45184
ds_read_b64_tr_b16 a[178:179], v146 offset:46464
s_add_u32 m0, s74, 14336
s_nop 0
buffer_load_dwordx4 v8, s[36:39], s77 offen lds
buffer_load_dwordx4 a[72:75], v240, s[44:47], s90 offen offset:3072 sc1
s_waitcnt lgkmcnt(14)
v_mfma_f32_32x32x16_bf16 v[64:79], a[164:167], a[116:119], v[64:79]
ds_read_b64_tr_b16 a[180:181], v146 offset:45248
ds_read_b64_tr_b16 a[182:183], v146 offset:46528
s_waitcnt lgkmcnt(14)
v_mfma_f32_32x32x16_bf16 v[80:95], a[168:171], a[116:119], v[80:95]
ds_read_b64_tr_b16 a[184:185], v156 offset:32768
ds_read_b64_tr_b16 a[186:187], v156 offset:33536
s_add_u32 m0, s74, 15360
s_nop 0
buffer_load_dwordx4 v9, s[36:39], s77 offen lds
buffer_load_dwordx4 a[76:79], v241, s[44:47], s90 offen sc1
s_add_u32 s90, s90, 5120
s_waitcnt lgkmcnt(14)
v_mfma_f32_32x32x16_bf16 v[96:111], a[172:175], a[116:119], v[96:111]
ds_read_b64_tr_b16 a[188:189], v156 offset:32832
ds_read_b64_tr_b16 a[190:191], v156 offset:33600
s_waitcnt lgkmcnt(8)
v_dot2c_f32_bf16 v20, s65, v160
v_dot2c_f32_bf16 v24, v160, v160
v_dot2c_f32_bf16 v21, s65, v161
v_dot2c_f32_bf16 v25, v161, v161
v_dot2c_f32_bf16 v14, s65, v162
v_dot2c_f32_bf16 v192, v162, v162
v_dot2c_f32_bf16 v15, s65, v163
v_dot2c_f32_bf16 v193, v163, v163
v_dot2c_f32_bf16 v20, s65, v164
v_dot2c_f32_bf16 v24, v164, v164
v_dot2c_f32_bf16 v21, s65, v165
v_dot2c_f32_bf16 v25, v165, v165
v_dot2c_f32_bf16 v14, s65, v166
v_dot2c_f32_bf16 v192, v166, v166
v_dot2c_f32_bf16 v15, s65, v167
v_dot2c_f32_bf16 v193, v167, v167
v_dot2c_f32_bf16 v20, s65, v168
v_dot2c_f32_bf16 v24, v168, v168
v_dot2c_f32_bf16 v21, s65, v169
v_dot2c_f32_bf16 v25, v169, v169
v_dot2c_f32_bf16 v14, s65, v170
v_dot2c_f32_bf16 v192, v170, v170
v_dot2c_f32_bf16 v15, s65, v171
v_dot2c_f32_bf16 v193, v171, v171
v_dot2c_f32_bf16 v20, s65, v172
v_dot2c_f32_bf16 v24, v172, v172
v_dot2c_f32_bf16 v21, s65, v173
v_dot2c_f32_bf16 v25, v173, v173
v_dot2c_f32_bf16 v14, s65, v174
v_dot2c_f32_bf16 v192, v174, v174
v_dot2c_f32_bf16 v15, s65, v175
v_dot2c_f32_bf16 v193, v175, v175
s_waitcnt lgkmcnt(6)
v_mfma_f32_32x32x16_bf16 v[112:127], a[176:179], a[116:119], v[112:127]
ds_read_b64_tr_b16 a[192:193], v156 offset:32896
ds_read_b64_tr_b16 a[194:195], v156 offset:33664
s_add_u32 m0, s74, 16384
s_nop 0
buffer_load_dwordx4 v10, s[36:39], s77 offen lds
s_add_u32 s77, s77, 221184
s_sub_u32 s87, s77, 2211840
s_cmp_ge_u32 s77, 2211840
s_cselect_b32 s77, s87, s77
buffer_load_dwordx4 a[80:83], v240, s[44:47], s90 offen offset:0 sc1
s_waitcnt lgkmcnt(6)
v_mfma_f32_32x32x16_bf16 v[128:143], a[180:183], a[116:119], v[128:143]
ds_read_b64_tr_b16 a[196:197], v148 offset:45056
ds_read_b64_tr_b16 a[198:199], v148 offset:46336
s_waitcnt lgkmcnt(6)
v_mfma_f32_32x32x16_bf16 v[32:47], a[184:187], a[120:123], v[32:47]
ds_read_b64_tr_b16 a[200:201], v148 offset:45120
ds_read_b64_tr_b16 a[202:203], v148 offset:46400
buffer_load_dwordx4 a[84:87], v240, s[44:47], s90 offen offset:1024 sc1
s_waitcnt lgkmcnt(6)
v_mfma_f32_32x32x16_bf16 v[48:63], a[188:191], a[120:123], v[48:63]
ds_read_b64_tr_b16 a[204:205], v148 offset:45184
ds_read_b64_tr_b16 a[206:207], v148 offset:46464
s_waitcnt lgkmcnt(6)
v_mfma_f32_32x32x16_bf16 v[64:79], a[192:195], a[120:123], v[64:79]
ds_read_b64_tr_b16 a[160:161], v148 offset:45248
ds_read_b64_tr_b16 a[162:163], v148 offset:46528
buffer_load_dwordx4 a[88:91], v240, s[44:47], s90 offen offset:2048 sc1
s_waitcnt lgkmcnt(6)
v_mfma_f32_32x32x16_bf16 v[80:95], a[196:199], a[120:123], v[80:95]
ds_read_b64_tr_b16 a[164:165], v158 offset:32768
ds_read_b64_tr_b16 a[166:167], v158 offset:33536
s_waitcnt lgkmcnt(6)
v_mfma_f32_32x32x16_bf16 v[96:111], a[200:203], a[120:123], v[96:111]
ds_read_b64_tr_b16 a[168:169], v158 offset:32832
ds_read_b64_tr_b16 a[170:171], v158 offset:33600
buffer_load_dwordx4 a[92:95], v240, s[44:47], s90 offen offset:3072 sc1
s_waitcnt lgkmcnt(6)
v_mfma_f32_32x32x16_bf16 v[112:127], a[204:207], a[120:123], v[112:127]
ds_read_b64_tr_b16 a[172:173], v158 offset:32896
ds_read_b64_tr_b16 a[174:175], v158 offset:33664
s_waitcnt lgkmcnt(6)
v_mfma_f32_32x32x16_bf16 v[128:143], a[160:163], a[120:123], v[128:143]
ds_read_b64_tr_b16 a[176:177], v150 offset:45056
ds_read_b64_tr_b16 a[178:179], v150 offset:46336
buffer_load_dwordx4 a[96:99], v241, s[44:47], s90 offen sc1
s_add_u32 s90, s90, 5120
s_waitcnt lgkmcnt(6)
v_mfma_f32_32x32x16_bf16 v[32:47], a[164:167], a[124:127], v[32:47]
ds_read_b64_tr_b16 a[180:181], v150 offset:45120
ds_read_b64_tr_b16 a[182:183], v150 offset:46400
s_waitcnt lgkmcnt(6)
v_mfma_f32_32x32x16_bf16 v[48:63], a[168:171], a[124:127], v[48:63]
ds_read_b64_tr_b16 a[184:185], v150 offset:45184
ds_read_b64_tr_b16 a[186:187], v150 offset:46464
buffer_load_dwordx4 a[100:103], v240, s[44:47], s90 offen offset:0 sc1
s_waitcnt lgkmcnt(6)
v_mfma_f32_32x32x16_bf16 v[64:79], a[172:175], a[124:127], v[64:79]
ds_read_b64_tr_b16 a[188:189], v150 offset:45248
ds_read_b64_tr_b16 a[190:191], v150 offset:46528
s_waitcnt lgkmcnt(6)
v_mfma_f32_32x32x16_bf16 v[80:95], a[176:179], a[124:127], v[80:95]
buffer_load_dwordx4 a[104:107], v240, s[44:47], s90 offen offset:1024 sc1
s_waitcnt lgkmcnt(4)
v_mfma_f32_32x32x16_bf16 v[96:111], a[180:183], a[124:127], v[96:111]
s_waitcnt lgkmcnt(0)
s_waitcnt vmcnt(29)
s_barrier
ds_read_b64_tr_b16 a[192:193], v153 offset:16384
ds_read_b64_tr_b16 a[194:195], v153 offset:17152
ds_read_b64_tr_b16 a[196:197], v153 offset:16448
ds_read_b64_tr_b16 a[198:199], v153 offset:17216
v_mfma_f32_32x32x16_bf16 v[112:127], a[184:187], a[124:127], v[112:127]
ds_read_b64_tr_b16 a[200:201], v153 offset:16512
ds_read_b64_tr_b16 a[202:203], v153 offset:17280
buffer_load_dwordx4 a[108:111], v240, s[44:47], s90 offen offset:2048 sc1
v_mfma_f32_32x32x16_bf16 v[128:143], a[188:191], a[124:127], v[128:143]
ds_read_b64_tr_b16 a[204:205], v145 offset:28672
ds_read_b64_tr_b16 a[206:207], v145 offset:29952
s_waitcnt lgkmcnt(6)
v_mfma_f32_32x32x16_bf16 v[32:47], a[192:195], a[128:131], v[32:47]
ds_read_b64_tr_b16 a[160:161], v145 offset:28736
ds_read_b64_tr_b16 a[162:163], v145 offset:30016
v_mfma_f32_16x16x32_bf16 v[208:211], a[192:195], v[246:249], v[208:211]
buffer_load_dwordx4 a[112:115], v240, s[44:47], s90 offen offset:3072 sc1
s_waitcnt lgkmcnt(6)
v_mfma_f32_32x32x16_bf16 v[48:63], a[196:199], a[128:131], v[48:63]
ds_read_b64_tr_b16 a[164:165], v145 offset:28800
ds_read_b64_tr_b16 a[166:167], v145 offset:30080
v_mfma_f32_16x16x32_bf16 v[212:215], a[196:199], v[246:249], v[212:215]
s_waitcnt lgkmcnt(6)
v_mfma_f32_32x32x16_bf16 v[64:79], a[200:203], a[128:131], v[64:79]
ds_read_b64_tr_b16 a[168:169], v145 offset:28864
ds_read_b64_tr_b16 a[170:171], v145 offset:30144
v_mfma_f32_16x16x32_bf16 v[216:219], a[200:203], v[246:249], v[216:219]
s_waitcnt lgkmcnt(6)
v_mfma_f32_32x32x16_bf16 v[80:95], a[204:207], a[128:131], v[80:95]
ds_read_b64_tr_b16 a[172:173], v155 offset:16384
ds_read_b64_tr_b16 a[174:175], v155 offset:17152
v_mfma_f32_16x16x32_bf16 v[220:223], a[204:207], v[246:249], v[220:223]
s_waitcnt lgkmcnt(6)
v_mfma_f32_32x32x16_bf16 v[96:111], a[160:163], a[128:131], v[96:111]
ds_read_b64_tr_b16 a[176:177], v155 offset:16448
ds_read_b64_tr_b16 a[178:179], v155 offset:17216
v_mfma_f32_16x16x32_bf16 v[224:227], a[160:163], v[246:249], v[224:227]
s_waitcnt lgkmcnt(6)
v_mfma_f32_32x32x16_bf16 v[112:127], a[164:167], a[128:131], v[112:127]
ds_read_b64_tr_b16 a[180:181], v155 offset:16512
ds_read_b64_tr_b16 a[182:183], v155 offset:17280
v_mfma_f32_16x16x32_bf16 v[228:231], a[164:167], v[246:249], v[228:231]
s_waitcnt lgkmcnt(6)
v_mfma_f32_32x32x16_bf16 v[128:143], a[168:171], a[128:131], v[128:143]
ds_read_b64_tr_b16 a[184:185], v147 offset:28672
ds_read_b64_tr_b16 a[186:187], v147 offset:29952
v_mfma_f32_16x16x32_bf16 v[232:235], a[168:171], v[246:249], v[232:235]
s_waitcnt lgkmcnt(6)
v_mfma_f32_32x32x16_bf16 v[32:47], a[172:175], a[132:135], v[32:47]
ds_read_b64_tr_b16 a[188:189], v147 offset:28736
ds_read_b64_tr_b16 a[190:191], v147 offset:30016
ds_read_b128 a[144:147], v16 offset:0
ds_read_b128 a[148:151], v17 offset:0
ds_read_b128 a[152:155], v18 offset:0
ds_read_b128 a[156:159], v19 offset:0
ds_read_b128 v[176:179], v16 offset:0
ds_read_b128 v[180:183], v17 offset:0
ds_read_b128 v[184:187], v18 offset:0
ds_read_b128 v[188:191], v19 offset:0
buffer_load_dwordx4 a[116:119], v241, s[44:47], s90 offen sc1
s_add_u32 s90, s90, 5120
s_waitcnt lgkmcnt(14)
v_mfma_f32_32x32x16_bf16 v[48:63], a[176:179], a[132:135], v[48:63]
ds_read_b64_tr_b16 a[192:193], v147 offset:28800
ds_read_b64_tr_b16 a[194:195], v147 offset:30080
s_waitcnt lgkmcnt(14)
v_mfma_f32_32x32x16_bf16 v[64:79], a[180:183], a[132:135], v[64:79]
ds_read_b64_tr_b16 a[196:197], v147 offset:28864
ds_read_b64_tr_b16 a[198:199], v147 offset:30144
s_waitcnt lgkmcnt(14)
v_mfma_f32_32x32x16_bf16 v[80:95], a[184:187], a[132:135], v[80:95]
ds_read_b64_tr_b16 a[200:201], v157 offset:16384
ds_read_b64_tr_b16 a[202:203], v157 offset:17152
s_waitcnt lgkmcnt(14)
v_mfma_f32_32x32x16_bf16 v[96:111], a[188:191], a[132:135], v[96:111]
ds_read_b64_tr_b16 a[204:205], v157 offset:16448
ds_read_b64_tr_b16 a[206:207], v157 offset:17216
s_waitcnt lgkmcnt(8)
v_dot2c_f32_bf16 v20, s65, v176
v_dot2c_f32_bf16 v24, v176, v176
v_dot2c_f32_bf16 v21, s65, v177
v_dot2c_f32_bf16 v25, v177, v177
v_dot2c_f32_bf16 v14, s65, v178
v_dot2c_f32_bf16 v192, v178, v178
v_dot2c_f32_bf16 v15, s65, v179
v_dot2c_f32_bf16 v193, v179, v179
v_dot2c_f32_bf16 v20, s65, v180
v_dot2c_f32_bf16 v24, v180, v180
v_dot2c_f32_bf16 v21, s65, v181
v_dot2c_f32_bf16 v25, v181, v181
v_dot2c_f32_bf16 v14, s65, v182
v_dot2c_f32_bf16 v192, v182, v182
v_dot2c_f32_bf16 v15, s65, v183
v_dot2c_f32_bf16 v193, v183, v183
v_dot2c_f32_bf16 v20, s65, v184
v_dot2c_f32_bf16 v24, v184, v184
v_dot2c_f32_bf16 v21, s65, v185
v_dot2c_f32_bf16 v25, v185, v185
v_dot2c_f32_bf16 v14, s65, v186
v_dot2c_f32_bf16 v192, v186, v186
v_dot2c_f32_bf16 v15, s65, v187
v_dot2c_f32_bf16 v193, v187, v187
v_dot2c_f32_bf16 v20, s65, v188
v_dot2c_f32_bf16 v24, v188, v188
v_dot2c_f32_bf16 v21, s65, v189
v_dot2c_f32_bf16 v25, v189, v189
v_dot2c_f32_bf16 v14, s65, v190
v_dot2c_f32_bf16 v192, v190, v190
v_dot2c_f32_bf16 v15, s65, v191
v_dot2c_f32_bf16 v193, v191, v191
v_add_f32 v20, v20, v14
s_nop 0
v_add_f32 v21, v21, v15
v_add_f32 v24, v24, v192
v_add_f32 v25, v25, v193
s_waitcnt lgkmcnt(6)
v_mfma_f32_32x32x16_bf16 v[112:127], a[192:195], a[132:135], v[112:127]
ds_read_b64_tr_b16 a[160:161], v157 offset:16512
ds_read_b64_tr_b16 a[162:163], v157 offset:17280
s_waitcnt lgkmcnt(6)
v_mfma_f32_32x32x16_bf16 v[128:143], a[196:199], a[132:135], v[128:143]
ds_read_b64_tr_b16 a[164:165], v149 offset:28672
ds_read_b64_tr_b16 a[166:167], v149 offset:29952
s_waitcnt lgkmcnt(6)
v_mfma_f32_32x32x16_bf16 v[32:47], a[200:203], a[136:139], v[32:47]
ds_read_b64_tr_b16 a[168:169], v149 offset:28736
ds_read_b64_tr_b16 a[170:171], v149 offset:30016
buffer_load_dwordx4 a[120:123], v240, s[44:47], s90 offen offset:0 sc1
s_waitcnt lgkmcnt(6)
v_mfma_f32_32x32x16_bf16 v[48:63], a[204:207], a[136:139], v[48:63]
ds_read_b64_tr_b16 a[172:173], v149 offset:28800
ds_read_b64_tr_b16 a[174:175], v149 offset:30080
s_waitcnt lgkmcnt(6)
v_mfma_f32_32x32x16_bf16 v[64:79], a[160:163], a[136:139], v[64:79]
ds_read_b64_tr_b16 a[176:177], v149 offset:28864
ds_read_b64_tr_b16 a[178:179], v149 offset:30144
s_waitcnt lgkmcnt(6)
v_mfma_f32_32x32x16_bf16 v[80:95], a[164:167], a[136:139], v[80:95]
ds_read_b64_tr_b16 a[180:181], v159 offset:16384
ds_read_b64_tr_b16 a[182:183], v159 offset:17152
s_waitcnt lgkmcnt(6)
v_mfma_f32_32x32x16_bf16 v[96:111], a[168:171], a[136:139], v[96:111]
ds_read_b64_tr_b16 a[184:185], v159 offset:16448
ds_read_b64_tr_b16 a[186:187], v159 offset:17216
s_waitcnt lgkmcnt(6)
v_mfma_f32_32x32x16_bf16 v[112:127], a[172:175], a[136:139], v[112:127]
ds_read_b64_tr_b16 a[188:189], v159 offset:16512
ds_read_b64_tr_b16 a[190:191], v159 offset:17280
s_waitcnt lgkmcnt(6)
v_mfma_f32_32x32x16_bf16 v[128:143], a[176:179], a[136:139], v[128:143]
ds_read_b64_tr_b16 a[192:193], v151 offset:28672
ds_read_b64_tr_b16 a[194:195], v151 offset:29952
s_waitcnt lgkmcnt(6)
v_mfma_f32_32x32x16_bf16 v[32:47], a[180:183], a[140:143], v[32:47]
ds_read_b64_tr_b16 a[196:197], v151 offset:28736
ds_read_b64_tr_b16 a[198:199], v151 offset:30016
buffer_load_dwordx4 a[124:127], v240, s[44:47], s90 offen offset:1024 sc1
s_waitcnt lgkmcnt(6)
v_mfma_f32_32x32x16_bf16 v[48:63], a[184:187], a[140:143], v[48:63]
ds_read_b64_tr_b16 a[200:201], v151 offset:28800
ds_read_b64_tr_b16 a[202:203], v151 offset:30080
s_waitcnt lgkmcnt(6)
v_mfma_f32_32x32x16_bf16 v[64:79], a[188:191], a[140:143], v[64:79]
ds_read_b64_tr_b16 a[204:205], v151 offset:28864
ds_read_b64_tr_b16 a[206:207], v151 offset:30144
s_waitcnt lgkmcnt(6)
v_mfma_f32_32x32x16_bf16 v[80:95], a[192:195], a[140:143], v[80:95]
s_waitcnt lgkmcnt(4)
v_mfma_f32_32x32x16_bf16 v[96:111], a[196:199], a[140:143], v[96:111]
s_waitcnt lgkmcnt(0)
s_waitcnt vmcnt(12)
s_barrier
ds_read_b64_tr_b16 a[160:161], v152 offset:0
ds_read_b64_tr_b16 a[162:163], v152 offset:768
ds_read_b64_tr_b16 a[164:165], v152 offset:64
ds_read_b64_tr_b16 a[166:167], v152 offset:832
v_mfma_f32_32x32x16_bf16 v[112:127], a[200:203], a[140:143], v[112:127]
ds_read_b64_tr_b16 a[168:169], v152 offset:128
ds_read_b64_tr_b16 a[170:171], v152 offset:896
v_mfma_f32_32x32x16_bf16 v[128:143], a[204:207], a[140:143], v[128:143]
ds_read_b64_tr_b16 a[172:173], v144 offset:12288
ds_read_b64_tr_b16 a[174:175], v144 offset:13568
s_waitcnt lgkmcnt(6)
v_mfma_f32_32x32x16_bf16 v[32:47], a[160:163], a[144:147], v[32:47]
ds_read_b64_tr_b16 a[176:177], v144 offset:12352
ds_read_b64_tr_b16 a[178:179], v144 offset:13632
v_mfma_f32_16x16x32_bf16 v[208:211], a[160:163], v[246:249], v[208:211]
buffer_load_dwordx4 a[128:131], v240, s[44:47], s90 offen offset:2048 sc1
s_waitcnt lgkmcnt(6)
v_mfma_f32_32x32x16_bf16 v[48:63], a[164:167], a[144:147], v[48:63]
ds_read_b64_tr_b16 a[180:181], v144 offset:12416
ds_read_b64_tr_b16 a[182:183], v144 offset:13696
v_mfma_f32_16x16x32_bf16 v[212:215], a[164:167], v[246:249], v[212:215]
s_waitcnt lgkmcnt(6)
v_mfma_f32_32x32x16_bf16 v[64:79], a[168:171], a[144:147], v[64:79]
ds_read_b64_tr_b16 a[184:185], v144 offset:12480
ds_read_b64_tr_b16 a[186:187], v144 offset:13760
v_mfma_f32_16x16x32_bf16 v[216:219], a[168:171], v[246:249], v[216:219]
s_waitcnt lgkmcnt(6)
v_mfma_f32_32x32x16_bf16 v[80:95], a[172:175], a[144:147], v[80:95]
ds_read_b64_tr_b16 a[188:189], v154 offset:0
ds_read_b64_tr_b16 a[190:191], v154 offset:768
v_mfma_f32_16x16x32_bf16 v[220:223], a[172:175], v[246:249], v[220:223]
s_waitcnt lgkmcnt(6)
v_mfma_f32_32x32x16_bf16 v[96:111], a[176:179], a[144:147], v[96:111]
ds_read_b64_tr_b16 a[192:193], v154 offset:64
ds_read_b64_tr_b16 a[194:195], v154 offset:832
v_mfma_f32_16x16x32_bf16 v[224:227], a[176:179], v[246:249], v[224:227]
s_waitcnt lgkmcnt(6)
v_mfma_f32_32x32x16_bf16 v[112:127], a[180:183], a[144:147], v[112:127]
ds_read_b64_tr_b16 a[196:197], v154 offset:128
ds_read_b64_tr_b16 a[198:199], v154 offset:896
v_mfma_f32_16x16x32_bf16 v[228:231], a[180:183], v[246:249], v[228:231]
s_waitcnt lgkmcnt(6)
v_mfma_f32_32x32x16_bf16 v[128:143], a[184:187], a[144:147], v[128:143]
ds_read_b64_tr_b16 a[200:201], v146 offset:12288
ds_read_b64_tr_b16 a[202:203], v146 offset:13568
v_mfma_f32_16x16x32_bf16 v[232:235], a[184:187], v[246:249], v[232:235]
s_waitcnt lgkmcnt(6)
v_mfma_f32_32x32x16_bf16 v[32:47], a[188:191], a[148:151], v[32:47]
ds_read_b64_tr_b16 a[204:205], v146 offset:12352
ds_read_b64_tr_b16 a[206:207], v146 offset:13632
buffer_load_dwordx4 a[132:135], v240, s[44:47], s90 offen offset:3072 sc1
s_waitcnt lgkmcnt(6)
v_mfma_f32_32x32x16_bf16 v[48:63], a[192:195], a[148:151], v[48:63]
ds_read_b64_tr_b16 a[160:161], v146 offset:12416
ds_read_b64_tr_b16 a[162:163], v146 offset:13696
s_waitcnt lgkmcnt(6)
v_mfma_f32_32x32x16_bf16 v[64:79], a[196:199], a[148:151], v[64:79]
ds_read_b64_tr_b16 a[164:165], v146 offset:12480
ds_read_b64_tr_b16 a[166:167], v146 offset:13760
s_waitcnt lgkmcnt(6)
v_mfma_f32_32x32x16_bf16 v[80:95], a[200:203], a[148:151], v[80:95]
ds_read_b64_tr_b16 a[168:169], v156 offset:0
ds_read_b64_tr_b16 a[170:171], v156 offset:768
s_waitcnt lgkmcnt(6)
v_mfma_f32_32x32x16_bf16 v[96:111], a[204:207], a[148:151], v[96:111]
ds_read_b64_tr_b16 a[172:173], v156 offset:64
ds_read_b64_tr_b16 a[174:175], v156 offset:832
s_waitcnt lgkmcnt(6)
v_mfma_f32_32x32x16_bf16 v[112:127], a[160:163], a[148:151], v[112:127]
ds_read_b64_tr_b16 a[176:177], v156 offset:128
ds_read_b64_tr_b16 a[178:179], v156 offset:896
s_waitcnt lgkmcnt(6)
v_mfma_f32_32x32x16_bf16 v[128:143], a[164:167], a[148:151], v[128:143]
ds_read_b64_tr_b16 a[180:181], v148 offset:12288
ds_read_b64_tr_b16 a[182:183], v148 offset:13568
s_waitcnt lgkmcnt(6)
v_mfma_f32_32x32x16_bf16 v[32:47], a[168:171], a[152:155], v[32:47]
ds_read_b64_tr_b16 a[184:185], v148 offset:12352
ds_read_b64_tr_b16 a[186:187], v148 offset:13632
buffer_load_dwordx4 a[136:139], v241, s[44:47], s90 offen sc1
s_add_u32 s90, s90, 5120
s_waitcnt lgkmcnt(6)
v_mfma_f32_32x32x16_bf16 v[48:63], a[172:175], a[152:155], v[48:63]
ds_read_b64_tr_b16 a[188:189], v148 offset:12416
ds_read_b64_tr_b16 a[190:191], v148 offset:13696
s_waitcnt lgkmcnt(6)
v_mfma_f32_32x32x16_bf16 v[64:79], a[176:179], a[152:155], v[64:79]
ds_read_b64_tr_b16 a[192:193], v148 offset:12480
ds_read_b64_tr_b16 a[194:195], v148 offset:13760
s_waitcnt lgkmcnt(6)
v_mfma_f32_32x32x16_bf16 v[80:95], a[180:183], a[152:155], v[80:95]
ds_read_b64_tr_b16 a[196:197], v158 offset:0
ds_read_b64_tr_b16 a[198:199], v158 offset:768
s_waitcnt lgkmcnt(6)
v_mfma_f32_32x32x16_bf16 v[96:111], a[184:187], a[152:155], v[96:111]
ds_read_b64_tr_b16 a[200:201], v158 offset:64
ds_read_b64_tr_b16 a[202:203], v158 offset:832
s_waitcnt lgkmcnt(6)
v_mfma_f32_32x32x16_bf16 v[112:127], a[188:191], a[152:155], v[112:127]
ds_read_b64_tr_b16 a[204:205], v158 offset:128
ds_read_b64_tr_b16 a[206:207], v158 offset:896
s_waitcnt lgkmcnt(6)
v_mfma_f32_32x32x16_bf16 v[128:143], a[192:195], a[152:155], v[128:143]
ds_read_b64_tr_b16 a[160:161], v150 offset:12288
ds_read_b64_tr_b16 a[162:163], v150 offset:13568
s_waitcnt lgkmcnt(6)
v_mfma_f32_32x32x16_bf16 v[32:47], a[196:199], a[156:159], v[32:47]
ds_read_b64_tr_b16 a[164:165], v150 offset:12352
ds_read_b64_tr_b16 a[166:167], v150 offset:13632
buffer_load_dwordx4 a[140:143], v240, s[44:47], s90 offen offset:0 sc1
s_waitcnt lgkmcnt(6)
v_mfma_f32_32x32x16_bf16 v[48:63], a[200:203], a[156:159], v[48:63]
ds_read_b64_tr_b16 a[168:169], v150 offset:12416
ds_read_b64_tr_b16 a[170:171], v150 offset:13696
s_waitcnt lgkmcnt(6)
v_mfma_f32_32x32x16_bf16 v[64:79], a[204:207], a[156:159], v[64:79]
ds_read_b64_tr_b16 a[172:173], v150 offset:12480
ds_read_b64_tr_b16 a[174:175], v150 offset:13760
s_waitcnt lgkmcnt(6)
v_mfma_f32_32x32x16_bf16 v[80:95], a[160:163], a[156:159], v[80:95]
s_waitcnt lgkmcnt(4)
v_mfma_f32_32x32x16_bf16 v[96:111], a[164:167], a[156:159], v[96:111]
s_waitcnt lgkmcnt(2)
v_mfma_f32_32x32x16_bf16 v[112:127], a[168:171], a[156:159], v[112:127]
s_waitcnt lgkmcnt(0)
v_mfma_f32_32x32x16_bf16 v[128:143], a[172:175], a[156:159], v[128:143]
buffer_load_dwordx4 a[144:147], v240, s[44:47], s90 offen offset:1024 sc1
buffer_load_dwordx4 a[148:151], v240, s[44:47], s90 offen offset:2048 sc1
buffer_load_dwordx4 a[152:155], v240, s[44:47], s90 offen offset:3072 sc1
buffer_load_dwordx4 a[156:159], v241, s[44:47], s90 offen sc1
s_add_u32 s90, s90, 5120
v_add_f32 v20, v20, v21
v_add_f32 v24, v24, v25
v_mov_b32 v21, v20
v_mov_b32 v25, v24
s_nop 0
v_permlane32_swap_b32 v20, v21
v_permlane32_swap_b32 v24, v25
v_add_f32 v20, v20, v21
v_add_f32_e64 v24, v24, v25
s_mov_b32 s60, 0x3acccccd
s_mov_b32 s61, 0x3727c5ac
v_mul_f32 v20, s60, v20
v_mul_f32 v24, s60, v24
v_fma_f32 v24, -v20, v20, v24
v_max_f32_e64 v24, 0, v24
v_cvt_pk_bf16_f32 v28, v20, v24
v_lshlrev_b32 v20, 16, v28
v_and_b32 v24, s64, v28
v_add_f32_e64 v24, s61, v24
v_cvt_pk_bf16_f32 v28, v24, v24
v_and_b32 v24, s64, v28
v_sqrt_f32 v24, v24
s_nop 0
v_cvt_pk_bf16_f32 v28, v24, v24
v_and_b32 v24, s64, v28
v_rcp_f32 v28, v24
s_nop 0
v_mul_f32 v24, v20, v28
v_sub_f32 v21, 0, v24
v_mov_b32 v20, v28
v_and_b32 v160, 15, v1
v_lshlrev_b32 v160, 6, v160
v_lshrrev_b32 v161, 4, v1
v_lshl_add_u32 v160, v161, 4, v160
s_lshl_b32 s60, s56, 10
s_add_u32 s60, s60, 159744
v_add_u32 v160, s60, v160
s_mov_b32 exec_lo, 0x00030003
s_mov_b32 exec_hi, 0x00030003
ds_write_b128 v160, v[208:211] offset:0
ds_write_b128 v160, v[212:215] offset:128
ds_write_b128 v160, v[216:219] offset:256
ds_write_b128 v160, v[220:223] offset:384
ds_write_b128 v160, v[224:227] offset:512
ds_write_b128 v160, v[228:231] offset:640
ds_write_b128 v160, v[232:235] offset:768
s_mov_b64 exec, -1
v_lshlrev_b32 v160, 4, v1
v_add_u32 v160, 159744, v160
s_waitcnt lgkmcnt(0)
s_barrier
s_cmp_lg_u32 s56, 0
s_cbranch_scc1 L_csr_B_7
ds_read_b128 v[162:165], v160 offset:0
ds_read_b128 v[166:169], v160 offset:1024
ds_read_b128 v[170:173], v160 offset:2048
ds_read_b128 v[174:177], v160 offset:3072
s_waitcnt lgkmcnt(0)
v_pk_add_f32 v[162:163], v[162:163], v[166:167]
v_pk_add_f32 v[164:165], v[164:165], v[168:169]
v_pk_add_f32 v[170:171], v[170:171], v[174:175]
v_pk_add_f32 v[172:173], v[172:173], v[176:177]
v_pk_add_f32 v[162:163], v[162:163], v[170:171]
v_pk_add_f32 v[164:165], v[164:165], v[172:173]
ds_write_b128 v160, v[162:165]
s_waitcnt lgkmcnt(0)
L_csr_B_7:
s_barrier
v_lshrrev_b32 v28, 5, v1
v_lshlrev_b32_e64 v28, 4, v28
v_add_u32 v28, 159744, v28
ds_read_b128 v[160:163], v28 offset:0
ds_read_b128 v[164:167], v28 offset:32
ds_read_b128 v[168:171], v28 offset:64
ds_read_b128 v[172:175], v28 offset:96
ds_read_b128 v[176:179], v28 offset:128
ds_read_b128 v[180:183], v28 offset:160
ds_read_b128 v[184:187], v28 offset:192
ds_read_b128 v[188:191], v28 offset:224
s_waitcnt lgkmcnt(4)
v_pk_mul_f32 v[160:161], v[160:161], v[20:21] op_sel:[0,1] op_sel_hi:[1,1]
v_pk_mul_f32 v[162:163], v[162:163], v[20:21] op_sel:[0,1] op_sel_hi:[1,1]
v_pk_mul_f32 v[164:165], v[164:165], v[20:21] op_sel:[0,1] op_sel_hi:[1,1]
v_pk_mul_f32 v[166:167], v[166:167], v[20:21] op_sel:[0,1] op_sel_hi:[1,1]
v_pk_mul_f32 v[168:169], v[168:169], v[20:21] op_sel:[0,1] op_sel_hi:[1,1]
v_pk_mul_f32 v[170:171], v[170:171], v[20:21] op_sel:[0,1] op_sel_hi:[1,1]
v_pk_mul_f32 v[172:173], v[172:173], v[20:21] op_sel:[0,1] op_sel_hi:[1,1]
v_pk_mul_f32 v[174:175], v[174:175], v[20:21] op_sel:[0,1] op_sel_hi:[1,1]
v_pk_fma_f32 v[32:33], v[32:33], v[20:21], v[160:161] op_sel_hi:[1,0,1]
v_pk_fma_f32 v[34:35], v[34:35], v[20:21], v[162:163] op_sel_hi:[1,0,1]
v_pk_fma_f32 v[36:37], v[36:37], v[20:21], v[164:165] op_sel_hi:[1,0,1]
v_pk_fma_f32 v[38:39], v[38:39], v[20:21], v[166:167] op_sel_hi:[1,0,1]
v_pk_fma_f32 v[40:41], v[40:41], v[20:21], v[168:169] op_sel_hi:[1,0,1]
v_pk_fma_f32 v[42:43], v[42:43], v[20:21], v[170:171] op_sel_hi:[1,0,1]
v_pk_fma_f32 v[44:45], v[44:45], v[20:21], v[172:173] op_sel_hi:[1,0,1]
v_pk_fma_f32 v[46:47], v[46:47], v[20:21], v[174:175] op_sel_hi:[1,0,1]
ds_read_b128 v[160:163], v28 offset:256
ds_read_b128 v[164:167], v28 offset:288
ds_read_b128 v[168:171], v28 offset:320
ds_read_b128 v[172:175], v28 offset:352
s_waitcnt lgkmcnt(4)
v_pk_mul_f32 v[176:177], v[176:177], v[20:21] op_sel:[0,1] op_sel_hi:[1,1]
v_pk_mul_f32 v[178:179], v[178:179], v[20:21] op_sel:[0,1] op_sel_hi:[1,1]
v_pk_mul_f32 v[180:181], v[180:181], v[20:21] op_sel:[0,1] op_sel_hi:[1,1]
v_pk_mul_f32 v[182:183], v[182:183], v[20:21] op_sel:[0,1] op_sel_hi:[1,1]
v_pk_mul_f32 v[184:185], v[184:185], v[20:21] op_sel:[0,1] op_sel_hi:[1,1]
v_pk_mul_f32 v[186:187], v[186:187], v[20:21] op_sel:[0,1] op_sel_hi:[1,1]
v_pk_mul_f32 v[188:189], v[188:189], v[20:21] op_sel:[0,1] op_sel_hi:[1,1]
v_pk_mul_f32 v[190:191], v[190:191], v[20:21] op_sel:[0,1] op_sel_hi:[1,1]
v_pk_fma_f32 v[48:49], v[48:49], v[20:21], v[176:177] op_sel_hi:[1,0,1]
v_pk_fma_f32 v[50:51], v[50:51], v[20:21], v[178:179] op_sel_hi:[1,0,1]
v_pk_fma_f32 v[52:53], v[52:53], v[20:21], v[180:181] op_sel_hi:[1,0,1]
v_pk_fma_f32 v[54:55], v[54:55], v[20:21], v[182:183] op_sel_hi:[1,0,1]
v_pk_fma_f32 v[56:57], v[56:57], v[20:21], v[184:185] op_sel_hi:[1,0,1]
v_pk_fma_f32 v[58:59], v[58:59], v[20:21], v[186:187] op_sel_hi:[1,0,1]
v_pk_fma_f32 v[60:61], v[60:61], v[20:21], v[188:189] op_sel_hi:[1,0,1]
v_pk_fma_f32 v[62:63], v[62:63], v[20:21], v[190:191] op_sel_hi:[1,0,1]
ds_read_b128 v[176:179], v28 offset:384
ds_read_b128 v[180:183], v28 offset:416
ds_read_b128 v[184:187], v28 offset:448
ds_read_b128 v[188:191], v28 offset:480
s_waitcnt lgkmcnt(4)
v_pk_mul_f32 v[160:161], v[160:161], v[20:21] op_sel:[0,1] op_sel_hi:[1,1]
v_pk_mul_f32 v[162:163], v[162:163], v[20:21] op_sel:[0,1] op_sel_hi:[1,1]
v_pk_mul_f32 v[164:165], v[164:165], v[20:21] op_sel:[0,1] op_sel_hi:[1,1]
v_pk_mul_f32 v[166:167], v[166:167], v[20:21] op_sel:[0,1] op_sel_hi:[1,1]
v_pk_mul_f32 v[168:169], v[168:169], v[20:21] op_sel:[0,1] op_sel_hi:[1,1]
v_pk_mul_f32 v[170:171], v[170:171], v[20:21] op_sel:[0,1] op_sel_hi:[1,1]
v_pk_mul_f32 v[172:173], v[172:173], v[20:21] op_sel:[0,1] op_sel_hi:[1,1]
v_pk_mul_f32 v[174:175], v[174:175], v[20:21] op_sel:[0,1] op_sel_hi:[1,1]
v_pk_fma_f32 v[64:65], v[64:65], v[20:21], v[160:161] op_sel_hi:[1,0,1]
v_pk_fma_f32 v[66:67], v[66:67], v[20:21], v[162:163] op_sel_hi:[1,0,1]
v_pk_fma_f32 v[68:69], v[68:69], v[20:21], v[164:165] op_sel_hi:[1,0,1]
v_pk_fma_f32 v[70:71], v[70:71], v[20:21], v[166:167] op_sel_hi:[1,0,1]
v_pk_fma_f32 v[72:73], v[72:73], v[20:21], v[168:169] op_sel_hi:[1,0,1]
v_pk_fma_f32 v[74:75], v[74:75], v[20:21], v[170:171] op_sel_hi:[1,0,1]
v_pk_fma_f32 v[76:77], v[76:77], v[20:21], v[172:173] op_sel_hi:[1,0,1]
v_pk_fma_f32 v[78:79], v[78:79], v[20:21], v[174:175] op_sel_hi:[1,0,1]
ds_read_b128 v[160:163], v28 offset:512
ds_read_b128 v[164:167], v28 offset:544
ds_read_b128 v[168:171], v28 offset:576
ds_read_b128 v[172:175], v28 offset:608
s_waitcnt lgkmcnt(4)
v_pk_mul_f32 v[176:177], v[176:177], v[20:21] op_sel:[0,1] op_sel_hi:[1,1]
v_pk_mul_f32 v[178:179], v[178:179], v[20:21] op_sel:[0,1] op_sel_hi:[1,1]
v_pk_mul_f32 v[180:181], v[180:181], v[20:21] op_sel:[0,1] op_sel_hi:[1,1]
v_pk_mul_f32 v[182:183], v[182:183], v[20:21] op_sel:[0,1] op_sel_hi:[1,1]
v_pk_mul_f32 v[184:185], v[184:185], v[20:21] op_sel:[0,1] op_sel_hi:[1,1]
v_pk_mul_f32 v[186:187], v[186:187], v[20:21] op_sel:[0,1] op_sel_hi:[1,1]
v_pk_mul_f32 v[188:189], v[188:189], v[20:21] op_sel:[0,1] op_sel_hi:[1,1]
v_pk_mul_f32 v[190:191], v[190:191], v[20:21] op_sel:[0,1] op_sel_hi:[1,1]
v_pk_fma_f32 v[80:81], v[80:81], v[20:21], v[176:177] op_sel_hi:[1,0,1]
v_pk_fma_f32 v[82:83], v[82:83], v[20:21], v[178:179] op_sel_hi:[1,0,1]
v_pk_fma_f32 v[84:85], v[84:85], v[20:21], v[180:181] op_sel_hi:[1,0,1]
v_pk_fma_f32 v[86:87], v[86:87], v[20:21], v[182:183] op_sel_hi:[1,0,1]
v_pk_fma_f32 v[88:89], v[88:89], v[20:21], v[184:185] op_sel_hi:[1,0,1]
v_pk_fma_f32 v[90:91], v[90:91], v[20:21], v[186:187] op_sel_hi:[1,0,1]
v_pk_fma_f32 v[92:93], v[92:93], v[20:21], v[188:189] op_sel_hi:[1,0,1]
v_pk_fma_f32 v[94:95], v[94:95], v[20:21], v[190:191] op_sel_hi:[1,0,1]
ds_read_b128 v[176:179], v28 offset:640
ds_read_b128 v[180:183], v28 offset:672
ds_read_b128 v[184:187], v28 offset:704
ds_read_b128 v[188:191], v28 offset:736
s_waitcnt lgkmcnt(4)
v_pk_mul_f32 v[160:161], v[160:161], v[20:21] op_sel:[0,1] op_sel_hi:[1,1]
v_pk_mul_f32 v[162:163], v[162:163], v[20:21] op_sel:[0,1] op_sel_hi:[1,1]
v_pk_mul_f32 v[164:165], v[164:165], v[20:21] op_sel:[0,1] op_sel_hi:[1,1]
v_pk_mul_f32 v[166:167], v[166:167], v[20:21] op_sel:[0,1] op_sel_hi:[1,1]
v_pk_mul_f32 v[168:169], v[168:169], v[20:21] op_sel:[0,1] op_sel_hi:[1,1]
v_pk_mul_f32 v[170:171], v[170:171], v[20:21] op_sel:[0,1] op_sel_hi:[1,1]
v_pk_mul_f32 v[172:173], v[172:173], v[20:21] op_sel:[0,1] op_sel_hi:[1,1]
v_pk_mul_f32 v[174:175], v[174:175], v[20:21] op_sel:[0,1] op_sel_hi:[1,1]
v_pk_fma_f32 v[96:97], v[96:97], v[20:21], v[160:161] op_sel_hi:[1,0,1]
v_pk_fma_f32 v[98:99], v[98:99], v[20:21], v[162:163] op_sel_hi:[1,0,1]
v_pk_fma_f32 v[100:101], v[100:101], v[20:21], v[164:165] op_sel_hi:[1,0,1]
v_pk_fma_f32 v[102:103], v[102:103], v[20:21], v[166:167] op_sel_hi:[1,0,1]
v_pk_fma_f32 v[104:105], v[104:105], v[20:21], v[168:169] op_sel_hi:[1,0,1]
v_pk_fma_f32 v[106:107], v[106:107], v[20:21], v[170:171] op_sel_hi:[1,0,1]
v_pk_fma_f32 v[108:109], v[108:109], v[20:21], v[172:173] op_sel_hi:[1,0,1]
v_pk_fma_f32 v[110:111], v[110:111], v[20:21], v[174:175] op_sel_hi:[1,0,1]
ds_read_b128 v[160:163], v28 offset:768
ds_read_b128 v[164:167], v28 offset:800
ds_read_b128 v[168:171], v28 offset:832
ds_read_b128 v[172:175], v28 offset:864
s_waitcnt lgkmcnt(4)
v_pk_mul_f32 v[176:177], v[176:177], v[20:21] op_sel:[0,1] op_sel_hi:[1,1]
v_pk_mul_f32 v[178:179], v[178:179], v[20:21] op_sel:[0,1] op_sel_hi:[1,1]
v_pk_mul_f32 v[180:181], v[180:181], v[20:21] op_sel:[0,1] op_sel_hi:[1,1]
v_pk_mul_f32 v[182:183], v[182:183], v[20:21] op_sel:[0,1] op_sel_hi:[1,1]
v_pk_mul_f32 v[184:185], v[184:185], v[20:21] op_sel:[0,1] op_sel_hi:[1,1]
v_pk_mul_f32 v[186:187], v[186:187], v[20:21] op_sel:[0,1] op_sel_hi:[1,1]
v_pk_mul_f32 v[188:189], v[188:189], v[20:21] op_sel:[0,1] op_sel_hi:[1,1]
v_pk_mul_f32 v[190:191], v[190:191], v[20:21] op_sel:[0,1] op_sel_hi:[1,1]
v_pk_fma_f32 v[112:113], v[112:113], v[20:21], v[176:177] op_sel_hi:[1,0,1]
v_pk_fma_f32 v[114:115], v[114:115], v[20:21], v[178:179] op_sel_hi:[1,0,1]
v_pk_fma_f32 v[116:117], v[116:117], v[20:21], v[180:181] op_sel_hi:[1,0,1]
v_pk_fma_f32 v[118:119], v[118:119], v[20:21], v[182:183] op_sel_hi:[1,0,1]
v_pk_fma_f32 v[120:121], v[120:121], v[20:21], v[184:185] op_sel_hi:[1,0,1]
v_pk_fma_f32 v[122:123], v[122:123], v[20:21], v[186:187] op_sel_hi:[1,0,1]
v_pk_fma_f32 v[124:125], v[124:125], v[20:21], v[188:189] op_sel_hi:[1,0,1]
v_pk_fma_f32 v[126:127], v[126:127], v[20:21], v[190:191] op_sel_hi:[1,0,1]
s_waitcnt lgkmcnt(0)
v_pk_mul_f32 v[160:161], v[160:161], v[20:21] op_sel:[0,1] op_sel_hi:[1,1]
v_pk_mul_f32 v[162:163], v[162:163], v[20:21] op_sel:[0,1] op_sel_hi:[1,1]
v_pk_mul_f32 v[164:165], v[164:165], v[20:21] op_sel:[0,1] op_sel_hi:[1,1]
v_pk_mul_f32 v[166:167], v[166:167], v[20:21] op_sel:[0,1] op_sel_hi:[1,1]
v_pk_mul_f32 v[168:169], v[168:169], v[20:21] op_sel:[0,1] op_sel_hi:[1,1]
v_pk_mul_f32 v[170:171], v[170:171], v[20:21] op_sel:[0,1] op_sel_hi:[1,1]
v_pk_mul_f32 v[172:173], v[172:173], v[20:21] op_sel:[0,1] op_sel_hi:[1,1]
v_pk_mul_f32 v[174:175], v[174:175], v[20:21] op_sel:[0,1] op_sel_hi:[1,1]
v_pk_fma_f32 v[128:129], v[128:129], v[20:21], v[160:161] op_sel_hi:[1,0,1]
v_pk_fma_f32 v[130:131], v[130:131], v[20:21], v[162:163] op_sel_hi:[1,0,1]
v_pk_fma_f32 v[132:133], v[132:133], v[20:21], v[164:165] op_sel_hi:[1,0,1]
v_pk_fma_f32 v[134:135], v[134:135], v[20:21], v[166:167] op_sel_hi:[1,0,1]
v_pk_fma_f32 v[136:137], v[136:137], v[20:21], v[168:169] op_sel_hi:[1,0,1]
v_pk_fma_f32 v[138:139], v[138:139], v[20:21], v[170:171] op_sel_hi:[1,0,1]
v_pk_fma_f32 v[140:141], v[140:141], v[20:21], v[172:173] op_sel_hi:[1,0,1]
v_pk_fma_f32 v[142:143], v[142:143], v[20:21], v[174:175] op_sel_hi:[1,0,1]
v_and_b32 v28, 15, v1
v_bfe_u32 v29, v1, 4, 1
v_lshrrev_b32 v30, 5, v1
v_lshlrev_b32 v144, 4, v28
v_lshl_add_u32 v144, v29, 10, v144
v_lshl_add_u32 v144, v30, 9, v144
s_and_b32 s60, s56, 1
s_lshl_b32 s60, s60, 11
v_add_u32 v144, s60, v144
s_barrier
v_mov_b32 v148, 0
v_mov_b32 v149, 0
v_mov_b32 v150, 0
v_mov_b32 v151, 0
v_lshlrev_b32_e64 v152, 4, v0
ds_write_b128 v152, v[148:151] offset:0
ds_write_b128 v152, v[148:151] offset:4096
ds_write_b128 v152, v[148:151] offset:8192
ds_write_b128 v152, v[148:151] offset:12288
ds_write_b128 v152, v[148:151] offset:16384
v_lshlrev_b32_e64 v240, 4, v1
v_add_u32 v241, 4096, v240
v_add_u32 v252, 1024, v240
v_add_u32 v253, 2048, v240
v_add_u32 v254, 3072, v240
s_add_u32 s62, s82, 0
s_lshl_b32 s62, s62, 12
s_add_u32 s62, s62, s78
v_pk_mul_f32 v[148:149], v[80:81], s[68:69]
v_pk_mul_f32 v[150:151], v[82:83], s[68:69]
v_pk_mul_f32 v[152:153], v[84:85], s[68:69]
v_pk_mul_f32 v[154:155], v[86:87], s[68:69]
v_pk_mul_f32 v[156:157], v[88:89], s[68:69]
v_pk_mul_f32 v[158:159], v[90:91], s[68:69]
v_pk_mul_f32 v[160:161], v[92:93], s[68:69]
v_pk_mul_f32 v[162:163], v[94:95], s[68:69]
v_exp_f32 v148, v148
v_exp_f32 v149, v149
v_exp_f32 v150, v150
v_exp_f32 v151, v151
v_exp_f32 v152, v152
v_exp_f32 v153, v153
v_exp_f32 v154, v154
v_exp_f32 v155, v155
v_exp_f32 v156, v156
v_exp_f32 v157, v157
v_exp_f32 v158, v158
v_exp_f32 v159, v159
v_exp_f32 v160, v160
v_exp_f32 v161, v161
v_exp_f32 v162, v162
v_exp_f32_e64 v163, v163
v_pk_add_f32 v[148:149], v[148:149], s[80:81]
v_pk_add_f32 v[150:151], v[150:151], s[80:81]
v_pk_add_f32 v[152:153], v[152:153], s[80:81]
v_pk_add_f32 v[154:155], v[154:155], s[80:81]
v_pk_add_f32 v[156:157], v[156:157], s[80:81]
v_pk_add_f32 v[158:159], v[158:159], s[80:81]
v_pk_add_f32 v[160:161], v[160:161], s[80:81]
v_pk_add_f32 v[162:163], v[162:163], s[80:81]
v_rcp_f32 v148, v148
v_rcp_f32 v149, v149
v_rcp_f32 v150, v150
v_rcp_f32 v151, v151
v_rcp_f32 v152, v152
v_rcp_f32 v153, v153
v_rcp_f32 v154, v154
v_rcp_f32 v155, v155
v_rcp_f32 v156, v156
v_rcp_f32 v157, v157
v_rcp_f32 v158, v158
v_rcp_f32 v159, v159
v_rcp_f32 v160, v160
v_rcp_f32 v161, v161
v_rcp_f32 v162, v162
v_rcp_f32 v163, v163
v_pk_mul_f32 v[148:149], v[148:149], v[80:81]
v_pk_mul_f32 v[150:151], v[150:151], v[82:83]
v_pk_mul_f32 v[152:153], v[152:153], v[84:85]
v_pk_mul_f32 v[154:155], v[154:155], v[86:87]
v_pk_mul_f32 v[156:157], v[156:157], v[88:89]
v_pk_mul_f32 v[158:159], v[158:159], v[90:91]
v_pk_mul_f32 v[160:161], v[160:161], v[92:93]
v_pk_mul_f32 v[162:163], v[162:163], v[94:95]
v_cvt_pk_bf16_f32 v164, v148, v149
v_cvt_pk_bf16_f32 v165, v150, v151
v_cvt_pk_bf16_f32 v166, v152, v153
v_cvt_pk_bf16_f32 v167, v154, v155
v_cvt_pk_bf16_f32 v168, v156, v157
v_cvt_pk_bf16_f32 v169, v158, v159
v_cvt_pk_bf16_f32 v170, v160, v161
v_cvt_pk_bf16_f32 v171, v162, v163
buffer_store_dwordx4 v[164:167], v144, s[44:47], s62 offen sc1
buffer_store_dwordx4 v[168:171], v144, s[44:47], s62 offen offset:256 sc1
s_add_u32 s62, s82, 1
s_lshl_b32 s62, s62, 12
s_add_u32 s62, s62, s78
v_pk_mul_f32 v[148:149], v[96:97], s[68:69]
v_pk_mul_f32 v[150:151], v[98:99], s[68:69]
v_pk_mul_f32 v[152:153], v[100:101], s[68:69]
v_pk_mul_f32 v[154:155], v[102:103], s[68:69]
v_pk_mul_f32 v[156:157], v[104:105], s[68:69]
v_pk_mul_f32 v[158:159], v[106:107], s[68:69]
v_pk_mul_f32 v[160:161], v[108:109], s[68:69]
v_pk_mul_f32 v[162:163], v[110:111], s[68:69]
v_exp_f32 v148, v148
v_exp_f32 v149, v149
v_exp_f32 v150, v150
v_exp_f32 v151, v151
v_exp_f32 v152, v152
v_exp_f32 v153, v153
v_exp_f32 v154, v154
v_exp_f32 v155, v155
v_exp_f32 v156, v156
v_exp_f32 v157, v157
v_exp_f32 v158, v158
v_exp_f32 v159, v159
v_exp_f32 v160, v160
v_exp_f32 v161, v161
v_exp_f32 v162, v162
v_exp_f32_e64 v163, v163
v_pk_add_f32 v[148:149], v[148:149], s[80:81]
v_pk_add_f32 v[150:151], v[150:151], s[80:81]
v_pk_add_f32 v[152:153], v[152:153], s[80:81]
v_pk_add_f32 v[154:155], v[154:155], s[80:81]
v_pk_add_f32 v[156:157], v[156:157], s[80:81]
v_pk_add_f32 v[158:159], v[158:159], s[80:81]
v_pk_add_f32 v[160:161], v[160:161], s[80:81]
v_pk_add_f32 v[162:163], v[162:163], s[80:81]
v_rcp_f32 v148, v148
v_rcp_f32 v149, v149
v_rcp_f32 v150, v150
v_rcp_f32 v151, v151
v_rcp_f32 v152, v152
v_rcp_f32 v153, v153
v_rcp_f32 v154, v154
v_rcp_f32 v155, v155
v_rcp_f32 v156, v156
v_rcp_f32 v157, v157
v_rcp_f32 v158, v158
v_rcp_f32 v159, v159
v_rcp_f32 v160, v160
v_rcp_f32 v161, v161
v_rcp_f32 v162, v162
v_rcp_f32 v163, v163
v_pk_mul_f32 v[148:149], v[148:149], v[96:97]
v_pk_mul_f32 v[150:151], v[150:151], v[98:99]
v_pk_mul_f32 v[152:153], v[152:153], v[100:101]
v_pk_mul_f32 v[154:155], v[154:155], v[102:103]
v_pk_mul_f32 v[156:157], v[156:157], v[104:105]
v_pk_mul_f32 v[158:159], v[158:159], v[106:107]
v_pk_mul_f32 v[160:161], v[160:161], v[108:109]
v_pk_mul_f32 v[162:163], v[162:163], v[110:111]
v_cvt_pk_bf16_f32 v172, v148, v149
v_cvt_pk_bf16_f32 v173, v150, v151
v_cvt_pk_bf16_f32 v174, v152, v153
v_cvt_pk_bf16_f32 v175, v154, v155
v_cvt_pk_bf16_f32 v176, v156, v157
v_cvt_pk_bf16_f32 v177, v158, v159
v_cvt_pk_bf16_f32 v178, v160, v161
v_cvt_pk_bf16_f32 v179, v162, v163
buffer_store_dwordx4 v[172:175], v144, s[44:47], s62 offen sc1
buffer_store_dwordx4 v[176:179], v144, s[44:47], s62 offen offset:256 sc1
s_add_u32 s62, s82, 2
s_lshl_b32 s62, s62, 12
s_add_u32 s62, s62, s78
v_pk_mul_f32 v[148:149], v[112:113], s[68:69]
v_pk_mul_f32 v[150:151], v[114:115], s[68:69]
v_pk_mul_f32 v[152:153], v[116:117], s[68:69]
v_pk_mul_f32 v[154:155], v[118:119], s[68:69]
v_pk_mul_f32 v[156:157], v[120:121], s[68:69]
v_pk_mul_f32 v[158:159], v[122:123], s[68:69]
v_pk_mul_f32 v[160:161], v[124:125], s[68:69]
v_pk_mul_f32 v[162:163], v[126:127], s[68:69]
v_exp_f32 v148, v148
v_exp_f32 v149, v149
v_exp_f32 v150, v150
v_exp_f32 v151, v151
v_exp_f32 v152, v152
v_exp_f32 v153, v153
v_exp_f32 v154, v154
v_exp_f32 v155, v155
v_exp_f32 v156, v156
v_exp_f32 v157, v157
v_exp_f32 v158, v158
v_exp_f32 v159, v159
v_exp_f32 v160, v160
v_exp_f32 v161, v161
v_exp_f32 v162, v162
v_exp_f32_e64 v163, v163
v_pk_add_f32 v[148:149], v[148:149], s[80:81]
v_pk_add_f32 v[150:151], v[150:151], s[80:81]
v_pk_add_f32 v[152:153], v[152:153], s[80:81]
v_pk_add_f32 v[154:155], v[154:155], s[80:81]
v_pk_add_f32 v[156:157], v[156:157], s[80:81]
v_pk_add_f32 v[158:159], v[158:159], s[80:81]
v_pk_add_f32 v[160:161], v[160:161], s[80:81]
v_pk_add_f32 v[162:163], v[162:163], s[80:81]
v_rcp_f32 v148, v148
v_rcp_f32 v149, v149
v_rcp_f32 v150, v150
v_rcp_f32 v151, v151
v_rcp_f32 v152, v152
v_rcp_f32 v153, v153
v_rcp_f32 v154, v154
v_rcp_f32 v155, v155
v_rcp_f32 v156, v156
v_rcp_f32 v157, v157
v_rcp_f32 v158, v158
v_rcp_f32 v159, v159
v_rcp_f32 v160, v160
v_rcp_f32 v161, v161
v_rcp_f32 v162, v162
v_rcp_f32 v163, v163
v_pk_mul_f32 v[148:149], v[148:149], v[112:113]
v_pk_mul_f32 v[150:151], v[150:151], v[114:115]
v_pk_mul_f32 v[152:153], v[152:153], v[116:117]
v_pk_mul_f32 v[154:155], v[154:155], v[118:119]
v_pk_mul_f32 v[156:157], v[156:157], v[120:121]
v_pk_mul_f32 v[158:159], v[158:159], v[122:123]
v_pk_mul_f32 v[160:161], v[160:161], v[124:125]
v_pk_mul_f32 v[162:163], v[162:163], v[126:127]
v_cvt_pk_bf16_f32 v180, v148, v149
v_cvt_pk_bf16_f32 v181, v150, v151
v_cvt_pk_bf16_f32 v182, v152, v153
v_cvt_pk_bf16_f32 v183, v154, v155
v_cvt_pk_bf16_f32 v184, v156, v157
v_cvt_pk_bf16_f32 v185, v158, v159
v_cvt_pk_bf16_f32 v186, v160, v161
v_cvt_pk_bf16_f32 v187, v162, v163
buffer_store_dwordx4 v[180:183], v144, s[44:47], s62 offen sc1
buffer_store_dwordx4 v[184:187], v144, s[44:47], s62 offen offset:256 sc1
s_add_u32 s62, s82, 3
s_lshl_b32 s62, s62, 12
s_add_u32 s62, s62, s78
v_pk_mul_f32 v[148:149], v[128:129], s[68:69]
v_pk_mul_f32 v[150:151], v[130:131], s[68:69]
v_pk_mul_f32 v[152:153], v[132:133], s[68:69]
v_pk_mul_f32 v[154:155], v[134:135], s[68:69]
v_pk_mul_f32 v[156:157], v[136:137], s[68:69]
v_pk_mul_f32 v[158:159], v[138:139], s[68:69]
v_pk_mul_f32 v[160:161], v[140:141], s[68:69]
v_pk_mul_f32 v[162:163], v[142:143], s[68:69]
v_exp_f32 v148, v148
v_exp_f32 v149, v149
v_exp_f32 v150, v150
v_exp_f32 v151, v151
v_exp_f32 v152, v152
v_exp_f32 v153, v153
v_exp_f32 v154, v154
v_exp_f32 v155, v155
v_exp_f32 v156, v156
v_exp_f32 v157, v157
v_exp_f32 v158, v158
v_exp_f32 v159, v159
v_exp_f32 v160, v160
v_exp_f32 v161, v161
v_exp_f32 v162, v162
v_exp_f32_e64 v163, v163
v_pk_add_f32 v[148:149], v[148:149], s[80:81]
v_pk_add_f32 v[150:151], v[150:151], s[80:81]
v_pk_add_f32 v[152:153], v[152:153], s[80:81]
v_pk_add_f32 v[154:155], v[154:155], s[80:81]
v_pk_add_f32 v[156:157], v[156:157], s[80:81]
v_pk_add_f32 v[158:159], v[158:159], s[80:81]
v_pk_add_f32 v[160:161], v[160:161], s[80:81]
v_pk_add_f32 v[162:163], v[162:163], s[80:81]
v_rcp_f32 v148, v148
v_rcp_f32 v149, v149
v_rcp_f32 v150, v150
v_rcp_f32 v151, v151
v_rcp_f32 v152, v152
v_rcp_f32 v153, v153
v_rcp_f32 v154, v154
v_rcp_f32 v155, v155
v_rcp_f32 v156, v156
v_rcp_f32 v157, v157
v_rcp_f32 v158, v158
v_rcp_f32 v159, v159
v_rcp_f32 v160, v160
v_rcp_f32 v161, v161
v_rcp_f32 v162, v162
v_rcp_f32 v163, v163
v_pk_mul_f32 v[148:149], v[148:149], v[128:129]
v_pk_mul_f32 v[150:151], v[150:151], v[130:131]
v_pk_mul_f32 v[152:153], v[152:153], v[132:133]
v_pk_mul_f32 v[154:155], v[154:155], v[134:135]
v_pk_mul_f32 v[156:157], v[156:157], v[136:137]
v_pk_mul_f32 v[158:159], v[158:159], v[138:139]
v_pk_mul_f32 v[160:161], v[160:161], v[140:141]
v_pk_mul_f32 v[162:163], v[162:163], v[142:143]
v_cvt_pk_bf16_f32 v188, v148, v149
v_cvt_pk_bf16_f32 v189, v150, v151
v_cvt_pk_bf16_f32 v190, v152, v153
v_cvt_pk_bf16_f32 v191, v154, v155
v_cvt_pk_bf16_f32 v192, v156, v157
v_cvt_pk_bf16_f32 v193, v158, v159
v_cvt_pk_bf16_f32 v194, v160, v161
v_cvt_pk_bf16_f32 v195, v162, v163
buffer_store_dwordx4 v[188:191], v144, s[44:47], s62 offen sc1
buffer_store_dwordx4 v[192:195], v144, s[44:47], s62 offen offset:256 sc1
v_mov_b32 v236, 0x7f000000
s_cmp_lg_u32 s56, 0
s_cbranch_scc1 L_s1_skip
v_lshlrev_b32_e64 v236, 7, v1
v_mov_b32 v237, 0x7f000000
v_cmp_gt_u32 vcc, 16, v1
s_nop 1
v_cndmask_b32 v236, v237, v236, vcc
s_lshl_b32 s61, s58, 11
s_add_u32 s61, s61, 2228224
L_p1:
buffer_load_dword v237, v236, s[44:47], s61 offen sc1
s_waitcnt vmcnt(0)
v_cmp_eq_u32 vcc, s84, v237
s_and_b32 s60, vcc_lo, 0xffff
s_cmp_eq_u32 s60, 0xffff
s_cbranch_scc1 L_p1ok
s_sub_u32 s7, s7, 1
s_cbranch_scc1 L_p1ok
s_sleep 2
s_branch L_p1
L_p1ok:
v_lshlrev_b32 v236, 4, v1
v_mov_b32 v237, 0x7f000000
v_cmp_gt_u32 vcc, 60, v1
s_nop 1
v_cndmask_b32_e64 v236, v237, v236, vcc
s_mul_i32 s60, s58, 245760
s_mul_i32 s61, s57, 960
s_add_u32 s60, s60, s61
s_add_u32 s60, s60, 262144
buffer_load_dwordx4 v[148:151], v236, s[44:47], s60 offen sc1
s_add_u32 s60, s60, 15360
buffer_load_dwordx4 v[152:155], v236, s[44:47], s60 offen sc1
s_add_u32 s60, s60, 15360
buffer_load_dwordx4 v[156:159], v236, s[44:47], s60 offen sc1
s_add_u32 s60, s60, 15360
buffer_load_dwordx4 v[160:163], v236, s[44:47], s60 offen sc1
s_add_u32 s60, s60, 15360
buffer_load_dwordx4 v[164:167], v236, s[44:47], s60 offen sc1
s_add_u32 s60, s60, 15360
buffer_load_dwordx4 v[168:171], v236, s[44:47], s60 offen sc1
s_add_u32 s60, s60, 15360
buffer_load_dwordx4 v[172:175], v236, s[44:47], s60 offen sc1
s_add_u32 s60, s60, 15360
buffer_load_dwordx4 v[176:179], v236, s[44:47], s60 offen sc1
s_add_u32 s60, s60, 15360
buffer_load_dwordx4 v[180:183], v236, s[44:47], s60 offen sc1
s_add_u32 s60, s60, 15360
buffer_load_dwordx4 v[184:187], v236, s[44:47], s60 offen sc1
s_add_u32 s60, s60, 15360
buffer_load_dwordx4 v[188:191], v236, s[44:47], s60 offen sc1
s_add_u32 s60, s60, 15360
buffer_load_dwordx4 v[192:195], v236, s[44:47], s60 offen sc1
s_add_u32 s60, s60, 15360
buffer_load_dwordx4 v[216:219], v236, s[44:47], s60 offen sc1
s_add_u32 s60, s60, 15360
buffer_load_dwordx4 v[220:223], v236, s[44:47], s60 offen sc1
s_add_u32 s60, s60, 15360
buffer_load_dwordx4 v[224:227], v236, s[44:47], s60 offen sc1
s_add_u32 s60, s60, 15360
buffer_load_dwordx4 v[228:231], v236, s[44:47], s60 offen sc1
s_add_u32 s60, s60, 15360
L_s1_skip:
v_lshlrev_b32 v244, 4, v1
v_add_u32_e64 v245, 0, v244
v_add_u32 v244, 147456, v244
v_cvt_pk_bf16_f32 v80, v32, v33
v_cvt_pk_bf16_f32 v81, v34, v35
v_cvt_pk_bf16_f32 v82, v36, v37
v_cvt_pk_bf16_f32 v83, v38, v39
v_cvt_pk_bf16_f32 v84, v40, v41
v_cvt_pk_bf16_f32 v85, v42, v43
v_cvt_pk_bf16_f32 v86, v44, v45
v_cvt_pk_bf16_f32 v87, v46, v47
v_cvt_pk_bf16_f32 v88, v48, v49
v_cvt_pk_bf16_f32 v89, v50, v51
v_cvt_pk_bf16_f32 v90, v52, v53
v_cvt_pk_bf16_f32 v91, v54, v55
v_cvt_pk_bf16_f32 v92, v56, v57
v_cvt_pk_bf16_f32 v93, v58, v59
v_cvt_pk_bf16_f32 v94, v60, v61
v_cvt_pk_bf16_f32 v95, v62, v63
v_cvt_pk_bf16_f32 v96, v64, v65
v_cvt_pk_bf16_f32 v97, v66, v67
v_cvt_pk_bf16_f32 v98, v68, v69
v_cvt_pk_bf16_f32 v99, v70, v71
ds_read_b128 v[32:35], v244 offset:0
ds_read_b128 v[36:39], v244 offset:1024
ds_read_b128 v[40:43], v244 offset:2048
ds_read_b128 v[44:47], v244 offset:3072
ds_read_b128 v[48:51], v244 offset:4096
ds_read_b128 v[52:55], v244 offset:5120
ds_read_b128 v[56:59], v244 offset:6144
ds_read_b128 v[60:63], v244 offset:7168
ds_read_b128 v[64:67], v244 offset:8192
ds_read_b128 v[68:71], v244 offset:9216
ds_read_b128 v[72:75], v244 offset:10240
s_waitcnt lgkmcnt(10)
v_mfma_f32_32x32x16_bf16 v[100:115], v[32:35], v[80:83], 0
s_waitcnt lgkmcnt(9)
v_mfma_f32_32x32x16_bf16 v[100:115], v[36:39], v[84:87], v[100:115]
s_waitcnt lgkmcnt(8)
v_mfma_f32_32x32x16_bf16 v[100:115], v[40:43], v[88:91], v[100:115]
s_waitcnt lgkmcnt(7)
v_mfma_f32_32x32x16_bf16 v[116:131], v[44:47], v[88:91], 0
s_waitcnt lgkmcnt(6)
v_mfma_f32_32x32x16_bf16 v[116:131], v[48:51], v[92:95], v[116:131]
s_waitcnt lgkmcnt(5)
v_mfma_f32_32x32x16_bf16 v[116:131], v[52:55], v[96:99], v[116:131]
s_waitcnt lgkmcnt(4)
v_mfma_f32_32x32x16_bf16 v[132:147], v[56:59], v[80:83], 0
s_waitcnt lgkmcnt(3)
v_mfma_f32_32x32x16_bf16 v[132:147], v[60:63], v[84:87], v[132:147]
s_waitcnt lgkmcnt(2)
v_mfma_f32_32x32x16_bf16 v[132:147], v[64:67], v[88:91], v[132:147]
s_waitcnt lgkmcnt(1)
v_mfma_f32_32x32x16_bf16 v[132:147], v[68:71], v[92:95], v[132:147]
s_waitcnt lgkmcnt(0)
v_mfma_f32_32x32x16_bf16 v[132:147], v[72:75], v[96:99], v[132:147]
v_max3_f32 v72, v100, v101, v102
v_min3_f32 v73, v100, v101, v102
v_max3_f32 v72, v72, v103, v104
v_min3_f32 v73, v73, v103, v104
v_max3_f32 v72, v72, v105, v106
v_min3_f32 v73, v73, v105, v106
v_max3_f32 v72, v72, v107, v108
v_min3_f32 v73, v73, v107, v108
v_max3_f32 v72, v72, v109, v110
v_min3_f32 v73, v73, v109, v110
v_max3_f32 v72, v72, v111, v112
v_min3_f32 v73, v73, v111, v112
v_max3_f32 v72, v72, v113, v114
v_min3_f32 v73, v73, v113, v114
v_max3_f32 v72, v72, v115, v132
v_min3_f32 v73, v73, v115, v132
v_max3_f32 v72, v72, v133, v134
v_min3_f32 v73, v73, v133, v134
v_max_f32 v72, v72, v135
v_min_f32 v73, v73, v135
v_mul_f32 v72, s68, v72
v_mul_f32_e64 v73, s66, v73
v_pk_fma_f32 v[32:33], v[100:101], s[66:67], v[72:73] op_sel_hi:[1,1,0]
v_pk_fma_f32 v[52:53], v[100:101], s[68:69], v[72:73] op_sel:[0,0,1] op_sel_hi:[1,1,1]
v_pk_fma_f32 v[34:35], v[102:103], s[66:67], v[72:73] op_sel_hi:[1,1,0]
v_pk_fma_f32 v[54:55], v[102:103], s[68:69], v[72:73] op_sel:[0,0,1] op_sel_hi:[1,1,1]
v_pk_fma_f32 v[36:37], v[104:105], s[66:67], v[72:73] op_sel_hi:[1,1,0]
v_pk_fma_f32 v[56:57], v[104:105], s[68:69], v[72:73] op_sel:[0,0,1] op_sel_hi:[1,1,1]
v_pk_fma_f32 v[38:39], v[106:107], s[66:67], v[72:73] op_sel_hi:[1,1,0]
v_pk_fma_f32 v[58:59], v[106:107], s[68:69], v[72:73] op_sel:[0,0,1] op_sel_hi:[1,1,1]
v_pk_fma_f32 v[40:41], v[108:109], s[66:67], v[72:73] op_sel_hi:[1,1,0]
v_pk_fma_f32 v[60:61], v[108:109], s[68:69], v[72:73] op_sel:[0,0,1] op_sel_hi:[1,1,1]
v_pk_fma_f32 v[42:43], v[110:111], s[66:67], v[72:73] op_sel_hi:[1,1,0]
v_pk_fma_f32 v[62:63], v[110:111], s[68:69], v[72:73] op_sel:[0,0,1] op_sel_hi:[1,1,1]
v_pk_fma_f32 v[44:45], v[112:113], s[66:67], v[72:73] op_sel_hi:[1,1,0]
v_pk_fma_f32 v[64:65], v[112:113], s[68:69], v[72:73] op_sel:[0,0,1] op_sel_hi:[1,1,1]
v_pk_fma_f32 v[46:47], v[114:115], s[66:67], v[72:73] op_sel_hi:[1,1,0]
v_pk_fma_f32 v[66:67], v[114:115], s[68:69], v[72:73] op_sel:[0,0,1] op_sel_hi:[1,1,1]
v_pk_fma_f32 v[48:49], v[132:133], s[66:67], v[72:73] op_sel_hi:[1,1,0]
v_pk_fma_f32 v[68:69], v[132:133], s[68:69], v[72:73] op_sel:[0,0,1] op_sel_hi:[1,1,1]
v_pk_fma_f32 v[50:51], v[134:135], s[66:67], v[72:73] op_sel_hi:[1,1,0]
v_pk_fma_f32 v[70:71], v[134:135], s[68:69], v[72:73] op_sel:[0,0,1] op_sel_hi:[1,1,1]
v_exp_f32 v32, v32
v_exp_f32 v33, v33
v_exp_f32 v34, v34
v_exp_f32 v35, v35
v_exp_f32 v36, v36
v_exp_f32 v37, v37
v_exp_f32 v38, v38
v_exp_f32 v39, v39
v_exp_f32 v40, v40
v_exp_f32 v41, v41
v_exp_f32 v42, v42
v_exp_f32 v43, v43
v_exp_f32 v44, v44
v_exp_f32 v45, v45
v_exp_f32 v46, v46
v_exp_f32 v47, v47
v_exp_f32 v48, v48
v_exp_f32 v49, v49
v_exp_f32 v50, v50
v_exp_f32 v51, v51
v_exp_f32 v52, v52
v_exp_f32 v53, v53
v_exp_f32 v54, v54
v_exp_f32 v55, v55
v_exp_f32 v56, v56
v_exp_f32 v57, v57
v_exp_f32 v58, v58
v_exp_f32 v59, v59
v_exp_f32 v60, v60
v_exp_f32 v61, v61
v_exp_f32 v62, v62
v_exp_f32 v63, v63
v_exp_f32 v64, v64
v_exp_f32 v65, v65
v_exp_f32 v66, v66
v_exp_f32 v67, v67
v_exp_f32 v68, v68
v_exp_f32 v69, v69
v_exp_f32 v70, v70
v_exp_f32 v71, v71
v_pk_add_f32 v[74:75], v[32:33], v[34:35]
v_pk_add_f32 v[76:77], v[52:53], v[54:55]
v_pk_add_f32 v[74:75], v[74:75], v[36:37]
v_pk_add_f32 v[76:77], v[76:77], v[56:57]
v_pk_add_f32 v[74:75], v[74:75], v[38:39]
v_pk_add_f32 v[76:77], v[76:77], v[58:59]
v_pk_add_f32 v[74:75], v[74:75], v[40:41]
v_pk_add_f32 v[76:77], v[76:77], v[60:61]
v_pk_add_f32 v[74:75], v[74:75], v[42:43]
v_pk_add_f32 v[76:77], v[76:77], v[62:63]
v_pk_add_f32 v[74:75], v[74:75], v[44:45]
v_pk_add_f32 v[76:77], v[76:77], v[64:65]
v_pk_add_f32 v[74:75], v[74:75], v[46:47]
v_pk_add_f32 v[76:77], v[76:77], v[66:67]
v_pk_add_f32 v[74:75], v[74:75], v[48:49]
v_pk_add_f32 v[76:77], v[76:77], v[68:69]
v_pk_add_f32 v[74:75], v[74:75], v[50:51]
v_pk_add_f32 v[76:77], v[76:77], v[70:71]
v_add_f32 v74, v74, v75
v_add_f32 v76, v76, v77
v_rcp_f32 v74, v74
v_rcp_f32 v76, v76
v_pk_mul_f32 v[32:33], v[32:33], v[74:75] op_sel_hi:[1,0]
v_pk_mul_f32 v[52:53], v[52:53], v[76:77] op_sel_hi:[1,0]
v_pk_mul_f32 v[34:35], v[34:35], v[74:75] op_sel_hi:[1,0]
v_pk_mul_f32 v[54:55], v[54:55], v[76:77] op_sel_hi:[1,0]
v_pk_mul_f32 v[36:37], v[36:37], v[74:75] op_sel_hi:[1,0]
v_pk_mul_f32 v[56:57], v[56:57], v[76:77] op_sel_hi:[1,0]
v_pk_mul_f32 v[38:39], v[38:39], v[74:75] op_sel_hi:[1,0]
v_pk_mul_f32 v[58:59], v[58:59], v[76:77] op_sel_hi:[1,0]
v_pk_mul_f32 v[40:41], v[40:41], v[74:75] op_sel_hi:[1,0]
v_pk_mul_f32 v[60:61], v[60:61], v[76:77] op_sel_hi:[1,0]
v_pk_mul_f32 v[42:43], v[42:43], v[74:75] op_sel_hi:[1,0]
v_pk_mul_f32 v[62:63], v[62:63], v[76:77] op_sel_hi:[1,0]
v_pk_mul_f32 v[44:45], v[44:45], v[74:75] op_sel_hi:[1,0]
v_pk_mul_f32 v[64:65], v[64:65], v[76:77] op_sel_hi:[1,0]
v_pk_mul_f32 v[46:47], v[46:47], v[74:75] op_sel_hi:[1,0]
v_pk_mul_f32 v[66:67], v[66:67], v[76:77] op_sel_hi:[1,0]
v_pk_mul_f32 v[48:49], v[48:49], v[74:75] op_sel_hi:[1,0]
v_pk_mul_f32 v[68:69], v[68:69], v[76:77] op_sel_hi:[1,0]
v_pk_mul_f32 v[50:51], v[50:51], v[74:75] op_sel_hi:[1,0]
v_pk_mul_f32 v[70:71], v[70:71], v[76:77] op_sel_hi:[1,0]
v_cvt_pk_bf16_f32 v196, v32, v33
v_cvt_pk_bf16_f32 v197, v34, v35
v_cvt_pk_bf16_f32 v198, v36, v37
v_cvt_pk_bf16_f32 v199, v38, v39
v_cvt_pk_bf16_f32 v200, v40, v41
v_cvt_pk_bf16_f32 v201, v42, v43
v_cvt_pk_bf16_f32 v202, v44, v45
v_cvt_pk_bf16_f32 v203, v46, v47
v_cvt_pk_bf16_f32 v204, v48, v49
v_cvt_pk_bf16_f32 v205, v50, v51
v_cvt_pk_bf16_f32 v206, v52, v53
v_cvt_pk_bf16_f32 v207, v54, v55
v_cvt_pk_bf16_f32 v208, v56, v57
v_cvt_pk_bf16_f32 v209, v58, v59
v_cvt_pk_bf16_f32 v210, v60, v61
v_cvt_pk_bf16_f32 v211, v62, v63
v_cvt_pk_bf16_f32 v212, v64, v65
v_cvt_pk_bf16_f32 v213, v66, v67
v_cvt_pk_bf16_f32 v214, v68, v69
v_cvt_pk_bf16_f32 v215, v70, v71
s_cmp_lg_u32 s56, 0
s_cbranch_scc1 L_s2_skip
s_waitcnt vmcnt(0)
v_pk_add_f32 v[148:149], v[148:149], v[180:181]
v_pk_add_f32 v[150:151], v[150:151], v[182:183]
v_pk_add_f32 v[152:153], v[152:153], v[184:185]
v_pk_add_f32 v[154:155], v[154:155], v[186:187]
v_pk_add_f32 v[156:157], v[156:157], v[188:189]
v_pk_add_f32 v[158:159], v[158:159], v[190:191]
v_pk_add_f32 v[160:161], v[160:161], v[192:193]
v_pk_add_f32 v[162:163], v[162:163], v[194:195]
v_pk_add_f32 v[164:165], v[164:165], v[216:217]
v_pk_add_f32 v[166:167], v[166:167], v[218:219]
v_pk_add_f32 v[168:169], v[168:169], v[220:221]
v_pk_add_f32 v[170:171], v[170:171], v[222:223]
v_pk_add_f32 v[172:173], v[172:173], v[224:225]
v_pk_add_f32 v[174:175], v[174:175], v[226:227]
v_pk_add_f32 v[176:177], v[176:177], v[228:229]
v_pk_add_f32 v[178:179], v[178:179], v[230:231]
v_pk_add_f32 v[148:149], v[148:149], v[164:165]
v_pk_add_f32 v[150:151], v[150:151], v[166:167]
v_pk_add_f32 v[152:153], v[152:153], v[168:169]
v_pk_add_f32 v[154:155], v[154:155], v[170:171]
v_pk_add_f32 v[156:157], v[156:157], v[172:173]
v_pk_add_f32 v[158:159], v[158:159], v[174:175]
v_pk_add_f32 v[160:161], v[160:161], v[176:177]
v_pk_add_f32 v[162:163], v[162:163], v[178:179]
v_pk_add_f32 v[148:149], v[148:149], v[156:157]
v_pk_add_f32 v[150:151], v[150:151], v[158:159]
v_pk_add_f32 v[152:153], v[152:153], v[160:161]
v_pk_add_f32 v[154:155], v[154:155], v[162:163]
v_pk_add_f32 v[148:149], v[148:149], v[152:153]
v_pk_add_f32 v[150:151], v[150:151], v[154:155]
s_mul_i32 s60, s58, 15360
s_mul_i32 s61, s57, 960
s_add_u32 s60, s60, s61
s_add_u32 s60, s60, 0
buffer_store_dwordx4 v[148:151], v236, s[44:47], s60 offen sc1
L_s2_skip:
v_max3_f32 v72, v116, v117, v118
v_min3_f32 v73, v116, v117, v118
v_max3_f32 v72, v72, v119, v120
v_min3_f32 v73, v73, v119, v120
v_max3_f32 v72, v72, v121, v122
v_min3_f32 v73, v73, v121, v122
v_max3_f32 v72, v72, v123, v124
v_min3_f32 v73, v73, v123, v124
v_max3_f32 v72, v72, v125, v126
v_min3_f32 v73, v73, v125, v126
v_max3_f32 v72, v72, v127, v128
v_min3_f32 v73, v73, v127, v128
v_max3_f32 v72, v72, v129, v130
v_min3_f32 v73, v73, v129, v130
v_max3_f32 v72, v72, v131, v136
v_min3_f32 v73, v73, v131, v136
v_max3_f32 v72, v72, v137, v138
v_min3_f32 v73, v73, v137, v138
v_max_f32 v72, v72, v139
v_min_f32 v73, v73, v139
v_mul_f32 v72, s68, v72
v_mul_f32_e64 v73, s66, v73
v_pk_fma_f32 v[32:33], v[116:117], s[66:67], v[72:73] op_sel_hi:[1,1,0]
v_pk_fma_f32 v[52:53], v[116:117], s[68:69], v[72:73] op_sel:[0,0,1] op_sel_hi:[1,1,1]
v_pk_fma_f32 v[34:35], v[118:119], s[66:67], v[72:73] op_sel_hi:[1,1,0]
v_pk_fma_f32 v[54:55], v[118:119], s[68:69], v[72:73] op_sel:[0,0,1] op_sel_hi:[1,1,1]
v_pk_fma_f32 v[36:37], v[120:121], s[66:67], v[72:73] op_sel_hi:[1,1,0]
v_pk_fma_f32 v[56:57], v[120:121], s[68:69], v[72:73] op_sel:[0,0,1] op_sel_hi:[1,1,1]
v_pk_fma_f32 v[38:39], v[122:123], s[66:67], v[72:73] op_sel_hi:[1,1,0]
v_pk_fma_f32 v[58:59], v[122:123], s[68:69], v[72:73] op_sel:[0,0,1] op_sel_hi:[1,1,1]
v_pk_fma_f32 v[40:41], v[124:125], s[66:67], v[72:73] op_sel_hi:[1,1,0]
v_pk_fma_f32 v[60:61], v[124:125], s[68:69], v[72:73] op_sel:[0,0,1] op_sel_hi:[1,1,1]
v_pk_fma_f32 v[42:43], v[126:127], s[66:67], v[72:73] op_sel_hi:[1,1,0]
v_pk_fma_f32 v[62:63], v[126:127], s[68:69], v[72:73] op_sel:[0,0,1] op_sel_hi:[1,1,1]
v_pk_fma_f32 v[44:45], v[128:129], s[66:67], v[72:73] op_sel_hi:[1,1,0]
v_pk_fma_f32 v[64:65], v[128:129], s[68:69], v[72:73] op_sel:[0,0,1] op_sel_hi:[1,1,1]
v_pk_fma_f32 v[46:47], v[130:131], s[66:67], v[72:73] op_sel_hi:[1,1,0]
v_pk_fma_f32 v[66:67], v[130:131], s[68:69], v[72:73] op_sel:[0,0,1] op_sel_hi:[1,1,1]
v_pk_fma_f32 v[48:49], v[136:137], s[66:67], v[72:73] op_sel_hi:[1,1,0]
v_pk_fma_f32 v[68:69], v[136:137], s[68:69], v[72:73] op_sel:[0,0,1] op_sel_hi:[1,1,1]
v_pk_fma_f32 v[50:51], v[138:139], s[66:67], v[72:73] op_sel_hi:[1,1,0]
v_pk_fma_f32 v[70:71], v[138:139], s[68:69], v[72:73] op_sel:[0,0,1] op_sel_hi:[1,1,1]
v_exp_f32 v32, v32
v_exp_f32 v33, v33
v_exp_f32 v34, v34
v_exp_f32 v35, v35
v_exp_f32 v36, v36
v_exp_f32 v37, v37
v_exp_f32 v38, v38
v_exp_f32 v39, v39
v_exp_f32 v40, v40
v_exp_f32 v41, v41
v_exp_f32 v42, v42
v_exp_f32 v43, v43
v_exp_f32 v44, v44
v_exp_f32 v45, v45
v_exp_f32 v46, v46
v_exp_f32 v47, v47
v_exp_f32 v48, v48
v_exp_f32 v49, v49
v_exp_f32 v50, v50
v_exp_f32 v51, v51
v_exp_f32 v52, v52
v_exp_f32 v53, v53
v_exp_f32 v54, v54
v_exp_f32 v55, v55
v_exp_f32 v56, v56
v_exp_f32 v57, v57
v_exp_f32 v58, v58
v_exp_f32 v59, v59
v_exp_f32 v60, v60
v_exp_f32 v61, v61
v_exp_f32 v62, v62
v_exp_f32 v63, v63
v_exp_f32 v64, v64
v_exp_f32 v65, v65
v_exp_f32 v66, v66
v_exp_f32 v67, v67
v_exp_f32 v68, v68
v_exp_f32 v69, v69
v_exp_f32 v70, v70
v_exp_f32 v71, v71
v_pk_add_f32 v[74:75], v[32:33], v[34:35]
v_pk_add_f32 v[76:77], v[52:53], v[54:55]
v_pk_add_f32 v[74:75], v[74:75], v[36:37]
v_pk_add_f32 v[76:77], v[76:77], v[56:57]
v_pk_add_f32 v[74:75], v[74:75], v[38:39]
v_pk_add_f32 v[76:77], v[76:77], v[58:59]
v_pk_add_f32 v[74:75], v[74:75], v[40:41]
v_pk_add_f32 v[76:77], v[76:77], v[60:61]
v_pk_add_f32 v[74:75], v[74:75], v[42:43]
v_pk_add_f32 v[76:77], v[76:77], v[62:63]
v_pk_add_f32 v[74:75], v[74:75], v[44:45]
v_pk_add_f32 v[76:77], v[76:77], v[64:65]
v_pk_add_f32 v[74:75], v[74:75], v[46:47]
v_pk_add_f32 v[76:77], v[76:77], v[66:67]
v_pk_add_f32 v[74:75], v[74:75], v[48:49]
v_pk_add_f32 v[76:77], v[76:77], v[68:69]
v_pk_add_f32 v[74:75], v[74:75], v[50:51]
v_pk_add_f32 v[76:77], v[76:77], v[70:71]
v_add_f32 v74, v74, v75
v_add_f32 v76, v76, v77
v_rcp_f32 v74, v74
v_rcp_f32 v76, v76
v_pk_mul_f32 v[32:33], v[32:33], v[74:75] op_sel_hi:[1,0]
v_pk_mul_f32 v[52:53], v[52:53], v[76:77] op_sel_hi:[1,0]
v_pk_mul_f32 v[34:35], v[34:35], v[74:75] op_sel_hi:[1,0]
v_pk_mul_f32 v[54:55], v[54:55], v[76:77] op_sel_hi:[1,0]
v_pk_mul_f32 v[36:37], v[36:37], v[74:75] op_sel_hi:[1,0]
v_pk_mul_f32 v[56:57], v[56:57], v[76:77] op_sel_hi:[1,0]
v_pk_mul_f32 v[38:39], v[38:39], v[74:75] op_sel_hi:[1,0]
v_pk_mul_f32 v[58:59], v[58:59], v[76:77] op_sel_hi:[1,0]
v_pk_mul_f32 v[40:41], v[40:41], v[74:75] op_sel_hi:[1,0]
v_pk_mul_f32 v[60:61], v[60:61], v[76:77] op_sel_hi:[1,0]
v_pk_mul_f32 v[42:43], v[42:43], v[74:75] op_sel_hi:[1,0]
v_pk_mul_f32 v[62:63], v[62:63], v[76:77] op_sel_hi:[1,0]
v_pk_mul_f32 v[44:45], v[44:45], v[74:75] op_sel_hi:[1,0]
v_pk_mul_f32 v[64:65], v[64:65], v[76:77] op_sel_hi:[1,0]
v_pk_mul_f32 v[46:47], v[46:47], v[74:75] op_sel_hi:[1,0]
v_pk_mul_f32 v[66:67], v[66:67], v[76:77] op_sel_hi:[1,0]
v_pk_mul_f32 v[48:49], v[48:49], v[74:75] op_sel_hi:[1,0]
v_pk_mul_f32 v[68:69], v[68:69], v[76:77] op_sel_hi:[1,0]
v_pk_mul_f32 v[50:51], v[50:51], v[74:75] op_sel_hi:[1,0]
v_pk_mul_f32 v[70:71], v[70:71], v[76:77] op_sel_hi:[1,0]
v_cvt_pk_bf16_f32 v216, v32, v33
v_cvt_pk_bf16_f32 v217, v34, v35
v_cvt_pk_bf16_f32 v218, v36, v37
v_cvt_pk_bf16_f32 v219, v38, v39
v_cvt_pk_bf16_f32 v220, v40, v41
v_cvt_pk_bf16_f32 v221, v42, v43
v_cvt_pk_bf16_f32 v222, v44, v45
v_cvt_pk_bf16_f32 v223, v46, v47
v_cvt_pk_bf16_f32 v224, v48, v49
v_cvt_pk_bf16_f32 v225, v50, v51
v_cvt_pk_bf16_f32 v226, v52, v53
v_cvt_pk_bf16_f32 v227, v54, v55
v_cvt_pk_bf16_f32 v228, v56, v57
v_cvt_pk_bf16_f32 v229, v58, v59
v_cvt_pk_bf16_f32 v230, v60, v61
v_cvt_pk_bf16_f32 v231, v62, v63
v_cvt_pk_bf16_f32 v232, v64, v65
v_cvt_pk_bf16_f32 v233, v66, v67
v_cvt_pk_bf16_f32 v234, v68, v69
v_cvt_pk_bf16_f32 v235, v70, v71
s_cmp_lg_u32 s56, 0
s_cbranch_scc1 L_f2skip
v_mov_b32 v237, s84
s_lshl_b32 s60, s58, 4
s_add_u32 s60, s60, s57
s_lshl_b32 s60, s60, 7
s_add_u32 s60, s60, 2244608
s_waitcnt vmcnt(0)
s_mov_b64 exec, 1
buffer_store_dword v237, off, s[44:47], s60 sc1
s_mov_b64 exec, -1
L_f2skip:
s_add_u32 m0, s94, 0
s_nop 0
buffer_load_dwordx4 v240, s[44:47], s90 offen sc1 lds
s_add_u32 m0, s94, 1024
s_nop 0
buffer_load_dwordx4 v252, s[44:47], s90 offen sc1 lds
s_add_u32 m0, s94, 2048
s_nop 0
buffer_load_dwordx4 v253, s[44:47], s90 offen sc1 lds
s_add_u32 m0, s94, 3072
s_nop 0
buffer_load_dwordx4 v254, s[44:47], s90 offen sc1 lds
s_add_u32 m0, s94, 4096
s_nop 0
buffer_load_dwordx4 v241, s[44:47], s90 offen sc1 lds
s_add_u32 s90, s90, 5120
s_add_u32 m0, s94, 5120
s_nop 0
buffer_load_dwordx4 v240, s[44:47], s90 offen sc1 lds
s_add_u32 m0, s94, 6144
s_nop 0
buffer_load_dwordx4 v252, s[44:47], s90 offen sc1 lds
s_add_u32 m0, s94, 7168
s_nop 0
buffer_load_dwordx4 v253, s[44:47], s90 offen sc1 lds
s_add_u32 m0, s94, 8192
s_nop 0
buffer_load_dwordx4 v254, s[44:47], s90 offen sc1 lds
s_add_u32 m0, s94, 9216
s_nop 0
buffer_load_dwordx4 v241, s[44:47], s90 offen sc1 lds
s_add_u32 s90, s90, 5120
s_add_u32 m0, s94, 10240
s_nop 0
buffer_load_dwordx4 v240, s[44:47], s90 offen sc1 lds
s_add_u32 m0, s94, 11264
s_nop 0
buffer_load_dwordx4 v252, s[44:47], s90 offen sc1 lds
s_add_u32 m0, s94, 12288
s_nop 0
buffer_load_dwordx4 v253, s[44:47], s90 offen sc1 lds
s_add_u32 m0, s94, 13312
s_nop 0
buffer_load_dwordx4 v254, s[44:47], s90 offen sc1 lds
s_add_u32 m0, s94, 14336
s_nop 0
buffer_load_dwordx4 v241, s[44:47], s90 offen sc1 lds
s_add_u32 s90, s90, 5120
s_add_u32 m0, s94, 15360
s_nop 0
buffer_load_dwordx4 v240, s[44:47], s90 offen sc1 lds
s_add_u32 m0, s94, 16384
s_nop 0
buffer_load_dwordx4 v252, s[44:47], s90 offen sc1 lds
s_add_u32 m0, s94, 17408
s_nop 0
buffer_load_dwordx4 v253, s[44:47], s90 offen sc1 lds
s_add_u32 m0, s94, 18432
s_nop 0
buffer_load_dwordx4 v254, s[44:47], s90 offen sc1 lds
s_add_u32 m0, s94, 19456
s_nop 0
buffer_load_dwordx4 v241, s[44:47], s90 offen sc1 lds
s_add_u32 s90, s90, 5120
s_add_u32 m0, s94, 20480
s_nop 0
buffer_load_dwordx4 v240, s[44:47], s90 offen sc1 lds
s_add_u32 m0, s94, 21504
s_nop 0
buffer_load_dwordx4 v252, s[44:47], s90 offen sc1 lds
s_add_u32 m0, s94, 22528
s_nop 0
buffer_load_dwordx4 v253, s[44:47], s90 offen sc1 lds
s_add_u32 m0, s94, 23552
s_nop 0
buffer_load_dwordx4 v254, s[44:47], s90 offen sc1 lds
s_add_u32 m0, s94, 24576
s_nop 0
buffer_load_dwordx4 v241, s[44:47], s90 offen sc1 lds
s_add_u32 s90, s90, 5120
s_add_u32 m0, s94, 25600
s_nop 0
buffer_load_dwordx4 v240, s[44:47], s90 offen sc1 lds
s_add_u32 m0, s94, 26624
s_nop 0
buffer_load_dwordx4 v252, s[44:47], s90 offen sc1 lds
s_add_u32 m0, s94, 27648
s_nop 0
buffer_load_dwordx4 v253, s[44:47], s90 offen sc1 lds
s_add_u32 m0, s94, 28672
s_nop 0
buffer_load_dwordx4 v254, s[44:47], s90 offen sc1 lds
s_add_u32 m0, s94, 29696
s_nop 0
buffer_load_dwordx4 v241, s[44:47], s90 offen sc1 lds
s_add_u32 s90, s90, 5120
s_cmp_lg_u32 s56, 0
s_cbranch_scc1 L_dok
v_lshlrev_b32_e64 v32, 7, v1
v_mov_b32 v33, 0x7f000000
v_cmp_gt_u32 vcc, 16, v1
s_nop 1
v_cndmask_b32 v32, v33, v32, vcc
s_lshl_b32 s61, s58, 11
s_add_u32 s61, s61, 2244608
L_dpoll:
buffer_load_dword v33, v32, s[44:47], s61 offen sc1
s_waitcnt vmcnt(0)
v_cmp_eq_u32 vcc, s84, v33
s_and_b32 s60, vcc_lo, 0xffff
s_cmp_eq_u32 s60, 0xffff
s_cbranch_scc1 L_dok
s_sub_u32 s7, s7, 1
s_cbranch_scc1 L_dok
s_sleep 2
s_branch L_dpoll
L_dok:
s_barrier
v_and_b32 v28, 31, v1
v_lshrrev_b32 v29, 5, v1
v_lshlrev_b32 v32, 4, v1
v_lshlrev_b32 v30, 4, v28
v_lshl_add_u32 v30, v29, 7, v30
v_add_u32 v30, 3072, v30
v_mov_b32 v31, 0x7f000000
v_cmp_gt_u32 vcc, 8, v28
s_nop 1
v_cndmask_b32 v33, v31, v30, vcc
s_lshl_b32 s60, s58, 2
s_add_u32 s60, s60, s56
s_mul_i32 s60, s60, 3840
s_add_u32 s60, s60, 0
buffer_load_dwordx4 v[36:39], v32, s[44:47], s60 offen offset:0 sc1
buffer_load_dwordx4 v[48:51], v33, s[44:47], s60 offen offset:0 sc1
buffer_load_dwordx4 v[40:43], v32, s[44:47], s60 offen offset:1024 sc1
buffer_load_dwordx4 v[52:55], v33, s[44:47], s60 offen offset:256 sc1
buffer_load_dwordx4 v[44:47], v32, s[44:47], s60 offen offset:2048 sc1
buffer_load_dwordx4 v[56:59], v33, s[44:47], s60 offen offset:512 sc1
v_lshrrev_b32 v30, 3, v28
v_lshlrev_b32 v30, 10, v30
v_and_b32_e64 v31, 7, v28
v_lshl_add_u32 v30, v31, 1, v30
s_lshr_b32 s60, s56, 1
s_and_b32 s61, s56, 1
s_mul_i32 s62, s60, 576
s_mul_i32 s63, s61, 5120
s_add_u32 s62, s62, s63
s_add_u32 s62, s62, 0
v_add_u32_e64 v30, s62, v30
v_lshl_add_u32 v60, v29, 7, v30
s_lshl_b32 s63, s61, 7
s_add_u32 s63, s63, 10240
v_lshl_add_u32 v61, v29, 8, v30
v_add_u32 v61, s63, v61
v_mov_b32 v31, 20480
v_add_u32 v62, 4096, v60
v_add_u32 v63, 4096, v61
v_cmp_gt_u32 vcc, 8, v28
s_nop 1
v_cndmask_b32 v62, v31, v62, vcc
v_cndmask_b32 v63, v31, v63, vcc
s_waitcnt vmcnt(0)
v_cvt_pk_bf16_f32 v36, v36, v37
v_cvt_pk_bf16_f32 v38, v38, v39
ds_write_b16 v60, v36 offset:0
ds_write_b16_d16_hi v60, v36 offset:16
ds_write_b16 v60, v38 offset:32
ds_write_b16_d16_hi v60, v38 offset:48
v_cvt_pk_bf16_f32 v40, v40, v41
v_cvt_pk_bf16_f32 v42, v42, v43
ds_write_b16 v60, v40 offset:256
ds_write_b16_d16_hi v60, v40 offset:272
ds_write_b16 v60, v42 offset:288
ds_write_b16_d16_hi v60, v42 offset:304
v_cvt_pk_bf16_f32 v44, v44, v45
v_cvt_pk_bf16_f32 v46, v46, v47
ds_write_b16 v61, v44 offset:0
ds_write_b16_d16_hi v61, v44 offset:16
ds_write_b16 v61, v46 offset:32
ds_write_b16_d16_hi v61, v46 offset:48
v_cvt_pk_bf16_f32 v48, v48, v49
v_cvt_pk_bf16_f32 v50, v50, v51
ds_write_b16 v62, v48 offset:0
ds_write_b16_d16_hi v62, v48 offset:16
ds_write_b16 v62, v50 offset:32
ds_write_b16_d16_hi v62, v50 offset:48
v_cvt_pk_bf16_f32 v52, v52, v53
v_cvt_pk_bf16_f32 v54, v54, v55
ds_write_b16 v62, v52 offset:256
ds_write_b16_d16_hi v62, v52 offset:272
ds_write_b16 v62, v54 offset:288
ds_write_b16_d16_hi v62, v54 offset:304
v_cvt_pk_bf16_f32 v56, v56, v57
v_cvt_pk_bf16_f32 v58, v58, v59
ds_write_b16 v63, v56 offset:0
ds_write_b16_d16_hi v63, v56 offset:16
ds_write_b16 v63, v58 offset:32
ds_write_b16_d16_hi v63, v58 offset:48
s_waitcnt lgkmcnt(0)
s_barrier
ds_read_b128 v[100:103], v245 offset:0
ds_read_b128 v[104:107], v245 offset:1024
ds_read_b128 v[108:111], v245 offset:2048
ds_read_b128 v[112:115], v245 offset:3072
ds_read_b128 v[116:119], v245 offset:4096
ds_read_b128 v[120:123], v245 offset:5120
ds_read_b128 v[124:127], v245 offset:6144
ds_read_b128 v[128:131], v245 offset:7168
s_waitcnt lgkmcnt(7)
v_mfma_f32_32x32x16_bf16 v[32:47], v[100:103], v[196:199], 0
ds_read_b128 v[132:135], v245 offset:8192
s_waitcnt lgkmcnt(7)
v_mfma_f32_32x32x16_bf16 v[32:47], v[104:107], v[200:203], v[32:47]
ds_read_b128 v[136:139], v245 offset:9216
s_waitcnt lgkmcnt(7)
v_mfma_f32_32x32x16_bf16 v[32:47], v[108:111], v[204:207], v[32:47]
ds_read_b128 v[140:143], v245 offset:10240
s_waitcnt lgkmcnt(7)
v_mfma_f32_32x32x16_bf16 v[32:47], v[112:115], v[208:211], v[32:47]
ds_read_b128 v[144:147], v245 offset:11264
s_waitcnt lgkmcnt(7)
v_mfma_f32_32x32x16_bf16 v[32:47], v[116:119], v[212:215], v[32:47]
ds_read_b128 v[148:151], v245 offset:12288
s_waitcnt lgkmcnt(7)
v_mfma_f32_32x32x16_bf16 v[48:63], v[120:123], v[216:219], 0
ds_read_b128 v[152:155], v245 offset:13312
s_waitcnt lgkmcnt(7)
v_mfma_f32_32x32x16_bf16 v[48:63], v[124:127], v[220:223], v[48:63]
ds_read_b128 v[156:159], v245 offset:14336
s_waitcnt lgkmcnt(7)
v_mfma_f32_32x32x16_bf16 v[48:63], v[128:131], v[224:227], v[48:63]
ds_read_b128 v[160:163], v245 offset:15360
s_waitcnt lgkmcnt(7)
v_mfma_f32_32x32x16_bf16 v[48:63], v[132:135], v[228:231], v[48:63]
ds_read_b128 v[164:167], v245 offset:16384
s_waitcnt lgkmcnt(7)
v_mfma_f32_32x32x16_bf16 v[48:63], v[136:139], v[232:235], v[48:63]
ds_read_b128 v[168:171], v245 offset:17408
s_waitcnt lgkmcnt(7)
v_mfma_f32_32x32x16_bf16 v[64:79], v[140:143], v[196:199], 0
ds_read_b128 v[172:175], v245 offset:18432
s_waitcnt lgkmcnt(7)
v_mfma_f32_32x32x16_bf16 v[64:79], v[144:147], v[200:203], v[64:79]
ds_read_b128 v[176:179], v245 offset:19456
s_waitcnt lgkmcnt(7)
v_mfma_f32_32x32x16_bf16 v[64:79], v[148:151], v[204:207], v[64:79]
s_waitcnt lgkmcnt(6)
v_mfma_f32_32x32x16_bf16 v[64:79], v[152:155], v[208:211], v[64:79]
s_waitcnt lgkmcnt(5)
v_mfma_f32_32x32x16_bf16 v[64:79], v[156:159], v[212:215], v[64:79]
s_waitcnt lgkmcnt(4)
v_mfma_f32_32x32x16_bf16 v[64:79], v[160:163], v[216:219], v[64:79]
s_waitcnt lgkmcnt(3)
v_mfma_f32_32x32x16_bf16 v[64:79], v[164:167], v[220:223], v[64:79]
s_waitcnt lgkmcnt(2)
v_mfma_f32_32x32x16_bf16 v[64:79], v[168:171], v[224:227], v[64:79]
s_waitcnt lgkmcnt(1)
v_mfma_f32_32x32x16_bf16 v[64:79], v[172:175], v[228:231], v[64:79]
s_waitcnt lgkmcnt(0)
v_mfma_f32_32x32x16_bf16 v[64:79], v[176:179], v[232:235], v[64:79]
s_mov_b32 s60, 0x358637bd
s_nop 10
v_add_f32 v80, s60, v72
v_add_f32 v82, s60, v76
v_rcp_f32 v80, v80
v_rcp_f32 v82, v82
v_pk_mul_f32 v[32:33], v[32:33], v[80:81] op_sel_hi:[1,0]
v_pk_mul_f32 v[34:35], v[34:35], v[80:81] op_sel_hi:[1,0]
v_pk_mul_f32 v[36:37], v[36:37], v[80:81] op_sel_hi:[1,0]
v_pk_mul_f32 v[38:39], v[38:39], v[80:81] op_sel_hi:[1,0]
v_pk_mul_f32 v[40:41], v[40:41], v[80:81] op_sel_hi:[1,0]
v_pk_mul_f32 v[42:43], v[42:43], v[80:81] op_sel_hi:[1,0]
v_pk_mul_f32 v[44:45], v[44:45], v[80:81] op_sel_hi:[1,0]
v_pk_mul_f32 v[46:47], v[46:47], v[80:81] op_sel_hi:[1,0]
v_pk_mul_f32 v[64:65], v[64:65], v[80:81] op_sel_hi:[1,0]
v_pk_mul_f32 v[66:67], v[66:67], v[80:81] op_sel_hi:[1,0]
v_cvt_pk_bf16_f32 v84, v32, v33
v_cvt_pk_bf16_f32 v85, v34, v35
v_cvt_pk_bf16_f32 v86, v36, v37
v_cvt_pk_bf16_f32 v87, v38, v39
v_cvt_pk_bf16_f32 v88, v40, v41
v_cvt_pk_bf16_f32 v89, v42, v43
v_cvt_pk_bf16_f32 v90, v44, v45
v_cvt_pk_bf16_f32 v91, v46, v47
v_cvt_pk_bf16_f32 v92, v64, v65
v_cvt_pk_bf16_f32 v93, v66, v67
v_pk_mul_f32 v[48:49], v[48:49], v[82:83] op_sel_hi:[1,0]
v_pk_mul_f32 v[50:51], v[50:51], v[82:83] op_sel_hi:[1,0]
v_pk_mul_f32 v[52:53], v[52:53], v[82:83] op_sel_hi:[1,0]
v_pk_mul_f32 v[54:55], v[54:55], v[82:83] op_sel_hi:[1,0]
v_pk_mul_f32 v[56:57], v[56:57], v[82:83] op_sel_hi:[1,0]
v_pk_mul_f32 v[58:59], v[58:59], v[82:83] op_sel_hi:[1,0]
v_pk_mul_f32 v[60:61], v[60:61], v[82:83] op_sel_hi:[1,0]
v_pk_mul_f32 v[62:63], v[62:63], v[82:83] op_sel_hi:[1,0]
v_pk_mul_f32 v[68:69], v[68:69], v[82:83] op_sel_hi:[1,0]
v_pk_mul_f32 v[70:71], v[70:71], v[82:83] op_sel_hi:[1,0]
v_cvt_pk_bf16_f32 v94, v48, v49
v_cvt_pk_bf16_f32 v95, v50, v51
v_cvt_pk_bf16_f32 v96, v52, v53
v_cvt_pk_bf16_f32 v97, v54, v55
v_cvt_pk_bf16_f32 v98, v56, v57
v_cvt_pk_bf16_f32 v99, v58, v59
v_cvt_pk_bf16_f32 v100, v60, v61
v_cvt_pk_bf16_f32 v101, v62, v63
v_cvt_pk_bf16_f32 v102, v68, v69
v_cvt_pk_bf16_f32 v103, v70, v71
v_and_b32_e64 v28, 15, v1
v_bfe_u32 v29, v1, 4, 1
v_lshrrev_b32 v30, 5, v1
v_lshlrev_b32 v104, 4, v28
v_lshl_add_u32 v104, v29, 10, v104
s_and_b32 s60, s56, 1
s_lshl_b32 s60, s60, 11
v_add_u32 v104, s60, v104
s_mul_i32 s60, s58, 10
v_mul_u32_u24 v30, 5, v30
v_add_u32 v30, s60, v30
s_add_u32 s62, s78, 221184
v_add_u32 v28, 0, v30
v_lshrrev_b32 v29, 2, v28
v_and_b32_e64 v28, 3, v28
v_lshl_add_u32 v105, v29, 12, v104
v_lshl_add_u32 v105, v28, 8, v105
buffer_store_dwordx4 v[84:87], v105, s[44:47], s62 offen sc1
v_add_u32 v28, 1, v30
v_lshrrev_b32 v29, 2, v28
v_and_b32_e64 v28, 3, v28
v_lshl_add_u32 v106, v29, 12, v104
v_lshl_add_u32 v106, v28, 8, v106
buffer_store_dwordx4 v[88:91], v106, s[44:47], s62 offen sc1
v_add_u32 v28, 2, v30
v_lshrrev_b32 v29, 2, v28
v_and_b32_e64 v28, 3, v28
v_lshl_add_u32 v107, v29, 12, v104
v_lshl_add_u32 v107, v28, 8, v107
buffer_store_dwordx4 v[92:95], v107, s[44:47], s62 offen sc1
v_add_u32 v28, 3, v30
v_lshrrev_b32 v29, 2, v28
v_and_b32_e64 v28, 3, v28
v_lshl_add_u32 v108, v29, 12, v104
v_lshl_add_u32 v108, v28, 8, v108
buffer_store_dwordx4 v[96:99], v108, s[44:47], s62 offen sc1
v_add_u32 v28, 4, v30
v_lshrrev_b32 v29, 2, v28
v_and_b32_e64 v28, 3, v28
v_lshl_add_u32 v109, v29, 12, v104
v_lshl_add_u32 v109, v28, 8, v109
buffer_store_dwordx4 v[100:103], v109, s[44:47], s62 offen sc1
L_k2:
s_nop 7
s_nop 7
v_lshlrev_b32_e64 v245, 10, v1
v_mov_b32 v251, 0x7f000000
v_cmp_gt_u32 vcc, 20, v1
s_nop 1
v_cndmask_b32_e64 v245, v251, v245, vcc
buffer_load_dword v251, v245, s[44:47], s93 offen sc1
s_mov_b32 s62, 0x3ffff
s_cmp_eq_u32 s56, 3
s_cselect_b32 s62, 0xfffff, s62
s_waitcnt vmcnt(0)
L_wp_K:
v_cmp_eq_u32 vcc, s84, v251
s_and_b32 s60, vcc_lo, s62
s_cmp_eq_u32 s60, s62
s_cbranch_scc1 L_wpok_K
s_sub_u32 s7, s7, 1
s_cbranch_scc1 L_wpok_K
s_sleep 2
buffer_load_dword v251, v245, s[44:47], s93 offen sc1
s_waitcnt vmcnt(0)
s_branch L_wp_K
L_wpok_K:
v_lshlrev_b32 v240, 4, v1
v_add_u32 v241, 4096, v240
s_waitcnt vmcnt(0) lgkmcnt(0)
s_barrier
s_cmp_lg_u32 s56, 0
s_cbranch_scc1 L_k2_go
v_mov_b32 v2, s84
s_lshl_b32 s60, s57, 4
s_add_u32 s60, s60, s59
s_lshl_b32 s60, s60, 7
s_add_u32 s60, s60, 2260992
s_mov_b64 exec, 1
buffer_store_dword v2, off, s[44:47], s60 sc1
s_mov_b64 exec, -1
v_lshlrev_b32_e64 v2, 7, v1
v_mov_b32 v3, 0x7f000000
v_cmp_gt_u32 vcc, 16, v1
s_nop 1
v_cndmask_b32 v2, v3, v2, vcc
s_lshl_b32 s61, s92, 11
s_add_u32 s61, s61, 2260992
L_k2_poll:
buffer_load_dword v3, v2, s[44:47], s61 offen sc1
s_waitcnt vmcnt(0)
v_cmp_eq_u32 vcc, s84, v3
s_and_b32 s60, vcc_lo, 0xffff
s_cmp_eq_u32 s60, 0xffff
s_cbranch_scc1 L_k2_go
s_sub_u32 s7, s7, 1
s_cbranch_scc1 L_k2_go
s_sleep 1
s_branch L_k2_poll
L_k2_go:
v_lshlrev_b32 v2, 4, v1
v_add_u32 v3, 4096, v2
v_and_b32 v4, 15, v1
v_lshrrev_b32 v5, 4, v1
v_mul_u32_u24 v4, 1280, v4
v_mul_u32_u24 v5, 40, v5
v_add_u32 v4, v4, v5
buffer_load_dwordx4 v[6:9], v4, s[24:27], s91 offen
buffer_load_dwordx4 v[10:13], v4, s[24:27], s91 offen offset:16
buffer_load_dwordx2 v[14:15], v4, s[24:27], s91 offen offset:32
v_add_u32 v240, s94, v2
s_barrier
buffer_load_dwordx4 v[116:119], v2, s[44:47], s89 offen offset:0 sc1
buffer_load_dwordx4 v[120:123], v2, s[44:47], s89 offen offset:1024 sc1
buffer_load_dwordx4 v[124:127], v2, s[44:47], s89 offen offset:2048 sc1
buffer_load_dwordx4 v[128:131], v2, s[44:47], s89 offen offset:3072 sc1
s_add_u32 s89, s89, 4096
buffer_load_dwordx4 v[152:155], v2, s[44:47], s89 offen offset:0 sc1
buffer_load_dwordx4 v[156:159], v2, s[44:47], s89 offen offset:1024 sc1
buffer_load_dwordx4 v[160:163], v2, s[44:47], s89 offen offset:2048 sc1
buffer_load_dwordx4 v[164:167], v2, s[44:47], s89 offen offset:3072 sc1
s_add_u32 s89, s89, 4096
buffer_load_dwordx4 v[188:191], v2, s[44:47], s89 offen offset:0 sc1
buffer_load_dwordx4 v[192:195], v2, s[44:47], s89 offen offset:1024 sc1
buffer_load_dwordx4 v[196:199], v2, s[44:47], s89 offen offset:2048 sc1
buffer_load_dwordx4 v[200:203], v2, s[44:47], s89 offen offset:3072 sc1
s_add_u32 s89, s89, 4096
buffer_load_dwordx4 v[224:227], v2, s[44:47], s89 offen offset:0 sc1
buffer_load_dwordx4 v[228:231], v2, s[44:47], s89 offen offset:1024 sc1
buffer_load_dwordx4 v[232:235], v2, s[44:47], s89 offen offset:2048 sc1
buffer_load_dwordx4 v[236:239], v2, s[44:47], s89 offen offset:3072 sc1
s_add_u32 s89, s89, 4096
s_waitcnt vmcnt(12)
v_mfma_f32_16x16x32_bf16 v[16:19], a[0:3], v[116:119], 0
v_mfma_f32_16x16x32_bf16 v[20:23], a[4:7], v[116:119], 0
v_mfma_f32_16x16x32_bf16 v[24:27], a[8:11], v[116:119], 0
v_mfma_f32_16x16x32_bf16 v[28:31], a[12:15], v[116:119], 0
v_mfma_f32_16x16x32_bf16 v[32:35], a[16:19], v[116:119], 0
v_mfma_f32_16x16x32_bf16 v[36:39], a[0:3], v[120:123], 0
v_mfma_f32_16x16x32_bf16 v[40:43], a[4:7], v[120:123], 0
v_mfma_f32_16x16x32_bf16 v[44:47], a[8:11], v[120:123], 0
v_mfma_f32_16x16x32_bf16 v[48:51], a[12:15], v[120:123], 0
v_mfma_f32_16x16x32_bf16 v[52:55], a[16:19], v[120:123], 0
v_mfma_f32_16x16x32_bf16 v[56:59], a[0:3], v[124:127], 0
v_mfma_f32_16x16x32_bf16 v[60:63], a[4:7], v[124:127], 0
v_mfma_f32_16x16x32_bf16 v[64:67], a[8:11], v[124:127], 0
v_mfma_f32_16x16x32_bf16 v[68:71], a[12:15], v[124:127], 0
v_mfma_f32_16x16x32_bf16 v[72:75], a[16:19], v[124:127], 0
v_mfma_f32_16x16x32_bf16 v[76:79], a[0:3], v[128:131], 0
v_mfma_f32_16x16x32_bf16 v[80:83], a[4:7], v[128:131], 0
v_mfma_f32_16x16x32_bf16 v[84:87], a[8:11], v[128:131], 0
v_mfma_f32_16x16x32_bf16 v[88:91], a[12:15], v[128:131], 0
v_mfma_f32_16x16x32_bf16 v[92:95], a[16:19], v[128:131], 0
buffer_load_dwordx4 v[116:119], v2, s[44:47], s89 offen offset:0 sc1
buffer_load_dwordx4 v[120:123], v2, s[44:47], s89 offen offset:1024 sc1
buffer_load_dwordx4 v[124:127], v2, s[44:47], s89 offen offset:2048 sc1
buffer_load_dwordx4 v[128:131], v2, s[44:47], s89 offen offset:3072 sc1
s_add_u32 s89, s89, 4096
s_waitcnt vmcnt(12)
v_mfma_f32_16x16x32_bf16 v[16:19], a[20:23], v[152:155], v[16:19]
v_mfma_f32_16x16x32_bf16 v[20:23], a[24:27], v[152:155], v[20:23]
v_mfma_f32_16x16x32_bf16 v[24:27], a[28:31], v[152:155], v[24:27]
v_mfma_f32_16x16x32_bf16 v[28:31], a[32:35], v[152:155], v[28:31]
v_mfma_f32_16x16x32_bf16 v[32:35], a[36:39], v[152:155], v[32:35]
v_mfma_f32_16x16x32_bf16 v[36:39], a[20:23], v[156:159], v[36:39]
v_mfma_f32_16x16x32_bf16 v[40:43], a[24:27], v[156:159], v[40:43]
v_mfma_f32_16x16x32_bf16 v[44:47], a[28:31], v[156:159], v[44:47]
v_mfma_f32_16x16x32_bf16 v[48:51], a[32:35], v[156:159], v[48:51]
v_mfma_f32_16x16x32_bf16 v[52:55], a[36:39], v[156:159], v[52:55]
v_mfma_f32_16x16x32_bf16 v[56:59], a[20:23], v[160:163], v[56:59]
v_mfma_f32_16x16x32_bf16 v[60:63], a[24:27], v[160:163], v[60:63]
v_mfma_f32_16x16x32_bf16 v[64:67], a[28:31], v[160:163], v[64:67]
v_mfma_f32_16x16x32_bf16 v[68:71], a[32:35], v[160:163], v[68:71]
v_mfma_f32_16x16x32_bf16 v[72:75], a[36:39], v[160:163], v[72:75]
v_mfma_f32_16x16x32_bf16 v[76:79], a[20:23], v[164:167], v[76:79]
v_mfma_f32_16x16x32_bf16 v[80:83], a[24:27], v[164:167], v[80:83]
v_mfma_f32_16x16x32_bf16 v[84:87], a[28:31], v[164:167], v[84:87]
v_mfma_f32_16x16x32_bf16 v[88:91], a[32:35], v[164:167], v[88:91]
v_mfma_f32_16x16x32_bf16 v[92:95], a[36:39], v[164:167], v[92:95]
buffer_load_dwordx4 v[152:155], v2, s[44:47], s89 offen offset:0 sc1
buffer_load_dwordx4 v[156:159], v2, s[44:47], s89 offen offset:1024 sc1
buffer_load_dwordx4 v[160:163], v2, s[44:47], s89 offen offset:2048 sc1
buffer_load_dwordx4 v[164:167], v2, s[44:47], s89 offen offset:3072 sc1
s_add_u32 s89, s89, 4096
s_waitcnt vmcnt(12)
v_mfma_f32_16x16x32_bf16 v[16:19], a[40:43], v[188:191], v[16:19]
v_mfma_f32_16x16x32_bf16 v[20:23], a[44:47], v[188:191], v[20:23]
v_mfma_f32_16x16x32_bf16 v[24:27], a[48:51], v[188:191], v[24:27]
v_mfma_f32_16x16x32_bf16 v[28:31], a[52:55], v[188:191], v[28:31]
v_mfma_f32_16x16x32_bf16 v[32:35], a[56:59], v[188:191], v[32:35]
v_mfma_f32_16x16x32_bf16 v[36:39], a[40:43], v[192:195], v[36:39]
v_mfma_f32_16x16x32_bf16 v[40:43], a[44:47], v[192:195], v[40:43]
v_mfma_f32_16x16x32_bf16 v[44:47], a[48:51], v[192:195], v[44:47]
v_mfma_f32_16x16x32_bf16 v[48:51], a[52:55], v[192:195], v[48:51]
v_mfma_f32_16x16x32_bf16 v[52:55], a[56:59], v[192:195], v[52:55]
v_mfma_f32_16x16x32_bf16 v[56:59], a[40:43], v[196:199], v[56:59]
v_mfma_f32_16x16x32_bf16 v[60:63], a[44:47], v[196:199], v[60:63]
v_mfma_f32_16x16x32_bf16 v[64:67], a[48:51], v[196:199], v[64:67]
v_mfma_f32_16x16x32_bf16 v[68:71], a[52:55], v[196:199], v[68:71]
v_mfma_f32_16x16x32_bf16 v[72:75], a[56:59], v[196:199], v[72:75]
v_mfma_f32_16x16x32_bf16 v[76:79], a[40:43], v[200:203], v[76:79]
v_mfma_f32_16x16x32_bf16 v[80:83], a[44:47], v[200:203], v[80:83]
v_mfma_f32_16x16x32_bf16 v[84:87], a[48:51], v[200:203], v[84:87]
v_mfma_f32_16x16x32_bf16 v[88:91], a[52:55], v[200:203], v[88:91]
v_mfma_f32_16x16x32_bf16 v[92:95], a[56:59], v[200:203], v[92:95]
buffer_load_dwordx4 v[188:191], v2, s[44:47], s89 offen offset:0 sc1
buffer_load_dwordx4 v[192:195], v2, s[44:47], s89 offen offset:1024 sc1
buffer_load_dwordx4 v[196:199], v2, s[44:47], s89 offen offset:2048 sc1
buffer_load_dwordx4 v[200:203], v2, s[44:47], s89 offen offset:3072 sc1
s_add_u32 s89, s89, 4096
s_waitcnt vmcnt(12)
v_mfma_f32_16x16x32_bf16 v[16:19], a[60:63], v[224:227], v[16:19]
v_mfma_f32_16x16x32_bf16 v[20:23], a[64:67], v[224:227], v[20:23]
v_mfma_f32_16x16x32_bf16 v[24:27], a[68:71], v[224:227], v[24:27]
v_mfma_f32_16x16x32_bf16 v[28:31], a[72:75], v[224:227], v[28:31]
v_mfma_f32_16x16x32_bf16 v[32:35], a[76:79], v[224:227], v[32:35]
v_mfma_f32_16x16x32_bf16 v[36:39], a[60:63], v[228:231], v[36:39]
v_mfma_f32_16x16x32_bf16 v[40:43], a[64:67], v[228:231], v[40:43]
v_mfma_f32_16x16x32_bf16 v[44:47], a[68:71], v[228:231], v[44:47]
v_mfma_f32_16x16x32_bf16 v[48:51], a[72:75], v[228:231], v[48:51]
v_mfma_f32_16x16x32_bf16 v[52:55], a[76:79], v[228:231], v[52:55]
v_mfma_f32_16x16x32_bf16 v[56:59], a[60:63], v[232:235], v[56:59]
v_mfma_f32_16x16x32_bf16 v[60:63], a[64:67], v[232:235], v[60:63]
v_mfma_f32_16x16x32_bf16 v[64:67], a[68:71], v[232:235], v[64:67]
v_mfma_f32_16x16x32_bf16 v[68:71], a[72:75], v[232:235], v[68:71]
v_mfma_f32_16x16x32_bf16 v[72:75], a[76:79], v[232:235], v[72:75]
v_mfma_f32_16x16x32_bf16 v[76:79], a[60:63], v[236:239], v[76:79]
v_mfma_f32_16x16x32_bf16 v[80:83], a[64:67], v[236:239], v[80:83]
v_mfma_f32_16x16x32_bf16 v[84:87], a[68:71], v[236:239], v[84:87]
v_mfma_f32_16x16x32_bf16 v[88:91], a[72:75], v[236:239], v[88:91]
v_mfma_f32_16x16x32_bf16 v[92:95], a[76:79], v[236:239], v[92:95]
buffer_load_dwordx4 v[224:227], v2, s[44:47], s89 offen offset:0 sc1
buffer_load_dwordx4 v[228:231], v2, s[44:47], s89 offen offset:1024 sc1
buffer_load_dwordx4 v[232:235], v2, s[44:47], s89 offen offset:2048 sc1
buffer_load_dwordx4 v[236:239], v2, s[44:47], s89 offen offset:3072 sc1
s_add_u32 s89, s89, 4096
s_waitcnt vmcnt(12)
v_mfma_f32_16x16x32_bf16 v[16:19], a[80:83], v[116:119], v[16:19]
v_mfma_f32_16x16x32_bf16 v[20:23], a[84:87], v[116:119], v[20:23]
v_mfma_f32_16x16x32_bf16 v[24:27], a[88:91], v[116:119], v[24:27]
v_mfma_f32_16x16x32_bf16 v[28:31], a[92:95], v[116:119], v[28:31]
v_mfma_f32_16x16x32_bf16 v[32:35], a[96:99], v[116:119], v[32:35]
v_mfma_f32_16x16x32_bf16 v[36:39], a[80:83], v[120:123], v[36:39]
v_mfma_f32_16x16x32_bf16 v[40:43], a[84:87], v[120:123], v[40:43]
v_mfma_f32_16x16x32_bf16 v[44:47], a[88:91], v[120:123], v[44:47]
v_mfma_f32_16x16x32_bf16 v[48:51], a[92:95], v[120:123], v[48:51]
v_mfma_f32_16x16x32_bf16 v[52:55], a[96:99], v[120:123], v[52:55]
v_mfma_f32_16x16x32_bf16 v[56:59], a[80:83], v[124:127], v[56:59]
v_mfma_f32_16x16x32_bf16 v[60:63], a[84:87], v[124:127], v[60:63]
v_mfma_f32_16x16x32_bf16 v[64:67], a[88:91], v[124:127], v[64:67]
v_mfma_f32_16x16x32_bf16 v[68:71], a[92:95], v[124:127], v[68:71]
v_mfma_f32_16x16x32_bf16 v[72:75], a[96:99], v[124:127], v[72:75]
v_mfma_f32_16x16x32_bf16 v[76:79], a[80:83], v[128:131], v[76:79]
v_mfma_f32_16x16x32_bf16 v[80:83], a[84:87], v[128:131], v[80:83]
v_mfma_f32_16x16x32_bf16 v[84:87], a[88:91], v[128:131], v[84:87]
v_mfma_f32_16x16x32_bf16 v[88:91], a[92:95], v[128:131], v[88:91]
v_mfma_f32_16x16x32_bf16 v[92:95], a[96:99], v[128:131], v[92:95]
ds_read_b128 v[96:99], v240 offset:0
ds_read_b128 v[100:103], v240 offset:1024
ds_read_b128 v[104:107], v240 offset:2048
ds_read_b128 v[108:111], v240 offset:3072
ds_read_b128 v[112:115], v240 offset:4096
buffer_load_dwordx4 v[116:119], v2, s[44:47], s89 offen offset:0 sc1
buffer_load_dwordx4 v[120:123], v2, s[44:47], s89 offen offset:1024 sc1
buffer_load_dwordx4 v[124:127], v2, s[44:47], s89 offen offset:2048 sc1
buffer_load_dwordx4 v[128:131], v2, s[44:47], s89 offen offset:3072 sc1
s_add_u32 s89, s89, 4096
s_waitcnt vmcnt(12)
v_mfma_f32_16x16x32_bf16 v[16:19], a[100:103], v[152:155], v[16:19]
v_mfma_f32_16x16x32_bf16 v[20:23], a[104:107], v[152:155], v[20:23]
v_mfma_f32_16x16x32_bf16 v[24:27], a[108:111], v[152:155], v[24:27]
v_mfma_f32_16x16x32_bf16 v[28:31], a[112:115], v[152:155], v[28:31]
v_mfma_f32_16x16x32_bf16 v[32:35], a[116:119], v[152:155], v[32:35]
v_mfma_f32_16x16x32_bf16 v[36:39], a[100:103], v[156:159], v[36:39]
v_mfma_f32_16x16x32_bf16 v[40:43], a[104:107], v[156:159], v[40:43]
v_mfma_f32_16x16x32_bf16 v[44:47], a[108:111], v[156:159], v[44:47]
v_mfma_f32_16x16x32_bf16 v[48:51], a[112:115], v[156:159], v[48:51]
v_mfma_f32_16x16x32_bf16 v[52:55], a[116:119], v[156:159], v[52:55]
v_mfma_f32_16x16x32_bf16 v[56:59], a[100:103], v[160:163], v[56:59]
v_mfma_f32_16x16x32_bf16 v[60:63], a[104:107], v[160:163], v[60:63]
v_mfma_f32_16x16x32_bf16 v[64:67], a[108:111], v[160:163], v[64:67]
v_mfma_f32_16x16x32_bf16 v[68:71], a[112:115], v[160:163], v[68:71]
v_mfma_f32_16x16x32_bf16 v[72:75], a[116:119], v[160:163], v[72:75]
v_mfma_f32_16x16x32_bf16 v[76:79], a[100:103], v[164:167], v[76:79]
v_mfma_f32_16x16x32_bf16 v[80:83], a[104:107], v[164:167], v[80:83]
v_mfma_f32_16x16x32_bf16 v[84:87], a[108:111], v[164:167], v[84:87]
v_mfma_f32_16x16x32_bf16 v[88:91], a[112:115], v[164:167], v[88:91]
v_mfma_f32_16x16x32_bf16 v[92:95], a[116:119], v[164:167], v[92:95]
ds_read_b128 v[132:135], v240 offset:5120
ds_read_b128 v[136:139], v240 offset:6144
ds_read_b128 v[140:143], v240 offset:7168
ds_read_b128 v[144:147], v240 offset:8192
ds_read_b128 v[148:151], v240 offset:9216
buffer_load_dwordx4 v[152:155], v2, s[44:47], s89 offen offset:0 sc1
buffer_load_dwordx4 v[156:159], v2, s[44:47], s89 offen offset:1024 sc1
buffer_load_dwordx4 v[160:163], v2, s[44:47], s89 offen offset:2048 sc1
buffer_load_dwordx4 v[164:167], v2, s[44:47], s89 offen offset:3072 sc1
s_add_u32 s89, s89, 4096
s_waitcnt vmcnt(12)
v_mfma_f32_16x16x32_bf16 v[16:19], a[120:123], v[188:191], v[16:19]
v_mfma_f32_16x16x32_bf16 v[20:23], a[124:127], v[188:191], v[20:23]
v_mfma_f32_16x16x32_bf16 v[24:27], a[128:131], v[188:191], v[24:27]
v_mfma_f32_16x16x32_bf16 v[28:31], a[132:135], v[188:191], v[28:31]
v_mfma_f32_16x16x32_bf16 v[32:35], a[136:139], v[188:191], v[32:35]
v_mfma_f32_16x16x32_bf16 v[36:39], a[120:123], v[192:195], v[36:39]
v_mfma_f32_16x16x32_bf16 v[40:43], a[124:127], v[192:195], v[40:43]
v_mfma_f32_16x16x32_bf16 v[44:47], a[128:131], v[192:195], v[44:47]
v_mfma_f32_16x16x32_bf16 v[48:51], a[132:135], v[192:195], v[48:51]
v_mfma_f32_16x16x32_bf16 v[52:55], a[136:139], v[192:195], v[52:55]
v_mfma_f32_16x16x32_bf16 v[56:59], a[120:123], v[196:199], v[56:59]
v_mfma_f32_16x16x32_bf16 v[60:63], a[124:127], v[196:199], v[60:63]
v_mfma_f32_16x16x32_bf16 v[64:67], a[128:131], v[196:199], v[64:67]
v_mfma_f32_16x16x32_bf16 v[68:71], a[132:135], v[196:199], v[68:71]
v_mfma_f32_16x16x32_bf16 v[72:75], a[136:139], v[196:199], v[72:75]
v_mfma_f32_16x16x32_bf16 v[76:79], a[120:123], v[200:203], v[76:79]
v_mfma_f32_16x16x32_bf16 v[80:83], a[124:127], v[200:203], v[80:83]
v_mfma_f32_16x16x32_bf16 v[84:87], a[128:131], v[200:203], v[84:87]
v_mfma_f32_16x16x32_bf16 v[88:91], a[132:135], v[200:203], v[88:91]
v_mfma_f32_16x16x32_bf16 v[92:95], a[136:139], v[200:203], v[92:95]
ds_read_b128 v[168:171], v240 offset:10240
ds_read_b128 v[172:175], v240 offset:11264
ds_read_b128 v[176:179], v240 offset:12288
ds_read_b128 v[180:183], v240 offset:13312
ds_read_b128 v[184:187], v240 offset:14336
buffer_load_dwordx4 v[188:191], v2, s[44:47], s89 offen offset:0 sc1
buffer_load_dwordx4 v[192:195], v2, s[44:47], s89 offen offset:1024 sc1
buffer_load_dwordx4 v[196:199], v2, s[44:47], s89 offen offset:2048 sc1
buffer_load_dwordx4 v[200:203], v2, s[44:47], s89 offen offset:3072 sc1
s_add_u32 s89, s89, 4096
s_waitcnt vmcnt(12)
v_mfma_f32_16x16x32_bf16 v[16:19], a[140:143], v[224:227], v[16:19]
v_mfma_f32_16x16x32_bf16 v[20:23], a[144:147], v[224:227], v[20:23]
v_mfma_f32_16x16x32_bf16 v[24:27], a[148:151], v[224:227], v[24:27]
v_mfma_f32_16x16x32_bf16 v[28:31], a[152:155], v[224:227], v[28:31]
v_mfma_f32_16x16x32_bf16 v[32:35], a[156:159], v[224:227], v[32:35]
v_mfma_f32_16x16x32_bf16 v[36:39], a[140:143], v[228:231], v[36:39]
v_mfma_f32_16x16x32_bf16 v[40:43], a[144:147], v[228:231], v[40:43]
v_mfma_f32_16x16x32_bf16 v[44:47], a[148:151], v[228:231], v[44:47]
v_mfma_f32_16x16x32_bf16 v[48:51], a[152:155], v[228:231], v[48:51]
v_mfma_f32_16x16x32_bf16 v[52:55], a[156:159], v[228:231], v[52:55]
v_mfma_f32_16x16x32_bf16 v[56:59], a[140:143], v[232:235], v[56:59]
v_mfma_f32_16x16x32_bf16 v[60:63], a[144:147], v[232:235], v[60:63]
v_mfma_f32_16x16x32_bf16 v[64:67], a[148:151], v[232:235], v[64:67]
v_mfma_f32_16x16x32_bf16 v[68:71], a[152:155], v[232:235], v[68:71]
v_mfma_f32_16x16x32_bf16 v[72:75], a[156:159], v[232:235], v[72:75]
v_mfma_f32_16x16x32_bf16 v[76:79], a[140:143], v[236:239], v[76:79]
v_mfma_f32_16x16x32_bf16 v[80:83], a[144:147], v[236:239], v[80:83]
v_mfma_f32_16x16x32_bf16 v[84:87], a[148:151], v[236:239], v[84:87]
v_mfma_f32_16x16x32_bf16 v[88:91], a[152:155], v[236:239], v[88:91]
v_mfma_f32_16x16x32_bf16 v[92:95], a[156:159], v[236:239], v[92:95]
ds_read_b128 v[204:207], v240 offset:15360
ds_read_b128 v[208:211], v240 offset:16384
ds_read_b128 v[212:215], v240 offset:17408
ds_read_b128 v[216:219], v240 offset:18432
ds_read_b128 v[220:223], v240 offset:19456
buffer_load_dwordx4 v[224:227], v2, s[44:47], s89 offen offset:0 sc1
buffer_load_dwordx4 v[228:231], v2, s[44:47], s89 offen offset:1024 sc1
buffer_load_dwordx4 v[232:235], v2, s[44:47], s89 offen offset:2048 sc1
buffer_load_dwordx4 v[236:239], v2, s[44:47], s89 offen offset:3072 sc1
s_add_u32 s89, s89, 4096
s_waitcnt vmcnt(12)
s_waitcnt lgkmcnt(15)
v_mfma_f32_16x16x32_bf16 v[16:19], v[96:99], v[116:119], v[16:19]
v_mfma_f32_16x16x32_bf16 v[20:23], v[100:103], v[116:119], v[20:23]
v_mfma_f32_16x16x32_bf16 v[24:27], v[104:107], v[116:119], v[24:27]
v_mfma_f32_16x16x32_bf16 v[28:31], v[108:111], v[116:119], v[28:31]
v_mfma_f32_16x16x32_bf16 v[32:35], v[112:115], v[116:119], v[32:35]
v_mfma_f32_16x16x32_bf16 v[36:39], v[96:99], v[120:123], v[36:39]
v_mfma_f32_16x16x32_bf16 v[40:43], v[100:103], v[120:123], v[40:43]
v_mfma_f32_16x16x32_bf16 v[44:47], v[104:107], v[120:123], v[44:47]
v_mfma_f32_16x16x32_bf16 v[48:51], v[108:111], v[120:123], v[48:51]
v_mfma_f32_16x16x32_bf16 v[52:55], v[112:115], v[120:123], v[52:55]
v_mfma_f32_16x16x32_bf16 v[56:59], v[96:99], v[124:127], v[56:59]
v_mfma_f32_16x16x32_bf16 v[60:63], v[100:103], v[124:127], v[60:63]
v_mfma_f32_16x16x32_bf16 v[64:67], v[104:107], v[124:127], v[64:67]
v_mfma_f32_16x16x32_bf16 v[68:71], v[108:111], v[124:127], v[68:71]
v_mfma_f32_16x16x32_bf16 v[72:75], v[112:115], v[124:127], v[72:75]
v_mfma_f32_16x16x32_bf16 v[76:79], v[96:99], v[128:131], v[76:79]
v_mfma_f32_16x16x32_bf16 v[80:83], v[100:103], v[128:131], v[80:83]
v_mfma_f32_16x16x32_bf16 v[84:87], v[104:107], v[128:131], v[84:87]
v_mfma_f32_16x16x32_bf16 v[88:91], v[108:111], v[128:131], v[88:91]
v_mfma_f32_16x16x32_bf16 v[92:95], v[112:115], v[128:131], v[92:95]
ds_read_b128 v[96:99], v240 offset:20480
ds_read_b128 v[100:103], v240 offset:21504
ds_read_b128 v[104:107], v240 offset:22528
ds_read_b128 v[108:111], v240 offset:23552
ds_read_b128 v[112:115], v240 offset:24576
buffer_load_dwordx4 v[116:119], v2, s[44:47], s89 offen offset:0 sc1
buffer_load_dwordx4 v[120:123], v2, s[44:47], s89 offen offset:1024 sc1
buffer_load_dwordx4 v[124:127], v2, s[44:47], s89 offen offset:2048 sc1
buffer_load_dwordx4 v[128:131], v2, s[44:47], s89 offen offset:3072 sc1
s_add_u32 s89, s89, 4096
s_waitcnt vmcnt(12)
s_waitcnt lgkmcnt(15)
v_mfma_f32_16x16x32_bf16 v[16:19], v[132:135], v[152:155], v[16:19]
v_mfma_f32_16x16x32_bf16 v[20:23], v[136:139], v[152:155], v[20:23]
v_mfma_f32_16x16x32_bf16 v[24:27], v[140:143], v[152:155], v[24:27]
v_mfma_f32_16x16x32_bf16 v[28:31], v[144:147], v[152:155], v[28:31]
v_mfma_f32_16x16x32_bf16 v[32:35], v[148:151], v[152:155], v[32:35]
v_mfma_f32_16x16x32_bf16 v[36:39], v[132:135], v[156:159], v[36:39]
v_mfma_f32_16x16x32_bf16 v[40:43], v[136:139], v[156:159], v[40:43]
v_mfma_f32_16x16x32_bf16 v[44:47], v[140:143], v[156:159], v[44:47]
v_mfma_f32_16x16x32_bf16 v[48:51], v[144:147], v[156:159], v[48:51]
v_mfma_f32_16x16x32_bf16 v[52:55], v[148:151], v[156:159], v[52:55]
v_mfma_f32_16x16x32_bf16 v[56:59], v[132:135], v[160:163], v[56:59]
v_mfma_f32_16x16x32_bf16 v[60:63], v[136:139], v[160:163], v[60:63]
v_mfma_f32_16x16x32_bf16 v[64:67], v[140:143], v[160:163], v[64:67]
v_mfma_f32_16x16x32_bf16 v[68:71], v[144:147], v[160:163], v[68:71]
v_mfma_f32_16x16x32_bf16 v[72:75], v[148:151], v[160:163], v[72:75]
v_mfma_f32_16x16x32_bf16 v[76:79], v[132:135], v[164:167], v[76:79]
v_mfma_f32_16x16x32_bf16 v[80:83], v[136:139], v[164:167], v[80:83]
v_mfma_f32_16x16x32_bf16 v[84:87], v[140:143], v[164:167], v[84:87]
v_mfma_f32_16x16x32_bf16 v[88:91], v[144:147], v[164:167], v[88:91]
v_mfma_f32_16x16x32_bf16 v[92:95], v[148:151], v[164:167], v[92:95]
ds_read_b128 v[132:135], v240 offset:25600
ds_read_b128 v[136:139], v240 offset:26624
ds_read_b128 v[140:143], v240 offset:27648
ds_read_b128 v[144:147], v240 offset:28672
ds_read_b128 v[148:151], v240 offset:29696
buffer_load_dwordx4 v[152:155], v2, s[44:47], s89 offen offset:0 sc1
buffer_load_dwordx4 v[156:159], v2, s[44:47], s89 offen offset:1024 sc1
buffer_load_dwordx4 v[160:163], v2, s[44:47], s89 offen offset:2048 sc1
buffer_load_dwordx4 v[164:167], v2, s[44:47], s89 offen offset:3072 sc1
s_add_u32 s89, s89, 4096
s_waitcnt vmcnt(12)
s_waitcnt lgkmcnt(15)
v_mfma_f32_16x16x32_bf16 v[16:19], v[168:171], v[188:191], v[16:19]
v_mfma_f32_16x16x32_bf16 v[20:23], v[172:175], v[188:191], v[20:23]
v_mfma_f32_16x16x32_bf16 v[24:27], v[176:179], v[188:191], v[24:27]
v_mfma_f32_16x16x32_bf16 v[28:31], v[180:183], v[188:191], v[28:31]
v_mfma_f32_16x16x32_bf16 v[32:35], v[184:187], v[188:191], v[32:35]
v_mfma_f32_16x16x32_bf16 v[36:39], v[168:171], v[192:195], v[36:39]
v_mfma_f32_16x16x32_bf16 v[40:43], v[172:175], v[192:195], v[40:43]
v_mfma_f32_16x16x32_bf16 v[44:47], v[176:179], v[192:195], v[44:47]
v_mfma_f32_16x16x32_bf16 v[48:51], v[180:183], v[192:195], v[48:51]
v_mfma_f32_16x16x32_bf16 v[52:55], v[184:187], v[192:195], v[52:55]
v_mfma_f32_16x16x32_bf16 v[56:59], v[168:171], v[196:199], v[56:59]
v_mfma_f32_16x16x32_bf16 v[60:63], v[172:175], v[196:199], v[60:63]
v_mfma_f32_16x16x32_bf16 v[64:67], v[176:179], v[196:199], v[64:67]
v_mfma_f32_16x16x32_bf16 v[68:71], v[180:183], v[196:199], v[68:71]
v_mfma_f32_16x16x32_bf16 v[72:75], v[184:187], v[196:199], v[72:75]
v_mfma_f32_16x16x32_bf16 v[76:79], v[168:171], v[200:203], v[76:79]
v_mfma_f32_16x16x32_bf16 v[80:83], v[172:175], v[200:203], v[80:83]
v_mfma_f32_16x16x32_bf16 v[84:87], v[176:179], v[200:203], v[84:87]
v_mfma_f32_16x16x32_bf16 v[88:91], v[180:183], v[200:203], v[88:91]
v_mfma_f32_16x16x32_bf16 v[92:95], v[184:187], v[200:203], v[92:95]
buffer_load_dwordx4 v[168:171], v2, s[44:47], s90 offen offset:0 sc1
buffer_load_dwordx4 v[172:175], v2, s[44:47], s90 offen offset:1024 sc1
buffer_load_dwordx4 v[176:179], v2, s[44:47], s90 offen offset:2048 sc1
buffer_load_dwordx4 v[180:183], v2, s[44:47], s90 offen offset:3072 sc1
buffer_load_dwordx4 v[184:187], v3, s[44:47], s90 offen sc1
s_add_u32 s90, s90, 5120
buffer_load_dwordx4 v[188:191], v2, s[44:47], s89 offen offset:0 sc1
buffer_load_dwordx4 v[192:195], v2, s[44:47], s89 offen offset:1024 sc1
buffer_load_dwordx4 v[196:199], v2, s[44:47], s89 offen offset:2048 sc1
buffer_load_dwordx4 v[200:203], v2, s[44:47], s89 offen offset:3072 sc1
s_add_u32 s89, s89, 4096
s_waitcnt vmcnt(17)
s_waitcnt lgkmcnt(10)
v_mfma_f32_16x16x32_bf16 v[16:19], v[204:207], v[224:227], v[16:19]
v_mfma_f32_16x16x32_bf16 v[20:23], v[208:211], v[224:227], v[20:23]
v_mfma_f32_16x16x32_bf16 v[24:27], v[212:215], v[224:227], v[24:27]
v_mfma_f32_16x16x32_bf16 v[28:31], v[216:219], v[224:227], v[28:31]
v_mfma_f32_16x16x32_bf16 v[32:35], v[220:223], v[224:227], v[32:35]
v_mfma_f32_16x16x32_bf16 v[36:39], v[204:207], v[228:231], v[36:39]
v_mfma_f32_16x16x32_bf16 v[40:43], v[208:211], v[228:231], v[40:43]
v_mfma_f32_16x16x32_bf16 v[44:47], v[212:215], v[228:231], v[44:47]
v_mfma_f32_16x16x32_bf16 v[48:51], v[216:219], v[228:231], v[48:51]
v_mfma_f32_16x16x32_bf16 v[52:55], v[220:223], v[228:231], v[52:55]
v_mfma_f32_16x16x32_bf16 v[56:59], v[204:207], v[232:235], v[56:59]
v_mfma_f32_16x16x32_bf16 v[60:63], v[208:211], v[232:235], v[60:63]
v_mfma_f32_16x16x32_bf16 v[64:67], v[212:215], v[232:235], v[64:67]
v_mfma_f32_16x16x32_bf16 v[68:71], v[216:219], v[232:235], v[68:71]
v_mfma_f32_16x16x32_bf16 v[72:75], v[220:223], v[232:235], v[72:75]
v_mfma_f32_16x16x32_bf16 v[76:79], v[204:207], v[236:239], v[76:79]
v_mfma_f32_16x16x32_bf16 v[80:83], v[208:211], v[236:239], v[80:83]
v_mfma_f32_16x16x32_bf16 v[84:87], v[212:215], v[236:239], v[84:87]
v_mfma_f32_16x16x32_bf16 v[88:91], v[216:219], v[236:239], v[88:91]
v_mfma_f32_16x16x32_bf16 v[92:95], v[220:223], v[236:239], v[92:95]
buffer_load_dwordx4 v[204:207], v2, s[44:47], s90 offen offset:0 sc1
buffer_load_dwordx4 v[208:211], v2, s[44:47], s90 offen offset:1024 sc1
buffer_load_dwordx4 v[212:215], v2, s[44:47], s90 offen offset:2048 sc1
buffer_load_dwordx4 v[216:219], v2, s[44:47], s90 offen offset:3072 sc1
buffer_load_dwordx4 v[220:223], v3, s[44:47], s90 offen sc1
s_add_u32 s90, s90, 5120
buffer_load_dwordx4 v[224:227], v2, s[44:47], s89 offen offset:0 sc1
buffer_load_dwordx4 v[228:231], v2, s[44:47], s89 offen offset:1024 sc1
buffer_load_dwordx4 v[232:235], v2, s[44:47], s89 offen offset:2048 sc1
buffer_load_dwordx4 v[236:239], v2, s[44:47], s89 offen offset:3072 sc1
s_add_u32 s89, s89, 4096
s_waitcnt vmcnt(22)
s_waitcnt lgkmcnt(5)
v_mfma_f32_16x16x32_bf16 v[16:19], v[96:99], v[116:119], v[16:19]
v_mfma_f32_16x16x32_bf16 v[20:23], v[100:103], v[116:119], v[20:23]
v_mfma_f32_16x16x32_bf16 v[24:27], v[104:107], v[116:119], v[24:27]
v_mfma_f32_16x16x32_bf16 v[28:31], v[108:111], v[116:119], v[28:31]
v_mfma_f32_16x16x32_bf16 v[32:35], v[112:115], v[116:119], v[32:35]
v_mfma_f32_16x16x32_bf16 v[36:39], v[96:99], v[120:123], v[36:39]
v_mfma_f32_16x16x32_bf16 v[40:43], v[100:103], v[120:123], v[40:43]
v_mfma_f32_16x16x32_bf16 v[44:47], v[104:107], v[120:123], v[44:47]
v_mfma_f32_16x16x32_bf16 v[48:51], v[108:111], v[120:123], v[48:51]
v_mfma_f32_16x16x32_bf16 v[52:55], v[112:115], v[120:123], v[52:55]
v_mfma_f32_16x16x32_bf16 v[56:59], v[96:99], v[124:127], v[56:59]
v_mfma_f32_16x16x32_bf16 v[60:63], v[100:103], v[124:127], v[60:63]
v_mfma_f32_16x16x32_bf16 v[64:67], v[104:107], v[124:127], v[64:67]
v_mfma_f32_16x16x32_bf16 v[68:71], v[108:111], v[124:127], v[68:71]
v_mfma_f32_16x16x32_bf16 v[72:75], v[112:115], v[124:127], v[72:75]
v_mfma_f32_16x16x32_bf16 v[76:79], v[96:99], v[128:131], v[76:79]
v_mfma_f32_16x16x32_bf16 v[80:83], v[100:103], v[128:131], v[80:83]
v_mfma_f32_16x16x32_bf16 v[84:87], v[104:107], v[128:131], v[84:87]
v_mfma_f32_16x16x32_bf16 v[88:91], v[108:111], v[128:131], v[88:91]
v_mfma_f32_16x16x32_bf16 v[92:95], v[112:115], v[128:131], v[92:95]
buffer_load_dwordx4 v[96:99], v2, s[44:47], s90 offen offset:0 sc1
buffer_load_dwordx4 v[100:103], v2, s[44:47], s90 offen offset:1024 sc1
buffer_load_dwordx4 v[104:107], v2, s[44:47], s90 offen offset:2048 sc1
buffer_load_dwordx4 v[108:111], v2, s[44:47], s90 offen offset:3072 sc1
buffer_load_dwordx4 v[112:115], v3, s[44:47], s90 offen sc1
s_add_u32 s90, s90, 5120
buffer_load_dwordx4 v[116:119], v2, s[44:47], s89 offen offset:0 sc1
buffer_load_dwordx4 v[120:123], v2, s[44:47], s89 offen offset:1024 sc1
buffer_load_dwordx4 v[124:127], v2, s[44:47], s89 offen offset:2048 sc1
buffer_load_dwordx4 v[128:131], v2, s[44:47], s89 offen offset:3072 sc1
s_add_u32 s89, s89, 4096
s_waitcnt vmcnt(27)
s_waitcnt lgkmcnt(0)
v_mfma_f32_16x16x32_bf16 v[16:19], v[132:135], v[152:155], v[16:19]
v_mfma_f32_16x16x32_bf16 v[20:23], v[136:139], v[152:155], v[20:23]
v_mfma_f32_16x16x32_bf16 v[24:27], v[140:143], v[152:155], v[24:27]
v_mfma_f32_16x16x32_bf16 v[28:31], v[144:147], v[152:155], v[28:31]
v_mfma_f32_16x16x32_bf16 v[32:35], v[148:151], v[152:155], v[32:35]
v_mfma_f32_16x16x32_bf16 v[36:39], v[132:135], v[156:159], v[36:39]
v_mfma_f32_16x16x32_bf16 v[40:43], v[136:139], v[156:159], v[40:43]
v_mfma_f32_16x16x32_bf16 v[44:47], v[140:143], v[156:159], v[44:47]
v_mfma_f32_16x16x32_bf16 v[48:51], v[144:147], v[156:159], v[48:51]
v_mfma_f32_16x16x32_bf16 v[52:55], v[148:151], v[156:159], v[52:55]
v_mfma_f32_16x16x32_bf16 v[56:59], v[132:135], v[160:163], v[56:59]
v_mfma_f32_16x16x32_bf16 v[60:63], v[136:139], v[160:163], v[60:63]
v_mfma_f32_16x16x32_bf16 v[64:67], v[140:143], v[160:163], v[64:67]
v_mfma_f32_16x16x32_bf16 v[68:71], v[144:147], v[160:163], v[68:71]
v_mfma_f32_16x16x32_bf16 v[72:75], v[148:151], v[160:163], v[72:75]
v_mfma_f32_16x16x32_bf16 v[76:79], v[132:135], v[164:167], v[76:79]
v_mfma_f32_16x16x32_bf16 v[80:83], v[136:139], v[164:167], v[80:83]
v_mfma_f32_16x16x32_bf16 v[84:87], v[140:143], v[164:167], v[84:87]
v_mfma_f32_16x16x32_bf16 v[88:91], v[144:147], v[164:167], v[88:91]
v_mfma_f32_16x16x32_bf16 v[92:95], v[148:151], v[164:167], v[92:95]
buffer_load_dwordx4 v[132:135], v2, s[44:47], s90 offen offset:0 sc1
buffer_load_dwordx4 v[136:139], v2, s[44:47], s90 offen offset:1024 sc1
buffer_load_dwordx4 v[140:143], v2, s[44:47], s90 offen offset:2048 sc1
buffer_load_dwordx4 v[144:147], v2, s[44:47], s90 offen offset:3072 sc1
buffer_load_dwordx4 v[148:151], v3, s[44:47], s90 offen sc1
s_add_u32 s90, s90, 5120
buffer_load_dwordx4 v[152:155], v2, s[44:47], s89 offen offset:0 sc1
buffer_load_dwordx4 v[156:159], v2, s[44:47], s89 offen offset:1024 sc1
buffer_load_dwordx4 v[160:163], v2, s[44:47], s89 offen offset:2048 sc1
buffer_load_dwordx4 v[164:167], v2, s[44:47], s89 offen offset:3072 sc1
s_add_u32 s89, s89, 4096
s_waitcnt vmcnt(27)
v_mfma_f32_16x16x32_bf16 v[16:19], v[168:171], v[188:191], v[16:19]
v_mfma_f32_16x16x32_bf16 v[20:23], v[172:175], v[188:191], v[20:23]
v_mfma_f32_16x16x32_bf16 v[24:27], v[176:179], v[188:191], v[24:27]
v_mfma_f32_16x16x32_bf16 v[28:31], v[180:183], v[188:191], v[28:31]
v_mfma_f32_16x16x32_bf16 v[32:35], v[184:187], v[188:191], v[32:35]
v_mfma_f32_16x16x32_bf16 v[36:39], v[168:171], v[192:195], v[36:39]
v_mfma_f32_16x16x32_bf16 v[40:43], v[172:175], v[192:195], v[40:43]
v_mfma_f32_16x16x32_bf16 v[44:47], v[176:179], v[192:195], v[44:47]
v_mfma_f32_16x16x32_bf16 v[48:51], v[180:183], v[192:195], v[48:51]
v_mfma_f32_16x16x32_bf16 v[52:55], v[184:187], v[192:195], v[52:55]
v_mfma_f32_16x16x32_bf16 v[56:59], v[168:171], v[196:199], v[56:59]
v_mfma_f32_16x16x32_bf16 v[60:63], v[172:175], v[196:199], v[60:63]
v_mfma_f32_16x16x32_bf16 v[64:67], v[176:179], v[196:199], v[64:67]
v_mfma_f32_16x16x32_bf16 v[68:71], v[180:183], v[196:199], v[68:71]
v_mfma_f32_16x16x32_bf16 v[72:75], v[184:187], v[196:199], v[72:75]
v_mfma_f32_16x16x32_bf16 v[76:79], v[168:171], v[200:203], v[76:79]
v_mfma_f32_16x16x32_bf16 v[80:83], v[172:175], v[200:203], v[80:83]
v_mfma_f32_16x16x32_bf16 v[84:87], v[176:179], v[200:203], v[84:87]
v_mfma_f32_16x16x32_bf16 v[88:91], v[180:183], v[200:203], v[88:91]
v_mfma_f32_16x16x32_bf16 v[92:95], v[184:187], v[200:203], v[92:95]
s_cmp_lg_u32 s56, 3
s_cbranch_scc1 L2_ls18
buffer_load_dwordx4 v[168:171], v2, s[44:47], s90 offen offset:0 sc1
buffer_load_dwordx4 v[172:175], v2, s[44:47], s90 offen offset:1024 sc1
buffer_load_dwordx4 v[176:179], v2, s[44:47], s90 offen offset:2048 sc1
buffer_load_dwordx4 v[180:183], v2, s[44:47], s90 offen offset:3072 sc1
buffer_load_dwordx4 v[184:187], v3, s[44:47], s90 offen sc1
s_add_u32 s90, s90, 5120
buffer_load_dwordx4 v[188:191], v2, s[44:47], s89 offen offset:0 sc1
buffer_load_dwordx4 v[192:195], v2, s[44:47], s89 offen offset:1024 sc1
buffer_load_dwordx4 v[196:199], v2, s[44:47], s89 offen offset:2048 sc1
buffer_load_dwordx4 v[200:203], v2, s[44:47], s89 offen offset:3072 sc1
s_add_u32 s89, s89, 4096
L2_ls18:
s_waitcnt vmcnt(18)
v_mfma_f32_16x16x32_bf16 v[16:19], v[204:207], v[224:227], v[16:19]
v_mfma_f32_16x16x32_bf16 v[20:23], v[208:211], v[224:227], v[20:23]
v_mfma_f32_16x16x32_bf16 v[24:27], v[212:215], v[224:227], v[24:27]
v_mfma_f32_16x16x32_bf16 v[28:31], v[216:219], v[224:227], v[28:31]
v_mfma_f32_16x16x32_bf16 v[32:35], v[220:223], v[224:227], v[32:35]
v_mfma_f32_16x16x32_bf16 v[36:39], v[204:207], v[228:231], v[36:39]
v_mfma_f32_16x16x32_bf16 v[40:43], v[208:211], v[228:231], v[40:43]
v_mfma_f32_16x16x32_bf16 v[44:47], v[212:215], v[228:231], v[44:47]
v_mfma_f32_16x16x32_bf16 v[48:51], v[216:219], v[228:231], v[48:51]
v_mfma_f32_16x16x32_bf16 v[52:55], v[220:223], v[228:231], v[52:55]
v_mfma_f32_16x16x32_bf16 v[56:59], v[204:207], v[232:235], v[56:59]
v_mfma_f32_16x16x32_bf16 v[60:63], v[208:211], v[232:235], v[60:63]
v_mfma_f32_16x16x32_bf16 v[64:67], v[212:215], v[232:235], v[64:67]
v_mfma_f32_16x16x32_bf16 v[68:71], v[216:219], v[232:235], v[68:71]
v_mfma_f32_16x16x32_bf16 v[72:75], v[220:223], v[232:235], v[72:75]
v_mfma_f32_16x16x32_bf16 v[76:79], v[204:207], v[236:239], v[76:79]
v_mfma_f32_16x16x32_bf16 v[80:83], v[208:211], v[236:239], v[80:83]
v_mfma_f32_16x16x32_bf16 v[84:87], v[212:215], v[236:239], v[84:87]
v_mfma_f32_16x16x32_bf16 v[88:91], v[216:219], v[236:239], v[88:91]
v_mfma_f32_16x16x32_bf16 v[92:95], v[220:223], v[236:239], v[92:95]
s_cmp_lg_u32 s56, 3
s_cbranch_scc1 L2_ls19
buffer_load_dwordx4 v[204:207], v2, s[44:47], s90 offen offset:0 sc1
buffer_load_dwordx4 v[208:211], v2, s[44:47], s90 offen offset:1024 sc1
buffer_load_dwordx4 v[212:215], v2, s[44:47], s90 offen offset:2048 sc1
buffer_load_dwordx4 v[216:219], v2, s[44:47], s90 offen offset:3072 sc1
buffer_load_dwordx4 v[220:223], v3, s[44:47], s90 offen sc1
s_add_u32 s90, s90, 5120
buffer_load_dwordx4 v[224:227], v2, s[44:47], s89 offen offset:0 sc1
buffer_load_dwordx4 v[228:231], v2, s[44:47], s89 offen offset:1024 sc1
buffer_load_dwordx4 v[232:235], v2, s[44:47], s89 offen offset:2048 sc1
buffer_load_dwordx4 v[236:239], v2, s[44:47], s89 offen offset:3072 sc1
s_add_u32 s89, s89, 4096
L2_ls19:
s_waitcnt vmcnt(9)
v_mfma_f32_16x16x32_bf16 v[16:19], v[96:99], v[116:119], v[16:19]
v_mfma_f32_16x16x32_bf16 v[20:23], v[100:103], v[116:119], v[20:23]
v_mfma_f32_16x16x32_bf16 v[24:27], v[104:107], v[116:119], v[24:27]
v_mfma_f32_16x16x32_bf16 v[28:31], v[108:111], v[116:119], v[28:31]
v_mfma_f32_16x16x32_bf16 v[32:35], v[112:115], v[116:119], v[32:35]
v_mfma_f32_16x16x32_bf16 v[36:39], v[96:99], v[120:123], v[36:39]
v_mfma_f32_16x16x32_bf16 v[40:43], v[100:103], v[120:123], v[40:43]
v_mfma_f32_16x16x32_bf16 v[44:47], v[104:107], v[120:123], v[44:47]
v_mfma_f32_16x16x32_bf16 v[48:51], v[108:111], v[120:123], v[48:51]
v_mfma_f32_16x16x32_bf16 v[52:55], v[112:115], v[120:123], v[52:55]
v_mfma_f32_16x16x32_bf16 v[56:59], v[96:99], v[124:127], v[56:59]
v_mfma_f32_16x16x32_bf16 v[60:63], v[100:103], v[124:127], v[60:63]
v_mfma_f32_16x16x32_bf16 v[64:67], v[104:107], v[124:127], v[64:67]
v_mfma_f32_16x16x32_bf16 v[68:71], v[108:111], v[124:127], v[68:71]
v_mfma_f32_16x16x32_bf16 v[72:75], v[112:115], v[124:127], v[72:75]
v_mfma_f32_16x16x32_bf16 v[76:79], v[96:99], v[128:131], v[76:79]
v_mfma_f32_16x16x32_bf16 v[80:83], v[100:103], v[128:131], v[80:83]
v_mfma_f32_16x16x32_bf16 v[84:87], v[104:107], v[128:131], v[84:87]
v_mfma_f32_16x16x32_bf16 v[88:91], v[108:111], v[128:131], v[88:91]
v_mfma_f32_16x16x32_bf16 v[92:95], v[112:115], v[128:131], v[92:95]
s_waitcnt vmcnt(0)
v_mfma_f32_16x16x32_bf16 v[16:19], v[132:135], v[152:155], v[16:19]
v_mfma_f32_16x16x32_bf16 v[20:23], v[136:139], v[152:155], v[20:23]
v_mfma_f32_16x16x32_bf16 v[24:27], v[140:143], v[152:155], v[24:27]
v_mfma_f32_16x16x32_bf16 v[28:31], v[144:147], v[152:155], v[28:31]
v_mfma_f32_16x16x32_bf16 v[32:35], v[148:151], v[152:155], v[32:35]
v_mfma_f32_16x16x32_bf16 v[36:39], v[132:135], v[156:159], v[36:39]
v_mfma_f32_16x16x32_bf16 v[40:43], v[136:139], v[156:159], v[40:43]
v_mfma_f32_16x16x32_bf16 v[44:47], v[140:143], v[156:159], v[44:47]
v_mfma_f32_16x16x32_bf16 v[48:51], v[144:147], v[156:159], v[48:51]
v_mfma_f32_16x16x32_bf16 v[52:55], v[148:151], v[156:159], v[52:55]
v_mfma_f32_16x16x32_bf16 v[56:59], v[132:135], v[160:163], v[56:59]
v_mfma_f32_16x16x32_bf16 v[60:63], v[136:139], v[160:163], v[60:63]
v_mfma_f32_16x16x32_bf16 v[64:67], v[140:143], v[160:163], v[64:67]
v_mfma_f32_16x16x32_bf16 v[68:71], v[144:147], v[160:163], v[68:71]
v_mfma_f32_16x16x32_bf16 v[72:75], v[148:151], v[160:163], v[72:75]
v_mfma_f32_16x16x32_bf16 v[76:79], v[132:135], v[164:167], v[76:79]
v_mfma_f32_16x16x32_bf16 v[80:83], v[136:139], v[164:167], v[80:83]
v_mfma_f32_16x16x32_bf16 v[84:87], v[140:143], v[164:167], v[84:87]
v_mfma_f32_16x16x32_bf16 v[88:91], v[144:147], v[164:167], v[88:91]
v_mfma_f32_16x16x32_bf16 v[92:95], v[148:151], v[164:167], v[92:95]
s_cmp_lg_u32 s56, 3
s_cbranch_scc1 L2_skip
s_waitcnt vmcnt(0)
v_mfma_f32_16x16x32_bf16 v[16:19], v[168:171], v[188:191], v[16:19]
v_mfma_f32_16x16x32_bf16 v[20:23], v[172:175], v[188:191], v[20:23]
v_mfma_f32_16x16x32_bf16 v[24:27], v[176:179], v[188:191], v[24:27]
v_mfma_f32_16x16x32_bf16 v[28:31], v[180:183], v[188:191], v[28:31]
v_mfma_f32_16x16x32_bf16 v[32:35], v[184:187], v[188:191], v[32:35]
v_mfma_f32_16x16x32_bf16 v[36:39], v[168:171], v[192:195], v[36:39]
v_mfma_f32_16x16x32_bf16 v[40:43], v[172:175], v[192:195], v[40:43]
v_mfma_f32_16x16x32_bf16 v[44:47], v[176:179], v[192:195], v[44:47]
v_mfma_f32_16x16x32_bf16 v[48:51], v[180:183], v[192:195], v[48:51]
v_mfma_f32_16x16x32_bf16 v[52:55], v[184:187], v[192:195], v[52:55]
v_mfma_f32_16x16x32_bf16 v[56:59], v[168:171], v[196:199], v[56:59]
v_mfma_f32_16x16x32_bf16 v[60:63], v[172:175], v[196:199], v[60:63]
v_mfma_f32_16x16x32_bf16 v[64:67], v[176:179], v[196:199], v[64:67]
v_mfma_f32_16x16x32_bf16 v[68:71], v[180:183], v[196:199], v[68:71]
v_mfma_f32_16x16x32_bf16 v[72:75], v[184:187], v[196:199], v[72:75]
v_mfma_f32_16x16x32_bf16 v[76:79], v[168:171], v[200:203], v[76:79]
v_mfma_f32_16x16x32_bf16 v[80:83], v[172:175], v[200:203], v[80:83]
v_mfma_f32_16x16x32_bf16 v[84:87], v[176:179], v[200:203], v[84:87]
v_mfma_f32_16x16x32_bf16 v[88:91], v[180:183], v[200:203], v[88:91]
v_mfma_f32_16x16x32_bf16 v[92:95], v[184:187], v[200:203], v[92:95]
s_waitcnt vmcnt(0)
v_mfma_f32_16x16x32_bf16 v[16:19], v[204:207], v[224:227], v[16:19]
v_mfma_f32_16x16x32_bf16 v[20:23], v[208:211], v[224:227], v[20:23]
v_mfma_f32_16x16x32_bf16 v[24:27], v[212:215], v[224:227], v[24:27]
v_mfma_f32_16x16x32_bf16 v[28:31], v[216:219], v[224:227], v[28:31]
v_mfma_f32_16x16x32_bf16 v[32:35], v[220:223], v[224:227], v[32:35]
v_mfma_f32_16x16x32_bf16 v[36:39], v[204:207], v[228:231], v[36:39]
v_mfma_f32_16x16x32_bf16 v[40:43], v[208:211], v[228:231], v[40:43]
v_mfma_f32_16x16x32_bf16 v[44:47], v[212:215], v[228:231], v[44:47]
v_mfma_f32_16x16x32_bf16 v[48:51], v[216:219], v[228:231], v[48:51]
v_mfma_f32_16x16x32_bf16 v[52:55], v[220:223], v[228:231], v[52:55]
v_mfma_f32_16x16x32_bf16 v[56:59], v[204:207], v[232:235], v[56:59]
v_mfma_f32_16x16x32_bf16 v[60:63], v[208:211], v[232:235], v[60:63]
v_mfma_f32_16x16x32_bf16 v[64:67], v[212:215], v[232:235], v[64:67]
v_mfma_f32_16x16x32_bf16 v[68:71], v[216:219], v[232:235], v[68:71]
v_mfma_f32_16x16x32_bf16 v[72:75], v[220:223], v[232:235], v[72:75]
v_mfma_f32_16x16x32_bf16 v[76:79], v[204:207], v[236:239], v[76:79]
v_mfma_f32_16x16x32_bf16 v[80:83], v[208:211], v[236:239], v[80:83]
v_mfma_f32_16x16x32_bf16 v[84:87], v[212:215], v[236:239], v[84:87]
v_mfma_f32_16x16x32_bf16 v[88:91], v[216:219], v[236:239], v[88:91]
v_mfma_f32_16x16x32_bf16 v[92:95], v[220:223], v[236:239], v[92:95]
L2_skip:
s_nop 7
s_nop 7
s_barrier
s_mul_i32 s60, s56, 20480
v_add_u32 v5, s60, v2
ds_write_b128 v5, v[16:19] offset:0
ds_write_b128 v5, v[20:23] offset:1024
ds_write_b128 v5, v[24:27] offset:2048
ds_write_b128 v5, v[28:31] offset:3072
ds_write_b128 v5, v[32:35] offset:4096
ds_write_b128 v5, v[36:39] offset:5120
ds_write_b128 v5, v[40:43] offset:6144
ds_write_b128 v5, v[44:47] offset:7168
ds_write_b128 v5, v[48:51] offset:8192
ds_write_b128 v5, v[52:55] offset:9216
ds_write_b128 v5, v[56:59] offset:10240
ds_write_b128 v5, v[60:63] offset:11264
ds_write_b128 v5, v[64:67] offset:12288
ds_write_b128 v5, v[68:71] offset:13312
ds_write_b128 v5, v[72:75] offset:14336
ds_write_b128 v5, v[76:79] offset:15360
ds_write_b128 v5, v[80:83] offset:16384
ds_write_b128 v5, v[84:87] offset:17408
ds_write_b128 v5, v[88:91] offset:18432
ds_write_b128 v5, v[92:95] offset:19456
s_mul_i32 s60, s56, 5120
v_add_u32_e64 v5, s60, v2
v_add_u32 v3, 40960, v5
s_waitcnt lgkmcnt(0)
s_barrier
ds_read_b128 v[96:99], v5 offset:0
ds_read_b128 v[100:103], v5 offset:1024
ds_read_b128 v[104:107], v5 offset:2048
ds_read_b128 v[108:111], v5 offset:3072
ds_read_b128 v[112:115], v5 offset:4096
ds_read_b128 v[116:119], v5 offset:20480
ds_read_b128 v[120:123], v5 offset:21504
ds_read_b128 v[124:127], v5 offset:22528
ds_read_b128 v[128:131], v5 offset:23552
ds_read_b128 v[132:135], v5 offset:24576
ds_read_b128 v[136:139], v3 offset:0
ds_read_b128 v[140:143], v3 offset:1024
ds_read_b128 v[144:147], v3 offset:2048
ds_read_b128 v[148:151], v3 offset:3072
ds_read_b128 v[152:155], v3 offset:4096
s_waitcnt lgkmcnt(5)
ds_read_b128 v[156:159], v3 offset:20480
ds_read_b128 v[160:163], v3 offset:21504
ds_read_b128 v[164:167], v3 offset:22528
ds_read_b128 v[168:171], v3 offset:23552
ds_read_b128 v[172:175], v3 offset:24576
s_waitcnt lgkmcnt(5)
v_pk_add_f32 v[96:97], v[96:97], v[116:117]
v_pk_add_f32 v[98:99], v[98:99], v[118:119]
v_pk_add_f32 v[100:101], v[100:101], v[120:121]
v_pk_add_f32 v[102:103], v[102:103], v[122:123]
v_pk_add_f32 v[104:105], v[104:105], v[124:125]
v_pk_add_f32 v[106:107], v[106:107], v[126:127]
v_pk_add_f32 v[108:109], v[108:109], v[128:129]
v_pk_add_f32 v[110:111], v[110:111], v[130:131]
v_pk_add_f32 v[112:113], v[112:113], v[132:133]
v_pk_add_f32 v[114:115], v[114:115], v[134:135]
v_pk_add_f32 v[96:97], v[96:97], v[136:137]
v_pk_add_f32 v[98:99], v[98:99], v[138:139]
v_pk_add_f32 v[100:101], v[100:101], v[140:141]
v_pk_add_f32 v[102:103], v[102:103], v[142:143]
v_pk_add_f32 v[104:105], v[104:105], v[144:145]
v_pk_add_f32 v[106:107], v[106:107], v[146:147]
v_pk_add_f32 v[108:109], v[108:109], v[148:149]
v_pk_add_f32 v[110:111], v[110:111], v[150:151]
v_pk_add_f32 v[112:113], v[112:113], v[152:153]
v_pk_add_f32 v[114:115], v[114:115], v[154:155]
v_pk_mul_f32 v[40:41], v[96:97], s[68:69]
v_pk_mul_f32 v[42:43], v[98:99], s[68:69]
v_pk_mul_f32 v[44:45], v[100:101], s[68:69]
v_pk_mul_f32 v[46:47], v[102:103], s[68:69]
v_pk_mul_f32 v[48:49], v[104:105], s[68:69]
v_pk_mul_f32 v[50:51], v[106:107], s[68:69]
v_pk_mul_f32 v[52:53], v[108:109], s[68:69]
v_pk_mul_f32 v[54:55], v[110:111], s[68:69]
v_pk_mul_f32 v[56:57], v[112:113], s[68:69]
v_pk_mul_f32 v[58:59], v[114:115], s[68:69]
v_exp_f32 v40, v40
v_exp_f32 v41, v41
v_exp_f32 v42, v42
v_exp_f32 v43, v43
v_exp_f32 v44, v44
v_exp_f32 v45, v45
v_exp_f32 v46, v46
v_exp_f32 v47, v47
v_exp_f32 v48, v48
v_exp_f32 v49, v49
v_exp_f32 v50, v50
v_exp_f32 v51, v51
v_exp_f32 v52, v52
v_exp_f32 v53, v53
v_exp_f32 v54, v54
v_exp_f32 v55, v55
v_exp_f32 v56, v56
v_exp_f32 v57, v57
v_exp_f32 v58, v58
v_exp_f32 v59, v59
v_pk_add_f32 v[40:41], v[40:41], s[80:81]
v_pk_add_f32 v[42:43], v[42:43], s[80:81]
v_pk_add_f32 v[44:45], v[44:45], s[80:81]
v_pk_add_f32 v[46:47], v[46:47], s[80:81]
v_pk_add_f32 v[48:49], v[48:49], s[80:81]
v_pk_add_f32 v[50:51], v[50:51], s[80:81]
v_pk_add_f32 v[52:53], v[52:53], s[80:81]
v_pk_add_f32 v[54:55], v[54:55], s[80:81]
v_pk_add_f32 v[56:57], v[56:57], s[80:81]
v_pk_add_f32 v[58:59], v[58:59], s[80:81]
v_rcp_f32 v40, v40
v_rcp_f32 v41, v41
v_rcp_f32 v42, v42
v_rcp_f32 v43, v43
v_rcp_f32 v44, v44
v_rcp_f32 v45, v45
v_rcp_f32 v46, v46
v_rcp_f32 v47, v47
v_rcp_f32 v48, v48
v_rcp_f32 v49, v49
v_rcp_f32 v50, v50
v_rcp_f32 v51, v51
v_rcp_f32 v52, v52
v_rcp_f32 v53, v53
v_rcp_f32 v54, v54
v_rcp_f32 v55, v55
v_rcp_f32 v56, v56
v_rcp_f32 v57, v57
v_rcp_f32 v58, v58
v_rcp_f32 v59, v59
v_pk_mul_f32 v[40:41], v[40:41], v[96:97]
v_pk_mul_f32 v[42:43], v[42:43], v[98:99]
v_pk_mul_f32 v[44:45], v[44:45], v[100:101]
v_pk_mul_f32 v[46:47], v[46:47], v[102:103]
v_pk_mul_f32 v[48:49], v[48:49], v[104:105]
v_pk_mul_f32 v[50:51], v[50:51], v[106:107]
v_pk_mul_f32 v[52:53], v[52:53], v[108:109]
v_pk_mul_f32 v[54:55], v[54:55], v[110:111]
v_pk_mul_f32 v[56:57], v[56:57], v[112:113]
v_pk_mul_f32 v[58:59], v[58:59], v[114:115]
s_waitcnt lgkmcnt(0)
v_lshlrev_b32 v64, 16, v6
v_and_b32 v65, s64, v6
v_lshlrev_b32 v66, 16, v7
v_and_b32 v67, s64, v7
v_lshlrev_b32 v68, 16, v8
v_and_b32 v69, s64, v8
v_lshlrev_b32 v70, 16, v9
v_and_b32 v71, s64, v9
v_lshlrev_b32 v72, 16, v10
v_and_b32 v73, s64, v10
v_lshlrev_b32 v74, 16, v11
v_and_b32 v75, s64, v11
v_lshlrev_b32 v76, 16, v12
v_and_b32 v77, s64, v12
v_lshlrev_b32 v78, 16, v13
v_and_b32 v79, s64, v13
v_lshlrev_b32 v80, 16, v14
v_and_b32 v81, s64, v14
v_lshlrev_b32 v82, 16, v15
v_and_b32_e64 v83, s64, v15
v_pk_fma_f32 v[40:41], v[40:41], v[156:157], v[64:65]
v_pk_fma_f32 v[42:43], v[42:43], v[158:159], v[66:67]
v_pk_fma_f32 v[44:45], v[44:45], v[160:161], v[68:69]
v_pk_fma_f32 v[46:47], v[46:47], v[162:163], v[70:71]
v_pk_fma_f32 v[48:49], v[48:49], v[164:165], v[72:73]
v_pk_fma_f32 v[50:51], v[50:51], v[166:167], v[74:75]
v_pk_fma_f32 v[52:53], v[52:53], v[168:169], v[76:77]
v_pk_fma_f32 v[54:55], v[54:55], v[170:171], v[78:79]
v_pk_fma_f32 v[56:57], v[56:57], v[172:173], v[80:81]
v_pk_fma_f32 v[58:59], v[58:59], v[174:175], v[82:83]
v_cvt_pk_bf16_f32 v16, v40, v41
v_cvt_pk_bf16_f32 v17, v42, v43
v_cvt_pk_bf16_f32 v18, v44, v45
v_cvt_pk_bf16_f32 v19, v46, v47
v_cvt_pk_bf16_f32 v20, v48, v49
v_cvt_pk_bf16_f32 v21, v50, v51
v_cvt_pk_bf16_f32 v22, v52, v53
v_cvt_pk_bf16_f32 v23, v54, v55
v_cvt_pk_bf16_f32 v24, v56, v57
v_cvt_pk_bf16_f32 v25, v58, v59
buffer_store_dwordx4 v[16:19], v4, s[96:99], s91 offen
buffer_store_dwordx4 v[20:23], v4, s[96:99], s91 offen offset:16
buffer_store_dwordx2 v[24:25], v4, s[96:99], s91 offen offset:32
L1_end:
s_endpgm
L_code_end:
.section .rodata,"a"
.p2align 6
.amdhsa_kernel recurrent_scan__linear_kernel_hedgehog__dense_activation_silu__prompt_kernel
  .amdhsa_next_free_vgpr 512
  .amdhsa_next_free_sgpr 102
  .amdhsa_accum_offset 256
  .amdhsa_group_segment_fixed_size 0
  .amdhsa_kernarg_size 80
  .amdhsa_user_sgpr_count 2
  .amdhsa_user_sgpr_kernarg_segment_ptr 1
  .amdhsa_system_sgpr_workgroup_id_x 1
.end_amdhsa_kernel
```
